```python
import torch

def _softmax(x, axis=-1):
    return torch.softmax(x, dim=axis)
def _gelu(x):
    return torch.nn.functional.gelu(x, approximate="tanh")
def _silu(x):
    return torch.nn.functional.silu(x)
def _sigmoid(x):
    return torch.sigmoid(x)
def _layernorm(x, axis=-1, eps=1e-5):
    m = x.mean(dim=axis, keepdim=True)
    v = x.var(dim=axis, keepdim=True, unbiased=False)
    return (x - m) / torch.sqrt(v + eps)
def _scatter_add(tgt, idx, src, axis=0):
    return tgt.clone().index_add_(axis, idx, src)
def _segment_sum(src, seg, n):
    out = torch.zeros((n,) + src.shape[1:], dtype=src.dtype)
    return out.index_add_(0, seg, src)
def _pad(x, pw):
    flat = tuple(v for pair in reversed(pw) for v in pair)
    return torch.nn.functional.pad(x, flat)

kernel_name = 'standalone__gqa_block_cached__near_ridge'

def setup_inputs():

    _w = (lambda a: (lambda t: t.to(torch.bfloat16) if t.is_floating_point() else t)(torch.as_tensor(a)))
    B, Sq, D = 8, 240, 512
    Hq, Hkv, Sk, Dh = 32, 32, 512, 128
    assert Hq % Hkv == 0, (Hq, Hkv)
    return {
        "x": _w((lambda *s: torch.randn(*s, dtype=torch.bfloat16) * 0.8)(B, Sq, D)),
        "k_cache": _w((lambda *s: torch.randn(*s, dtype=torch.bfloat16) * 0.8)(B, Hkv, Sk, Dh)),
        "v_cache": _w((lambda *s: torch.randn(*s, dtype=torch.bfloat16) * 0.05)(B, Hkv, Sk, Dh)),
        "wq": _w((lambda *s: torch.randn(*s, dtype=torch.bfloat16) * 0.8)(D, Hq * Dh) * (D ** -0.5)),
        "wo": _w((lambda *s: torch.randn(*s, dtype=torch.bfloat16) * 0.05)(Hq * Dh, D) * ((Hq * Dh) ** -0.5)),
    }

def reference(x, k_cache, v_cache, wq, wo):
    B, Sq, D = x.shape
    Hq, Dh = 32, 128
    Hkv = k_cache.shape[1]
    rep = Hq // Hkv
    q = (lambda x, *d: x.permute(*d))((x @ wq).reshape(B, Sq, Hq, Dh), 0, 2, 1, 3)
    k = (lambda x, n, axis: torch.repeat_interleave(x, n, dim=axis))(k_cache, rep, axis=1)
    v = (lambda x, n, axis: torch.repeat_interleave(x, n, dim=axis))(v_cache, rep, axis=1)
    scores = torch.einsum("bhqd,bhkd->bhqk", q, k) * (Dh ** -0.5)
    p = _softmax(scores, axis=-1)
    o = torch.einsum("bhqk,bhkd->bhqd", p, v)
    return (lambda x, *d: x.permute(*d))(o, 0, 2, 1, 3).reshape(B, Sq, Hq * Dh) @ wo
```

```asm
; @launch grid=(256,1,1) block=(256,1,1) lds=163840
.amdgcn_target "amdgcn-amd-amdhsa--gfx950"
.text
.globl standalone__gqa_block_cached__near_ridge_kernel
.p2align 12
.p2align 8
.type standalone__gqa_block_cached__near_ridge_kernel,@function
standalone__gqa_block_cached__near_ridge_kernel:
    s_cmp_ge_u32 s2, 256
    s_cbranch_scc1 L_end
    s_load_dwordx8 s[4:11], s[0:1], 0
    s_load_dwordx8 s[12:19], s[0:1], 32
    v_lshrrev_b32 v1, 6, v0
    v_and_b32 v0, 63, v0
    v_readfirstlane_b32 s42, v1
    s_and_b32 s43, s2, 7
    s_lshr_b32 s50, s2, 3
    s_and_b32 s40, s2, 1
    s_lshl_b32 s40, s40, 2
    s_and_b32 s49, s50, 3
    s_add_u32 s40, s40, s49
    s_lshr_b32 s41, s43, 1
    s_lshl_b32 s41, s41, 3
    s_lshr_b32 s49, s50, 2
    s_add_u32 s41, s41, s49
    s_lshr_b32 s64, s50, 3
    s_and_b32 s65, s50, 7
    s_xor_b32 s65, s65, 0
    s_add_u32 s66, s43, 9
    s_lshr_b32 s66, s66, 1
    s_lshl_b32 s56, s42, 12
    s_lshl_b32 s57, s42, 11
    s_lshl_b32 s46, s42, 13
    v_lshrrev_b32 v2, 3, v0
    v_and_b32 v3, 7, v0
    v_lshrrev_b32 v4, 4, v0
    v_xor_b32 v3, v3, v4
    v_lshlrev_b32 v3, 4, v3
    v_lshl_add_u32 v3, v2, 10, v3
    v_lshl_add_u32 v96, v1, 16, v3
    v_xor_b32 v3, 64, v96
    v_add_u32 v97, 7168, v3
    v_add_u32 v98, 14336, v96
    v_add_u32 v99, 21504, v3
    v_add_u32 v100, 32768, v96
    v_add_u32 v101, 39936, v3
    v_add_u32 v102, 47104, v96
    v_add_u32 v103, 54272, v3
    v_and_b32 v5, 15, v0
    v_lshlrev_b32 v6, 1, v4
    v_xor_b32 v6, v5, v6
    v_lshlrev_b32 v6, 4, v6
    v_lshl_add_u32 v22, v4, 8, v6
    v_lshl_add_u32 v7, v1, 4, v4
    v_lshl_add_u32 v104, v7, 13, v6
    v_xor_b32 v6, 128, v104
    v_add_u32 v105, 31744, v104
    v_add_u32 v106, 63488, v6
    v_add_u32 v107, 95232, v6
    s_mul_i32 s49, s40, 245760
    s_lshl_b32 s50, s41, 8
    s_waitcnt lgkmcnt(0)
    s_add_u32 s20, s4, s49
    s_addc_u32 s21, s5, 0
    s_mov_b32 s22, 245760
    s_mov_b32 s23, 0x00020000
    s_add_u32 s24, s10, s50
    s_addc_u32 s25, s11, 0
    s_mov_b32 s26, 0
    s_mov_b32 s27, 0x00020000
    s_sub_u32 s26, 4194304, s50
    s_load_dword s100, s[20:21], 0
    s_add_u32 s49, s66, 0
    s_and_b32 s49, s49, 7
    s_lshl_b32 s44, s49, 7
    s_add_u32 m0, s56, 98304
    s_lshl_b32 s45, s49, 19
    buffer_load_dwordx4 v104, s[24:27], s45 offen offset:0 lds
    buffer_load_dwordx4 v105, s[24:27], s45 offen offset:1024 lds
    buffer_load_dwordx4 v106, s[24:27], s45 offen offset:2048 lds
    buffer_load_dwordx4 v107, s[24:27], s45 offen offset:3072 lds
    s_add_u32 m0, s46, 32768
    s_nop 0
    buffer_load_dwordx4 v96, s[20:23], s44 offen offset:0 lds
    buffer_load_dwordx4 v97, s[20:23], s44 offen offset:1024 lds
    buffer_load_dwordx4 v98, s[20:23], s44 offen offset:2048 lds
    buffer_load_dwordx4 v99, s[20:23], s44 offen offset:3072 lds
    s_add_u32 m0, s46, 36864
    s_nop 0
    buffer_load_dwordx4 v100, s[20:23], s44 offen offset:0 lds
    buffer_load_dwordx4 v101, s[20:23], s44 offen offset:1024 lds
    buffer_load_dwordx4 v102, s[20:23], s44 offen offset:2048 lds
    buffer_load_dwordx4 v103, s[20:23], s44 offen offset:3072 lds
    s_cmp_lt_u32 s42, 2
    s_cbranch_scc1 L_t01
    s_cmp_eq_u32 s42, 2
    s_cbranch_scc1 L_t2
    s_mov_b32 s51, 0x1080000
    s_load_dword s96, s[18:19], s51
    s_load_dword s97, s[14:15], 0
    s_load_dword s98, s[16:17], 128
    s_branch L_tend
L_t2:
    s_lshl_b32 s51, s40, 21
    s_lshl_b32 s52, s43, 21
    s_add_u32 s51, s51, 1836032
    s_add_u32 s52, s52, 1836032
    s_load_dword s97, s[18:19], s51
    s_load_dword s98, s[18:19], s52
    s_branch L_tend
L_t01:
    s_cmp_eq_u32 s42, 0
    s_cbranch_scc1 L_t0
    s_mov_b32 s51, 0x200000
    s_load_dword s96, s[10:11], 0
    s_load_dword s97, s[10:11], s51
    s_load_dword s98, s[12:13], 0
    s_load_dword s99, s[12:13], s51
    s_branch L_tend
L_t0:
    s_lshl_b32 s51, s40, 5
    s_add_u32 s51, s51, s41
    s_lshl_b32 s51, s51, 17
    s_load_dword s97, s[6:7], s51
    s_load_dword s98, s[8:9], s51
L_tend:
    v_xor_b32 v23, 128, v22
    v_xor_b32 v5, v5, v4
    v_lshlrev_b32 v5, 4, v5
    v_lshl_add_u32 v20, v4, 8, v5
    s_and_b32 s49, s42, 1
    s_lshl_b32 s49, s49, 7
    v_xor_b32 v20, s49, v20
    v_xor_b32 v21, 64, v20
    s_lshl_b32 s49, s40, 5
    s_add_u32 s49, s49, s41
    s_lshl_b32 s49, s49, 17
    s_add_u32 s28, s6, s49
    s_addc_u32 s29, s7, 0
    s_mov_b32 s30, 131072
    s_mov_b32 s31, 0x00020000
    s_add_u32 s32, s8, s49
    s_addc_u32 s33, s9, 0
    s_mov_b32 s34, 131072
    s_mov_b32 s35, 0x00020000
    s_and_b32 s58, s41, 7
    s_lshl_b32 s58, s58, 14
    s_add_u32 s58, s58, s57
    v_and_b32 v2, 15, v0
    v_lshrrev_b32 v3, 4, v0
    v_lshrrev_b32 v4, 1, v2
    v_xor_b32 v4, v4, v3
    v_lshlrev_b32 v4, 4, v4
    v_lshl_add_u32 v4, v2, 7, v4
    v_lshl_add_u32 v4, v1, 13, v4
    v_add_u32 v108, 32768, v4
    v_xor_b32 v109, 64, v108
    v_add_u32 v110, 98304, v108
    v_add_u32 v111, 98304, v109
    v_bfe_u32 v4, v0, 2, 2
    v_mul_u32_u24 v5, 288, v4
    v_lshl_add_u32 v5, v3, 11, v5
    v_and_b32 v6, 16, v0
    v_lshl_add_u32 v5, v6, 3, v5
    v_and_b32 v6, 3, v0
    v_lshl_add_u32 v5, v6, 3, v5
    v_add_u32 v112, 81920, v5
    v_xor_b32 v113, 32, v112
    v_xor_b32 v114, 64, v112
    v_xor_b32 v115, 96, v112
    v_xor_b32 v116, 128, v112
    v_xor_b32 v117, 160, v112
    v_xor_b32 v118, 192, v112
    v_xor_b32 v119, 224, v112
    s_getpc_b64 s[4:5]
L_pc:
    s_lshr_b32 s49, s2, 3
    s_lshl_b32 s49, s49, 2
    s_add_u32 s49, s49, s42
    s_lshl_b32 s49, s49, 9
    v_lshlrev_b32 v2, 3, v0
    v_add_u32 v2, s49, v2
    s_mov_b32 s6, L_code_end - L_pc
    s_mov_b32 s7, 0x00020000
    buffer_load_dword v3, v2, s[4:7], 0 offen
    s_add_u32 s49, s66, 1
    s_and_b32 s49, s49, 7
    s_lshl_b32 s44, s49, 7
    s_add_u32 m0, s56, 114688
    s_lshl_b32 s45, s49, 19
    buffer_load_dwordx4 v104, s[24:27], s45 offen offset:0 lds
    buffer_load_dwordx4 v105, s[24:27], s45 offen offset:1024 lds
    buffer_load_dwordx4 v106, s[24:27], s45 offen offset:2048 lds
    buffer_load_dwordx4 v107, s[24:27], s45 offen offset:3072 lds
    s_add_u32 m0, s46, 131072
    s_nop 0
    buffer_load_dwordx4 v96, s[20:23], s44 offen offset:0 lds
    buffer_load_dwordx4 v97, s[20:23], s44 offen offset:1024 lds
    buffer_load_dwordx4 v98, s[20:23], s44 offen offset:2048 lds
    buffer_load_dwordx4 v99, s[20:23], s44 offen offset:3072 lds
    s_add_u32 m0, s46, 135168
    s_nop 0
    buffer_load_dwordx4 v100, s[20:23], s44 offen offset:0 lds
    buffer_load_dwordx4 v101, s[20:23], s44 offen offset:1024 lds
    buffer_load_dwordx4 v102, s[20:23], s44 offen offset:2048 lds
    buffer_load_dwordx4 v103, s[20:23], s44 offen offset:3072 lds
    s_and_b32 s49, s41, 7
    s_lshl_b32 s49, s49, 2
    s_add_u32 s49, s49, s42
    s_lshl_b32 s49, s49, 13
    v_and_b32 v2, 7, v0
    v_lshlrev_b32 v2, 10, v2
    buffer_load_dword v4, v2, s[20:23], s49 offen offset:384
    s_waitcnt vmcnt(14)
    s_barrier
    ds_read_b128 a[32:35], v108 offset:0
    ds_read_b128 a[36:39], v109 offset:0
    ds_read_b128 a[40:43], v108 offset:2048
    ds_read_b128 a[44:47], v109 offset:2048
    ds_read_b128 a[48:51], v108 offset:4096
    ds_read_b128 a[52:55], v109 offset:4096
    ds_read_b128 a[56:59], v108 offset:6144
    ds_read_b128 a[60:63], v109 offset:6144
    ds_read_b64_tr_b16 a[0:1], v112 offset:16384
    ds_read_b64_tr_b16 a[2:3], v112 offset:17408
    ds_read_b64_tr_b16 a[4:5], v112 offset:24576
    ds_read_b64_tr_b16 a[6:7], v112 offset:25600
    ds_read_b64_tr_b16 a[8:9], v113 offset:16384
    ds_read_b64_tr_b16 a[10:11], v113 offset:17408
    ds_read_b64_tr_b16 a[12:13], v113 offset:24576
    ds_read_b64_tr_b16 a[14:15], v113 offset:25600
    s_waitcnt lgkmcnt(0)
    v_mfma_f32_16x16x32_bf16 v[32:35], a[0:3], a[32:35], 0
    s_add_u32 s49, s66, 2
    ds_read_b64_tr_b16 a[16:17], v114 offset:16384
    v_mfma_f32_16x16x32_bf16 v[32:35], a[4:7], a[36:39], v[32:35]
    s_and_b32 s49, s49, 7
    ds_read_b64_tr_b16 a[18:19], v114 offset:17408
    v_mfma_f32_16x16x32_bf16 v[40:43], a[0:3], a[40:43], 0
    ds_read_b64_tr_b16 a[20:21], v114 offset:24576
    v_mfma_f32_16x16x32_bf16 v[40:43], a[4:7], a[44:47], v[40:43]
    s_lshl_b32 s44, s49, 7
    ds_read_b64_tr_b16 a[22:23], v114 offset:25600
    v_mfma_f32_16x16x32_bf16 v[48:51], a[0:3], a[48:51], 0
    v_mfma_f32_16x16x32_bf16 v[48:51], a[4:7], a[52:55], v[48:51]
    s_add_u32 m0, s56, 81920
    ds_read_b64_tr_b16 a[24:25], v115 offset:16384
    v_mfma_f32_16x16x32_bf16 v[56:59], a[0:3], a[56:59], 0
    ds_read_b64_tr_b16 a[26:27], v115 offset:17408
    v_mfma_f32_16x16x32_bf16 v[56:59], a[4:7], a[60:63], v[56:59]
    s_lshl_b32 s45, s49, 19
    ds_read_b64_tr_b16 a[28:29], v115 offset:24576
    v_mfma_f32_16x16x32_bf16 v[36:39], a[8:11], a[32:35], 0
    buffer_load_dwordx4 v104, s[24:27], s45 offen offset:0 lds
    v_mfma_f32_16x16x32_bf16 v[36:39], a[12:15], a[36:39], v[36:39]
    ds_read_b64_tr_b16 a[30:31], v115 offset:25600
    v_mfma_f32_16x16x32_bf16 v[44:47], a[8:11], a[40:43], 0
    buffer_load_dwordx4 v105, s[24:27], s45 offen offset:1024 lds
    v_mfma_f32_16x16x32_bf16 v[44:47], a[12:15], a[44:47], v[44:47]
    v_mfma_f32_16x16x32_bf16 v[52:55], a[8:11], a[48:51], 0
    buffer_load_dwordx4 v106, s[24:27], s45 offen offset:2048 lds
    v_mfma_f32_16x16x32_bf16 v[52:55], a[12:15], a[52:55], v[52:55]
    v_mfma_f32_16x16x32_bf16 v[60:63], a[8:11], a[56:59], 0
    buffer_load_dwordx4 v107, s[24:27], s45 offen offset:3072 lds
    v_mfma_f32_16x16x32_bf16 v[60:63], a[12:15], a[60:63], v[60:63]
    s_waitcnt lgkmcnt(0)
    v_mfma_f32_16x16x32_bf16 v[64:67], a[16:19], a[32:35], 0
    s_add_u32 m0, s46, 32768
    ds_read_b64_tr_b16 a[0:1], v116 offset:16384
    v_mfma_f32_16x16x32_bf16 v[64:67], a[20:23], a[36:39], v[64:67]
    ds_read_b64_tr_b16 a[2:3], v116 offset:17408
    v_mfma_f32_16x16x32_bf16 v[72:75], a[16:19], a[40:43], 0
    s_nop 0
    ds_read_b64_tr_b16 a[4:5], v116 offset:24576
    v_mfma_f32_16x16x32_bf16 v[72:75], a[20:23], a[44:47], v[72:75]
    ds_read_b64_tr_b16 a[6:7], v116 offset:25600
    v_mfma_f32_16x16x32_bf16 v[80:83], a[16:19], a[48:51], 0
    ds_read_b64_tr_b16 a[8:9], v117 offset:16384
    v_mfma_f32_16x16x32_bf16 v[80:83], a[20:23], a[52:55], v[80:83]
    buffer_load_dwordx4 v96, s[20:23], s44 offen offset:0 lds
    v_mfma_f32_16x16x32_bf16 v[88:91], a[16:19], a[56:59], 0
    ds_read_b64_tr_b16 a[10:11], v117 offset:17408
    v_mfma_f32_16x16x32_bf16 v[88:91], a[20:23], a[60:63], v[88:91]
    ds_read_b64_tr_b16 a[12:13], v117 offset:24576
    v_mfma_f32_16x16x32_bf16 v[68:71], a[24:27], a[32:35], 0
    buffer_load_dwordx4 v97, s[20:23], s44 offen offset:1024 lds
    v_mfma_f32_16x16x32_bf16 v[68:71], a[28:31], a[36:39], v[68:71]
    ds_read_b64_tr_b16 a[14:15], v117 offset:25600
    v_mfma_f32_16x16x32_bf16 v[76:79], a[24:27], a[40:43], 0
    buffer_load_dwordx4 v98, s[20:23], s44 offen offset:2048 lds
    v_mfma_f32_16x16x32_bf16 v[76:79], a[28:31], a[44:47], v[76:79]
    v_mfma_f32_16x16x32_bf16 v[84:87], a[24:27], a[48:51], 0
    v_mfma_f32_16x16x32_bf16 v[84:87], a[28:31], a[52:55], v[84:87]
    buffer_load_dwordx4 v99, s[20:23], s44 offen offset:3072 lds
    v_mfma_f32_16x16x32_bf16 v[92:95], a[24:27], a[56:59], 0
    v_mfma_f32_16x16x32_bf16 v[92:95], a[28:31], a[60:63], v[92:95]
    s_waitcnt lgkmcnt(0)
    v_mfma_f32_16x16x32_bf16 v[192:195], a[0:3], a[32:35], 0
    s_add_u32 m0, s46, 36864
    ds_read_b64_tr_b16 a[16:17], v118 offset:16384
    v_mfma_f32_16x16x32_bf16 v[192:195], a[4:7], a[36:39], v[192:195]
    ds_read_b64_tr_b16 a[18:19], v118 offset:17408
    v_mfma_f32_16x16x32_bf16 v[200:203], a[0:3], a[40:43], 0
    s_nop 0
    ds_read_b64_tr_b16 a[20:21], v118 offset:24576
    v_mfma_f32_16x16x32_bf16 v[200:203], a[4:7], a[44:47], v[200:203]
    ds_read_b64_tr_b16 a[22:23], v118 offset:25600
    v_mfma_f32_16x16x32_bf16 v[208:211], a[0:3], a[48:51], 0
    ds_read_b64_tr_b16 a[24:25], v119 offset:16384
    v_mfma_f32_16x16x32_bf16 v[208:211], a[4:7], a[52:55], v[208:211]
    buffer_load_dwordx4 v100, s[20:23], s44 offen offset:0 lds
    v_mfma_f32_16x16x32_bf16 v[216:219], a[0:3], a[56:59], 0
    ds_read_b64_tr_b16 a[26:27], v119 offset:17408
    v_mfma_f32_16x16x32_bf16 v[216:219], a[4:7], a[60:63], v[216:219]
    ds_read_b64_tr_b16 a[28:29], v119 offset:24576
    v_mfma_f32_16x16x32_bf16 v[196:199], a[8:11], a[32:35], 0
    buffer_load_dwordx4 v101, s[20:23], s44 offen offset:1024 lds
    v_mfma_f32_16x16x32_bf16 v[196:199], a[12:15], a[36:39], v[196:199]
    ds_read_b64_tr_b16 a[30:31], v119 offset:25600
    v_mfma_f32_16x16x32_bf16 v[204:207], a[8:11], a[40:43], 0
    buffer_load_dwordx4 v102, s[20:23], s44 offen offset:2048 lds
    v_mfma_f32_16x16x32_bf16 v[204:207], a[12:15], a[44:47], v[204:207]
    v_mfma_f32_16x16x32_bf16 v[212:215], a[8:11], a[48:51], 0
    v_mfma_f32_16x16x32_bf16 v[212:215], a[12:15], a[52:55], v[212:215]
    buffer_load_dwordx4 v103, s[20:23], s44 offen offset:3072 lds
    v_mfma_f32_16x16x32_bf16 v[220:223], a[8:11], a[56:59], 0
    v_mfma_f32_16x16x32_bf16 v[220:223], a[12:15], a[60:63], v[220:223]
    s_waitcnt vmcnt(13) lgkmcnt(0)
    s_barrier
    v_mfma_f32_16x16x32_bf16 v[224:227], a[16:19], a[32:35], 0
    s_add_u32 s50, s58, 0
    ds_read_b128 a[96:99], v110 offset:0
    ds_read_b128 a[100:103], v111 offset:0
    v_mfma_f32_16x16x32_bf16 v[224:227], a[20:23], a[36:39], v[224:227]
    ds_read_b128 a[104:107], v110 offset:2048
    v_mfma_f32_16x16x32_bf16 v[232:235], a[16:19], a[40:43], 0
    ds_read_b128 a[108:111], v111 offset:2048
    v_mfma_f32_16x16x32_bf16 v[232:235], a[20:23], a[44:47], v[232:235]
    s_add_u32 m0, s57, 0
    ds_read_b128 a[112:115], v110 offset:4096
    ds_read_b128 a[116:119], v111 offset:4096
    v_mfma_f32_16x16x32_bf16 v[240:243], a[16:19], a[48:51], 0
    ds_read_b128 a[120:123], v110 offset:6144
    v_mfma_f32_16x16x32_bf16 v[240:243], a[20:23], a[52:55], v[240:243]
    ds_read_b128 a[124:127], v111 offset:6144
    v_mfma_f32_16x16x32_bf16 v[248:251], a[16:19], a[56:59], 0
    s_and_b32 s50, s50, 0x1ffff
    ds_read_b64_tr_b16 a[0:1], v112 offset:32768
    ds_read_b64_tr_b16 a[2:3], v112 offset:33792
    v_mfma_f32_16x16x32_bf16 v[248:251], a[20:23], a[60:63], v[248:251]
    ds_read_b64_tr_b16 a[4:5], v112 offset:40960
    v_mfma_f32_16x16x32_bf16 v[228:231], a[24:27], a[32:35], 0
    ds_read_b64_tr_b16 a[6:7], v112 offset:41984
    v_mfma_f32_16x16x32_bf16 v[228:231], a[28:31], a[36:39], v[228:231]
    buffer_load_dwordx4 v20, s[28:31], s50 offen offset:0 nt lds
    v_mfma_f32_16x16x32_bf16 v[236:239], a[24:27], a[40:43], 0
    ds_read_b64_tr_b16 a[8:9], v113 offset:32768
    ds_read_b64_tr_b16 a[10:11], v113 offset:33792
    v_mfma_f32_16x16x32_bf16 v[236:239], a[28:31], a[44:47], v[236:239]
    ds_read_b64_tr_b16 a[12:13], v113 offset:40960
    v_mfma_f32_16x16x32_bf16 v[244:247], a[24:27], a[48:51], 0
    buffer_load_dwordx4 v21, s[28:31], s50 offen offset:1024 nt lds
    v_mfma_f32_16x16x32_bf16 v[244:247], a[28:31], a[52:55], v[244:247]
    ds_read_b64_tr_b16 a[14:15], v113 offset:41984
    v_mfma_f32_16x16x32_bf16 v[252:255], a[24:27], a[56:59], 0
    v_mfma_f32_16x16x32_bf16 v[252:255], a[28:31], a[60:63], v[252:255]
    s_waitcnt lgkmcnt(0)
    v_mfma_f32_16x16x32_bf16 v[32:35], a[0:3], a[96:99], v[32:35]
    s_add_u32 s49, s66, 3
    ds_read_b64_tr_b16 a[16:17], v114 offset:32768
    v_mfma_f32_16x16x32_bf16 v[32:35], a[4:7], a[100:103], v[32:35]
    s_and_b32 s49, s49, 7
    ds_read_b64_tr_b16 a[18:19], v114 offset:33792
    v_mfma_f32_16x16x32_bf16 v[40:43], a[0:3], a[104:107], v[40:43]
    ds_read_b64_tr_b16 a[20:21], v114 offset:40960
    v_mfma_f32_16x16x32_bf16 v[40:43], a[4:7], a[108:111], v[40:43]
    s_lshl_b32 s44, s49, 7
    ds_read_b64_tr_b16 a[22:23], v114 offset:41984
    v_mfma_f32_16x16x32_bf16 v[48:51], a[0:3], a[112:115], v[48:51]
    v_mfma_f32_16x16x32_bf16 v[48:51], a[4:7], a[116:119], v[48:51]
    s_add_u32 m0, s56, 98304
    ds_read_b64_tr_b16 a[24:25], v115 offset:32768
    v_mfma_f32_16x16x32_bf16 v[56:59], a[0:3], a[120:123], v[56:59]
    ds_read_b64_tr_b16 a[26:27], v115 offset:33792
    v_mfma_f32_16x16x32_bf16 v[56:59], a[4:7], a[124:127], v[56:59]
    s_lshl_b32 s45, s49, 19
    ds_read_b64_tr_b16 a[28:29], v115 offset:40960
    v_mfma_f32_16x16x32_bf16 v[36:39], a[8:11], a[96:99], v[36:39]
    buffer_load_dwordx4 v104, s[24:27], s45 offen offset:0 lds
    v_mfma_f32_16x16x32_bf16 v[36:39], a[12:15], a[100:103], v[36:39]
    ds_read_b64_tr_b16 a[30:31], v115 offset:41984
    v_mfma_f32_16x16x32_bf16 v[44:47], a[8:11], a[104:107], v[44:47]
    buffer_load_dwordx4 v105, s[24:27], s45 offen offset:1024 lds
    v_mfma_f32_16x16x32_bf16 v[44:47], a[12:15], a[108:111], v[44:47]
    v_mfma_f32_16x16x32_bf16 v[52:55], a[8:11], a[112:115], v[52:55]
    buffer_load_dwordx4 v106, s[24:27], s45 offen offset:2048 lds
    v_mfma_f32_16x16x32_bf16 v[52:55], a[12:15], a[116:119], v[52:55]
    v_mfma_f32_16x16x32_bf16 v[60:63], a[8:11], a[120:123], v[60:63]
    buffer_load_dwordx4 v107, s[24:27], s45 offen offset:3072 lds
    v_mfma_f32_16x16x32_bf16 v[60:63], a[12:15], a[124:127], v[60:63]
    s_waitcnt lgkmcnt(0)
    v_mfma_f32_16x16x32_bf16 v[64:67], a[16:19], a[96:99], v[64:67]
    s_add_u32 m0, s46, 131072
    ds_read_b64_tr_b16 a[0:1], v116 offset:32768
    v_mfma_f32_16x16x32_bf16 v[64:67], a[20:23], a[100:103], v[64:67]
    ds_read_b64_tr_b16 a[2:3], v116 offset:33792
    v_mfma_f32_16x16x32_bf16 v[72:75], a[16:19], a[104:107], v[72:75]
    s_nop 0
    ds_read_b64_tr_b16 a[4:5], v116 offset:40960
    v_mfma_f32_16x16x32_bf16 v[72:75], a[20:23], a[108:111], v[72:75]
    ds_read_b64_tr_b16 a[6:7], v116 offset:41984
    v_mfma_f32_16x16x32_bf16 v[80:83], a[16:19], a[112:115], v[80:83]
    ds_read_b64_tr_b16 a[8:9], v117 offset:32768
    v_mfma_f32_16x16x32_bf16 v[80:83], a[20:23], a[116:119], v[80:83]
    buffer_load_dwordx4 v96, s[20:23], s44 offen offset:0 lds
    v_mfma_f32_16x16x32_bf16 v[88:91], a[16:19], a[120:123], v[88:91]
    ds_read_b64_tr_b16 a[10:11], v117 offset:33792
    v_mfma_f32_16x16x32_bf16 v[88:91], a[20:23], a[124:127], v[88:91]
    ds_read_b64_tr_b16 a[12:13], v117 offset:40960
    v_mfma_f32_16x16x32_bf16 v[68:71], a[24:27], a[96:99], v[68:71]
    buffer_load_dwordx4 v97, s[20:23], s44 offen offset:1024 lds
    v_mfma_f32_16x16x32_bf16 v[68:71], a[28:31], a[100:103], v[68:71]
    ds_read_b64_tr_b16 a[14:15], v117 offset:41984
    v_mfma_f32_16x16x32_bf16 v[76:79], a[24:27], a[104:107], v[76:79]
    buffer_load_dwordx4 v98, s[20:23], s44 offen offset:2048 lds
    v_mfma_f32_16x16x32_bf16 v[76:79], a[28:31], a[108:111], v[76:79]
    v_mfma_f32_16x16x32_bf16 v[84:87], a[24:27], a[112:115], v[84:87]
    v_mfma_f32_16x16x32_bf16 v[84:87], a[28:31], a[116:119], v[84:87]
    buffer_load_dwordx4 v99, s[20:23], s44 offen offset:3072 lds
    v_mfma_f32_16x16x32_bf16 v[92:95], a[24:27], a[120:123], v[92:95]
    v_mfma_f32_16x16x32_bf16 v[92:95], a[28:31], a[124:127], v[92:95]
    s_waitcnt lgkmcnt(0)
    v_mfma_f32_16x16x32_bf16 v[192:195], a[0:3], a[96:99], v[192:195]
    s_add_u32 m0, s46, 135168
    ds_read_b64_tr_b16 a[16:17], v118 offset:32768
    v_mfma_f32_16x16x32_bf16 v[192:195], a[4:7], a[100:103], v[192:195]
    ds_read_b64_tr_b16 a[18:19], v118 offset:33792
    v_mfma_f32_16x16x32_bf16 v[200:203], a[0:3], a[104:107], v[200:203]
    s_nop 0
    ds_read_b64_tr_b16 a[20:21], v118 offset:40960
    v_mfma_f32_16x16x32_bf16 v[200:203], a[4:7], a[108:111], v[200:203]
    ds_read_b64_tr_b16 a[22:23], v118 offset:41984
    v_mfma_f32_16x16x32_bf16 v[208:211], a[0:3], a[112:115], v[208:211]
    ds_read_b64_tr_b16 a[24:25], v119 offset:32768
    v_mfma_f32_16x16x32_bf16 v[208:211], a[4:7], a[116:119], v[208:211]
    buffer_load_dwordx4 v100, s[20:23], s44 offen offset:0 lds
    v_mfma_f32_16x16x32_bf16 v[216:219], a[0:3], a[120:123], v[216:219]
    ds_read_b64_tr_b16 a[26:27], v119 offset:33792
    v_mfma_f32_16x16x32_bf16 v[216:219], a[4:7], a[124:127], v[216:219]
    ds_read_b64_tr_b16 a[28:29], v119 offset:40960
    v_mfma_f32_16x16x32_bf16 v[196:199], a[8:11], a[96:99], v[196:199]
    buffer_load_dwordx4 v101, s[20:23], s44 offen offset:1024 lds
    v_mfma_f32_16x16x32_bf16 v[196:199], a[12:15], a[100:103], v[196:199]
    ds_read_b64_tr_b16 a[30:31], v119 offset:41984
    v_mfma_f32_16x16x32_bf16 v[204:207], a[8:11], a[104:107], v[204:207]
    buffer_load_dwordx4 v102, s[20:23], s44 offen offset:2048 lds
    v_mfma_f32_16x16x32_bf16 v[204:207], a[12:15], a[108:111], v[204:207]
    v_mfma_f32_16x16x32_bf16 v[212:215], a[8:11], a[112:115], v[212:215]
    v_mfma_f32_16x16x32_bf16 v[212:215], a[12:15], a[116:119], v[212:215]
    buffer_load_dwordx4 v103, s[20:23], s44 offen offset:3072 lds
    v_mfma_f32_16x16x32_bf16 v[220:223], a[8:11], a[120:123], v[220:223]
    v_mfma_f32_16x16x32_bf16 v[220:223], a[12:15], a[124:127], v[220:223]
    s_mov_b64 exec, 0
    s_cmp_lt_u32 s42, 2
    s_cbranch_scc1 L_h0
    s_cmp_eq_u32 s42, 2
    s_cbranch_scc1 L_pad2
    s_branch L_pad3
L_h0:
    s_cmp_eq_u32 s42, 0
    s_cbranch_scc1 L_pad0
    s_branch L_pad1
L_ret0:
    s_mov_b64 exec, -1
    s_waitcnt vmcnt(14) lgkmcnt(0)
    s_barrier
    v_mfma_f32_16x16x32_bf16 v[224:227], a[16:19], a[96:99], v[224:227]
    s_add_u32 s50, s58, 8192
    ds_read_b128 a[32:35], v108 offset:0
    ds_read_b128 a[36:39], v109 offset:0
    v_mfma_f32_16x16x32_bf16 v[224:227], a[20:23], a[100:103], v[224:227]
    ds_read_b128 a[40:43], v108 offset:2048
    v_mfma_f32_16x16x32_bf16 v[232:235], a[16:19], a[104:107], v[232:235]
    ds_read_b128 a[44:47], v109 offset:2048
    v_mfma_f32_16x16x32_bf16 v[232:235], a[20:23], a[108:111], v[232:235]
    s_add_u32 m0, s57, 8192
    ds_read_b128 a[48:51], v108 offset:4096
    ds_read_b128 a[52:55], v109 offset:4096
    v_mfma_f32_16x16x32_bf16 v[240:243], a[16:19], a[112:115], v[240:243]
    ds_read_b128 a[56:59], v108 offset:6144
    v_mfma_f32_16x16x32_bf16 v[240:243], a[20:23], a[116:119], v[240:243]
    ds_read_b128 a[60:63], v109 offset:6144
    v_mfma_f32_16x16x32_bf16 v[248:251], a[16:19], a[120:123], v[248:251]
    s_and_b32 s50, s50, 0x1ffff
    ds_read_b64_tr_b16 a[0:1], v112 offset:0
    ds_read_b64_tr_b16 a[2:3], v112 offset:1024
    v_mfma_f32_16x16x32_bf16 v[248:251], a[20:23], a[124:127], v[248:251]
    ds_read_b64_tr_b16 a[4:5], v112 offset:8192
    v_mfma_f32_16x16x32_bf16 v[228:231], a[24:27], a[96:99], v[228:231]
    ds_read_b64_tr_b16 a[6:7], v112 offset:9216
    v_mfma_f32_16x16x32_bf16 v[228:231], a[28:31], a[100:103], v[228:231]
    buffer_load_dwordx4 v20, s[28:31], s50 offen offset:0 nt lds
    v_mfma_f32_16x16x32_bf16 v[236:239], a[24:27], a[104:107], v[236:239]
    ds_read_b64_tr_b16 a[8:9], v113 offset:0
    ds_read_b64_tr_b16 a[10:11], v113 offset:1024
    v_mfma_f32_16x16x32_bf16 v[236:239], a[28:31], a[108:111], v[236:239]
    ds_read_b64_tr_b16 a[12:13], v113 offset:8192
    v_mfma_f32_16x16x32_bf16 v[244:247], a[24:27], a[112:115], v[244:247]
    buffer_load_dwordx4 v21, s[28:31], s50 offen offset:1024 nt lds
    v_mfma_f32_16x16x32_bf16 v[244:247], a[28:31], a[116:119], v[244:247]
    ds_read_b64_tr_b16 a[14:15], v113 offset:9216
    v_mfma_f32_16x16x32_bf16 v[252:255], a[24:27], a[120:123], v[252:255]
    v_mfma_f32_16x16x32_bf16 v[252:255], a[28:31], a[124:127], v[252:255]
    s_waitcnt lgkmcnt(0)
    v_mfma_f32_16x16x32_bf16 v[32:35], a[0:3], a[32:35], v[32:35]
    s_add_u32 s49, s66, 4
    ds_read_b64_tr_b16 a[16:17], v114 offset:0
    v_mfma_f32_16x16x32_bf16 v[32:35], a[4:7], a[36:39], v[32:35]
    s_and_b32 s49, s49, 7
    ds_read_b64_tr_b16 a[18:19], v114 offset:1024
    v_mfma_f32_16x16x32_bf16 v[40:43], a[0:3], a[40:43], v[40:43]
    ds_read_b64_tr_b16 a[20:21], v114 offset:8192
    v_mfma_f32_16x16x32_bf16 v[40:43], a[4:7], a[44:47], v[40:43]
    s_lshl_b32 s44, s49, 7
    ds_read_b64_tr_b16 a[22:23], v114 offset:9216
    v_mfma_f32_16x16x32_bf16 v[48:51], a[0:3], a[48:51], v[48:51]
    v_mfma_f32_16x16x32_bf16 v[48:51], a[4:7], a[52:55], v[48:51]
    s_add_u32 m0, s56, 114688
    ds_read_b64_tr_b16 a[24:25], v115 offset:0
    v_mfma_f32_16x16x32_bf16 v[56:59], a[0:3], a[56:59], v[56:59]
    ds_read_b64_tr_b16 a[26:27], v115 offset:1024
    v_mfma_f32_16x16x32_bf16 v[56:59], a[4:7], a[60:63], v[56:59]
    s_lshl_b32 s45, s49, 19
    ds_read_b64_tr_b16 a[28:29], v115 offset:8192
    v_mfma_f32_16x16x32_bf16 v[36:39], a[8:11], a[32:35], v[36:39]
    buffer_load_dwordx4 v104, s[24:27], s45 offen offset:0 lds
    v_mfma_f32_16x16x32_bf16 v[36:39], a[12:15], a[36:39], v[36:39]
    ds_read_b64_tr_b16 a[30:31], v115 offset:9216
    v_mfma_f32_16x16x32_bf16 v[44:47], a[8:11], a[40:43], v[44:47]
    buffer_load_dwordx4 v105, s[24:27], s45 offen offset:1024 lds
    v_mfma_f32_16x16x32_bf16 v[44:47], a[12:15], a[44:47], v[44:47]
    v_mfma_f32_16x16x32_bf16 v[52:55], a[8:11], a[48:51], v[52:55]
    buffer_load_dwordx4 v106, s[24:27], s45 offen offset:2048 lds
    v_mfma_f32_16x16x32_bf16 v[52:55], a[12:15], a[52:55], v[52:55]
    v_mfma_f32_16x16x32_bf16 v[60:63], a[8:11], a[56:59], v[60:63]
    buffer_load_dwordx4 v107, s[24:27], s45 offen offset:3072 lds
    v_mfma_f32_16x16x32_bf16 v[60:63], a[12:15], a[60:63], v[60:63]
    s_waitcnt lgkmcnt(0)
    v_mfma_f32_16x16x32_bf16 v[64:67], a[16:19], a[32:35], v[64:67]
    s_add_u32 m0, s46, 32768
    ds_read_b64_tr_b16 a[0:1], v116 offset:0
    v_mfma_f32_16x16x32_bf16 v[64:67], a[20:23], a[36:39], v[64:67]
    ds_read_b64_tr_b16 a[2:3], v116 offset:1024
    v_mfma_f32_16x16x32_bf16 v[72:75], a[16:19], a[40:43], v[72:75]
    s_nop 0
    ds_read_b64_tr_b16 a[4:5], v116 offset:8192
    v_mfma_f32_16x16x32_bf16 v[72:75], a[20:23], a[44:47], v[72:75]
    ds_read_b64_tr_b16 a[6:7], v116 offset:9216
    v_mfma_f32_16x16x32_bf16 v[80:83], a[16:19], a[48:51], v[80:83]
    ds_read_b64_tr_b16 a[8:9], v117 offset:0
    v_mfma_f32_16x16x32_bf16 v[80:83], a[20:23], a[52:55], v[80:83]
    buffer_load_dwordx4 v96, s[20:23], s44 offen offset:0 lds
    v_mfma_f32_16x16x32_bf16 v[88:91], a[16:19], a[56:59], v[88:91]
    ds_read_b64_tr_b16 a[10:11], v117 offset:1024
    v_mfma_f32_16x16x32_bf16 v[88:91], a[20:23], a[60:63], v[88:91]
    ds_read_b64_tr_b16 a[12:13], v117 offset:8192
    v_mfma_f32_16x16x32_bf16 v[68:71], a[24:27], a[32:35], v[68:71]
    buffer_load_dwordx4 v97, s[20:23], s44 offen offset:1024 lds
    v_mfma_f32_16x16x32_bf16 v[68:71], a[28:31], a[36:39], v[68:71]
    ds_read_b64_tr_b16 a[14:15], v117 offset:9216
    v_mfma_f32_16x16x32_bf16 v[76:79], a[24:27], a[40:43], v[76:79]
    buffer_load_dwordx4 v98, s[20:23], s44 offen offset:2048 lds
    v_mfma_f32_16x16x32_bf16 v[76:79], a[28:31], a[44:47], v[76:79]
    v_mfma_f32_16x16x32_bf16 v[84:87], a[24:27], a[48:51], v[84:87]
    v_mfma_f32_16x16x32_bf16 v[84:87], a[28:31], a[52:55], v[84:87]
    buffer_load_dwordx4 v99, s[20:23], s44 offen offset:3072 lds
    v_mfma_f32_16x16x32_bf16 v[92:95], a[24:27], a[56:59], v[92:95]
    v_mfma_f32_16x16x32_bf16 v[92:95], a[28:31], a[60:63], v[92:95]
    s_waitcnt lgkmcnt(0)
    v_mfma_f32_16x16x32_bf16 v[192:195], a[0:3], a[32:35], v[192:195]
    s_add_u32 m0, s46, 36864
    ds_read_b64_tr_b16 a[16:17], v118 offset:0
    v_mfma_f32_16x16x32_bf16 v[192:195], a[4:7], a[36:39], v[192:195]
    ds_read_b64_tr_b16 a[18:19], v118 offset:1024
    v_mfma_f32_16x16x32_bf16 v[200:203], a[0:3], a[40:43], v[200:203]
    s_nop 0
    ds_read_b64_tr_b16 a[20:21], v118 offset:8192
    v_mfma_f32_16x16x32_bf16 v[200:203], a[4:7], a[44:47], v[200:203]
    ds_read_b64_tr_b16 a[22:23], v118 offset:9216
    v_mfma_f32_16x16x32_bf16 v[208:211], a[0:3], a[48:51], v[208:211]
    ds_read_b64_tr_b16 a[24:25], v119 offset:0
    v_mfma_f32_16x16x32_bf16 v[208:211], a[4:7], a[52:55], v[208:211]
    buffer_load_dwordx4 v100, s[20:23], s44 offen offset:0 lds
    v_mfma_f32_16x16x32_bf16 v[216:219], a[0:3], a[56:59], v[216:219]
    ds_read_b64_tr_b16 a[26:27], v119 offset:1024
    v_mfma_f32_16x16x32_bf16 v[216:219], a[4:7], a[60:63], v[216:219]
    ds_read_b64_tr_b16 a[28:29], v119 offset:8192
    v_mfma_f32_16x16x32_bf16 v[196:199], a[8:11], a[32:35], v[196:199]
    buffer_load_dwordx4 v101, s[20:23], s44 offen offset:1024 lds
    v_mfma_f32_16x16x32_bf16 v[196:199], a[12:15], a[36:39], v[196:199]
    ds_read_b64_tr_b16 a[30:31], v119 offset:9216
    v_mfma_f32_16x16x32_bf16 v[204:207], a[8:11], a[40:43], v[204:207]
L_pad0:
    s_cbranch_execz L_ret0
    buffer_load_dwordx4 v102, s[20:23], s44 offen offset:2048 lds
    v_mfma_f32_16x16x32_bf16 v[204:207], a[12:15], a[44:47], v[204:207]
    v_mfma_f32_16x16x32_bf16 v[212:215], a[8:11], a[48:51], v[212:215]
    v_mfma_f32_16x16x32_bf16 v[212:215], a[12:15], a[52:55], v[212:215]
    buffer_load_dwordx4 v103, s[20:23], s44 offen offset:3072 lds
    v_mfma_f32_16x16x32_bf16 v[220:223], a[8:11], a[56:59], v[220:223]
    v_mfma_f32_16x16x32_bf16 v[220:223], a[12:15], a[60:63], v[220:223]
    s_mov_b64 exec, 0
    s_cmp_lt_u32 s42, 2
    s_cbranch_scc1 L_h1
    s_cmp_eq_u32 s42, 2
    s_cbranch_scc1 L_pad6
    s_branch L_pad7
L_h1:
    s_cmp_eq_u32 s42, 0
    s_cbranch_scc1 L_pad4
    s_branch L_pad5
L_ret1:
    s_mov_b64 exec, -1
    s_waitcnt vmcnt(14) lgkmcnt(0)
    s_barrier
    v_mfma_f32_16x16x32_bf16 v[224:227], a[16:19], a[32:35], v[224:227]
    s_add_u32 s50, s58, 0
    ds_read_b128 a[96:99], v110 offset:0
    ds_read_b128 a[100:103], v111 offset:0
    v_mfma_f32_16x16x32_bf16 v[224:227], a[20:23], a[36:39], v[224:227]
    ds_read_b128 a[104:107], v110 offset:2048
    v_mfma_f32_16x16x32_bf16 v[232:235], a[16:19], a[40:43], v[232:235]
    ds_read_b128 a[108:111], v111 offset:2048
    v_mfma_f32_16x16x32_bf16 v[232:235], a[20:23], a[44:47], v[232:235]
    s_add_u32 m0, s57, 65536
    ds_read_b128 a[112:115], v110 offset:4096
    ds_read_b128 a[116:119], v111 offset:4096
    v_mfma_f32_16x16x32_bf16 v[240:243], a[16:19], a[48:51], v[240:243]
    ds_read_b128 a[120:123], v110 offset:6144
    v_mfma_f32_16x16x32_bf16 v[240:243], a[20:23], a[52:55], v[240:243]
    ds_read_b128 a[124:127], v111 offset:6144
    v_mfma_f32_16x16x32_bf16 v[248:251], a[16:19], a[56:59], v[248:251]
    s_and_b32 s50, s50, 0x1ffff
    ds_read_b64_tr_b16 a[0:1], v112 offset:16384
    ds_read_b64_tr_b16 a[2:3], v112 offset:17408
    v_mfma_f32_16x16x32_bf16 v[248:251], a[20:23], a[60:63], v[248:251]
    ds_read_b64_tr_b16 a[4:5], v112 offset:24576
    v_mfma_f32_16x16x32_bf16 v[228:231], a[24:27], a[32:35], v[228:231]
    ds_read_b64_tr_b16 a[6:7], v112 offset:25600
    v_mfma_f32_16x16x32_bf16 v[228:231], a[28:31], a[36:39], v[228:231]
    buffer_load_dwordx4 v22, s[32:35], s50 offen offset:0 nt lds
    v_mfma_f32_16x16x32_bf16 v[236:239], a[24:27], a[40:43], v[236:239]
    ds_read_b64_tr_b16 a[8:9], v113 offset:16384
    ds_read_b64_tr_b16 a[10:11], v113 offset:17408
    v_mfma_f32_16x16x32_bf16 v[236:239], a[28:31], a[44:47], v[236:239]
    ds_read_b64_tr_b16 a[12:13], v113 offset:24576
    v_mfma_f32_16x16x32_bf16 v[244:247], a[24:27], a[48:51], v[244:247]
    buffer_load_dwordx4 v23, s[32:35], s50 offen offset:1024 nt lds
    v_mfma_f32_16x16x32_bf16 v[244:247], a[28:31], a[52:55], v[244:247]
    ds_read_b64_tr_b16 a[14:15], v113 offset:25600
    v_mfma_f32_16x16x32_bf16 v[252:255], a[24:27], a[56:59], v[252:255]
    v_mfma_f32_16x16x32_bf16 v[252:255], a[28:31], a[60:63], v[252:255]
    s_waitcnt lgkmcnt(0)
    v_mfma_f32_16x16x32_bf16 v[32:35], a[0:3], a[96:99], v[32:35]
    s_add_u32 s49, s66, 5
    ds_read_b64_tr_b16 a[16:17], v114 offset:16384
    v_mfma_f32_16x16x32_bf16 v[32:35], a[4:7], a[100:103], v[32:35]
    s_and_b32 s49, s49, 7
    ds_read_b64_tr_b16 a[18:19], v114 offset:17408
    v_mfma_f32_16x16x32_bf16 v[40:43], a[0:3], a[104:107], v[40:43]
    ds_read_b64_tr_b16 a[20:21], v114 offset:24576
    v_mfma_f32_16x16x32_bf16 v[40:43], a[4:7], a[108:111], v[40:43]
    s_lshl_b32 s44, s49, 7
    ds_read_b64_tr_b16 a[22:23], v114 offset:25600
    v_mfma_f32_16x16x32_bf16 v[48:51], a[0:3], a[112:115], v[48:51]
    v_mfma_f32_16x16x32_bf16 v[48:51], a[4:7], a[116:119], v[48:51]
    s_add_u32 m0, s56, 81920
    ds_read_b64_tr_b16 a[24:25], v115 offset:16384
    v_mfma_f32_16x16x32_bf16 v[56:59], a[0:3], a[120:123], v[56:59]
    ds_read_b64_tr_b16 a[26:27], v115 offset:17408
    v_mfma_f32_16x16x32_bf16 v[56:59], a[4:7], a[124:127], v[56:59]
    s_lshl_b32 s45, s49, 19
    ds_read_b64_tr_b16 a[28:29], v115 offset:24576
    v_mfma_f32_16x16x32_bf16 v[36:39], a[8:11], a[96:99], v[36:39]
    buffer_load_dwordx4 v104, s[24:27], s45 offen offset:0 lds
    v_mfma_f32_16x16x32_bf16 v[36:39], a[12:15], a[100:103], v[36:39]
    ds_read_b64_tr_b16 a[30:31], v115 offset:25600
    v_mfma_f32_16x16x32_bf16 v[44:47], a[8:11], a[104:107], v[44:47]
    buffer_load_dwordx4 v105, s[24:27], s45 offen offset:1024 lds
    v_mfma_f32_16x16x32_bf16 v[44:47], a[12:15], a[108:111], v[44:47]
    v_mfma_f32_16x16x32_bf16 v[52:55], a[8:11], a[112:115], v[52:55]
    buffer_load_dwordx4 v106, s[24:27], s45 offen offset:2048 lds
    v_mfma_f32_16x16x32_bf16 v[52:55], a[12:15], a[116:119], v[52:55]
    v_mfma_f32_16x16x32_bf16 v[60:63], a[8:11], a[120:123], v[60:63]
    buffer_load_dwordx4 v107, s[24:27], s45 offen offset:3072 lds
    v_mfma_f32_16x16x32_bf16 v[60:63], a[12:15], a[124:127], v[60:63]
    s_waitcnt lgkmcnt(0)
    v_mfma_f32_16x16x32_bf16 v[64:67], a[16:19], a[96:99], v[64:67]
    s_add_u32 m0, s46, 131072
    ds_read_b64_tr_b16 a[0:1], v116 offset:16384
    v_mfma_f32_16x16x32_bf16 v[64:67], a[20:23], a[100:103], v[64:67]
    ds_read_b64_tr_b16 a[2:3], v116 offset:17408
    v_mfma_f32_16x16x32_bf16 v[72:75], a[16:19], a[104:107], v[72:75]
    s_nop 0
    ds_read_b64_tr_b16 a[4:5], v116 offset:24576
    v_mfma_f32_16x16x32_bf16 v[72:75], a[20:23], a[108:111], v[72:75]
    ds_read_b64_tr_b16 a[6:7], v116 offset:25600
    v_mfma_f32_16x16x32_bf16 v[80:83], a[16:19], a[112:115], v[80:83]
    ds_read_b64_tr_b16 a[8:9], v117 offset:16384
    v_mfma_f32_16x16x32_bf16 v[80:83], a[20:23], a[116:119], v[80:83]
    buffer_load_dwordx4 v96, s[20:23], s44 offen offset:0 lds
    v_mfma_f32_16x16x32_bf16 v[88:91], a[16:19], a[120:123], v[88:91]
    ds_read_b64_tr_b16 a[10:11], v117 offset:17408
    v_mfma_f32_16x16x32_bf16 v[88:91], a[20:23], a[124:127], v[88:91]
    ds_read_b64_tr_b16 a[12:13], v117 offset:24576
    v_mfma_f32_16x16x32_bf16 v[68:71], a[24:27], a[96:99], v[68:71]
    buffer_load_dwordx4 v97, s[20:23], s44 offen offset:1024 lds
    v_mfma_f32_16x16x32_bf16 v[68:71], a[28:31], a[100:103], v[68:71]
    ds_read_b64_tr_b16 a[14:15], v117 offset:25600
    v_mfma_f32_16x16x32_bf16 v[76:79], a[24:27], a[104:107], v[76:79]
    buffer_load_dwordx4 v98, s[20:23], s44 offen offset:2048 lds
    v_mfma_f32_16x16x32_bf16 v[76:79], a[28:31], a[108:111], v[76:79]
    v_mfma_f32_16x16x32_bf16 v[84:87], a[24:27], a[112:115], v[84:87]
    v_mfma_f32_16x16x32_bf16 v[84:87], a[28:31], a[116:119], v[84:87]
    buffer_load_dwordx4 v99, s[20:23], s44 offen offset:3072 lds
    v_mfma_f32_16x16x32_bf16 v[92:95], a[24:27], a[120:123], v[92:95]
    v_mfma_f32_16x16x32_bf16 v[92:95], a[28:31], a[124:127], v[92:95]
    s_waitcnt lgkmcnt(0)
    v_mfma_f32_16x16x32_bf16 v[192:195], a[0:3], a[96:99], v[192:195]
    s_add_u32 m0, s46, 135168
    ds_read_b64_tr_b16 a[16:17], v118 offset:16384
    v_mfma_f32_16x16x32_bf16 v[192:195], a[4:7], a[100:103], v[192:195]
    ds_read_b64_tr_b16 a[18:19], v118 offset:17408
    v_mfma_f32_16x16x32_bf16 v[200:203], a[0:3], a[104:107], v[200:203]
    s_nop 0
    ds_read_b64_tr_b16 a[20:21], v118 offset:24576
    v_mfma_f32_16x16x32_bf16 v[200:203], a[4:7], a[108:111], v[200:203]
    ds_read_b64_tr_b16 a[22:23], v118 offset:25600
    v_mfma_f32_16x16x32_bf16 v[208:211], a[0:3], a[112:115], v[208:211]
    ds_read_b64_tr_b16 a[24:25], v119 offset:16384
    v_mfma_f32_16x16x32_bf16 v[208:211], a[4:7], a[116:119], v[208:211]
    buffer_load_dwordx4 v100, s[20:23], s44 offen offset:0 lds
    v_mfma_f32_16x16x32_bf16 v[216:219], a[0:3], a[120:123], v[216:219]
    ds_read_b64_tr_b16 a[26:27], v119 offset:17408
    v_mfma_f32_16x16x32_bf16 v[216:219], a[4:7], a[124:127], v[216:219]
    ds_read_b64_tr_b16 a[28:29], v119 offset:24576
    v_mfma_f32_16x16x32_bf16 v[196:199], a[8:11], a[96:99], v[196:199]
    buffer_load_dwordx4 v101, s[20:23], s44 offen offset:1024 lds
    v_mfma_f32_16x16x32_bf16 v[196:199], a[12:15], a[100:103], v[196:199]
    ds_read_b64_tr_b16 a[30:31], v119 offset:25600
    v_mfma_f32_16x16x32_bf16 v[204:207], a[8:11], a[104:107], v[204:207]
    buffer_load_dwordx4 v102, s[20:23], s44 offen offset:2048 lds
    v_mfma_f32_16x16x32_bf16 v[204:207], a[12:15], a[108:111], v[204:207]
    v_mfma_f32_16x16x32_bf16 v[212:215], a[8:11], a[112:115], v[212:215]
    v_mfma_f32_16x16x32_bf16 v[212:215], a[12:15], a[116:119], v[212:215]
    buffer_load_dwordx4 v103, s[20:23], s44 offen offset:3072 lds
    v_mfma_f32_16x16x32_bf16 v[220:223], a[8:11], a[120:123], v[220:223]
    v_mfma_f32_16x16x32_bf16 v[220:223], a[12:15], a[124:127], v[220:223]
    s_mov_b64 exec, 0
    s_cmp_lt_u32 s42, 2
    s_cbranch_scc1 L_h2
    s_cmp_eq_u32 s42, 2
    s_cbranch_scc1 L_pad10
    s_branch L_pad11
L_h2:
    s_cmp_eq_u32 s42, 0
    s_cbranch_scc1 L_pad8
    s_branch L_pad9
L_pad10:
L_pad11:
L_ret2:
    s_mov_b64 exec, -1
    s_waitcnt vmcnt(14) lgkmcnt(0)
    s_barrier
    v_mfma_f32_16x16x32_bf16 v[224:227], a[16:19], a[96:99], v[224:227]
    s_add_u32 s50, s58, 16384
    ds_read_b128 a[32:35], v108 offset:0
    ds_read_b128 a[36:39], v109 offset:0
    v_mfma_f32_16x16x32_bf16 v[224:227], a[20:23], a[100:103], v[224:227]
    ds_read_b128 a[40:43], v108 offset:2048
    v_mfma_f32_16x16x32_bf16 v[232:235], a[16:19], a[104:107], v[232:235]
    ds_read_b128 a[44:47], v109 offset:2048
    v_mfma_f32_16x16x32_bf16 v[232:235], a[20:23], a[108:111], v[232:235]
    s_add_u32 m0, s57, 16384
    ds_read_b128 a[48:51], v108 offset:4096
    ds_read_b128 a[52:55], v109 offset:4096
    v_mfma_f32_16x16x32_bf16 v[240:243], a[16:19], a[112:115], v[240:243]
    ds_read_b128 a[56:59], v108 offset:6144
    v_mfma_f32_16x16x32_bf16 v[240:243], a[20:23], a[116:119], v[240:243]
    ds_read_b128 a[60:63], v109 offset:6144
    v_mfma_f32_16x16x32_bf16 v[248:251], a[16:19], a[120:123], v[248:251]
    s_and_b32 s50, s50, 0x1ffff
    ds_read_b64_tr_b16 a[0:1], v112 offset:32768
    ds_read_b64_tr_b16 a[2:3], v112 offset:33792
    v_mfma_f32_16x16x32_bf16 v[248:251], a[20:23], a[124:127], v[248:251]
    ds_read_b64_tr_b16 a[4:5], v112 offset:40960
    v_mfma_f32_16x16x32_bf16 v[228:231], a[24:27], a[96:99], v[228:231]
    ds_read_b64_tr_b16 a[6:7], v112 offset:41984
    v_mfma_f32_16x16x32_bf16 v[228:231], a[28:31], a[100:103], v[228:231]
    buffer_load_dwordx4 v20, s[28:31], s50 offen offset:0 nt lds
    v_mfma_f32_16x16x32_bf16 v[236:239], a[24:27], a[104:107], v[236:239]
    ds_read_b64_tr_b16 a[8:9], v113 offset:32768
    ds_read_b64_tr_b16 a[10:11], v113 offset:33792
    v_mfma_f32_16x16x32_bf16 v[236:239], a[28:31], a[108:111], v[236:239]
    ds_read_b64_tr_b16 a[12:13], v113 offset:40960
    v_mfma_f32_16x16x32_bf16 v[244:247], a[24:27], a[112:115], v[244:247]
    buffer_load_dwordx4 v21, s[28:31], s50 offen offset:1024 nt lds
    v_mfma_f32_16x16x32_bf16 v[244:247], a[28:31], a[116:119], v[244:247]
    ds_read_b64_tr_b16 a[14:15], v113 offset:41984
    v_mfma_f32_16x16x32_bf16 v[252:255], a[24:27], a[120:123], v[252:255]
    v_mfma_f32_16x16x32_bf16 v[252:255], a[28:31], a[124:127], v[252:255]
    s_waitcnt lgkmcnt(0)
    v_mfma_f32_16x16x32_bf16 v[32:35], a[0:3], a[32:35], v[32:35]
    s_add_u32 s49, s66, 6
    ds_read_b64_tr_b16 a[16:17], v114 offset:32768
    v_mfma_f32_16x16x32_bf16 v[32:35], a[4:7], a[36:39], v[32:35]
    s_and_b32 s49, s49, 7
    ds_read_b64_tr_b16 a[18:19], v114 offset:33792
    v_mfma_f32_16x16x32_bf16 v[40:43], a[0:3], a[40:43], v[40:43]
    ds_read_b64_tr_b16 a[20:21], v114 offset:40960
    v_mfma_f32_16x16x32_bf16 v[40:43], a[4:7], a[44:47], v[40:43]
    s_lshl_b32 s44, s49, 7
    ds_read_b64_tr_b16 a[22:23], v114 offset:41984
    v_mfma_f32_16x16x32_bf16 v[48:51], a[0:3], a[48:51], v[48:51]
    v_mfma_f32_16x16x32_bf16 v[48:51], a[4:7], a[52:55], v[48:51]
    s_add_u32 m0, s56, 98304
    ds_read_b64_tr_b16 a[24:25], v115 offset:32768
    v_mfma_f32_16x16x32_bf16 v[56:59], a[0:3], a[56:59], v[56:59]
    ds_read_b64_tr_b16 a[26:27], v115 offset:33792
    v_mfma_f32_16x16x32_bf16 v[56:59], a[4:7], a[60:63], v[56:59]
    s_lshl_b32 s45, s49, 19
    ds_read_b64_tr_b16 a[28:29], v115 offset:40960
    v_mfma_f32_16x16x32_bf16 v[36:39], a[8:11], a[32:35], v[36:39]
    buffer_load_dwordx4 v104, s[24:27], s45 offen offset:0 lds
    v_mfma_f32_16x16x32_bf16 v[36:39], a[12:15], a[36:39], v[36:39]
    ds_read_b64_tr_b16 a[30:31], v115 offset:41984
    v_mfma_f32_16x16x32_bf16 v[44:47], a[8:11], a[40:43], v[44:47]
    buffer_load_dwordx4 v105, s[24:27], s45 offen offset:1024 lds
    v_mfma_f32_16x16x32_bf16 v[44:47], a[12:15], a[44:47], v[44:47]
    v_mfma_f32_16x16x32_bf16 v[52:55], a[8:11], a[48:51], v[52:55]
    buffer_load_dwordx4 v106, s[24:27], s45 offen offset:2048 lds
    v_mfma_f32_16x16x32_bf16 v[52:55], a[12:15], a[52:55], v[52:55]
    v_mfma_f32_16x16x32_bf16 v[60:63], a[8:11], a[56:59], v[60:63]
    buffer_load_dwordx4 v107, s[24:27], s45 offen offset:3072 lds
    v_mfma_f32_16x16x32_bf16 v[60:63], a[12:15], a[60:63], v[60:63]
    s_waitcnt lgkmcnt(0)
    v_mfma_f32_16x16x32_bf16 v[64:67], a[16:19], a[32:35], v[64:67]
    s_add_u32 m0, s46, 32768
    ds_read_b64_tr_b16 a[0:1], v116 offset:32768
    v_mfma_f32_16x16x32_bf16 v[64:67], a[20:23], a[36:39], v[64:67]
    ds_read_b64_tr_b16 a[2:3], v116 offset:33792
    v_mfma_f32_16x16x32_bf16 v[72:75], a[16:19], a[40:43], v[72:75]
    s_nop 0
    ds_read_b64_tr_b16 a[4:5], v116 offset:40960
    v_mfma_f32_16x16x32_bf16 v[72:75], a[20:23], a[44:47], v[72:75]
    ds_read_b64_tr_b16 a[6:7], v116 offset:41984
    v_mfma_f32_16x16x32_bf16 v[80:83], a[16:19], a[48:51], v[80:83]
    ds_read_b64_tr_b16 a[8:9], v117 offset:32768
    v_mfma_f32_16x16x32_bf16 v[80:83], a[20:23], a[52:55], v[80:83]
    buffer_load_dwordx4 v96, s[20:23], s44 offen offset:0 lds
    v_mfma_f32_16x16x32_bf16 v[88:91], a[16:19], a[56:59], v[88:91]
    ds_read_b64_tr_b16 a[10:11], v117 offset:33792
    v_mfma_f32_16x16x32_bf16 v[88:91], a[20:23], a[60:63], v[88:91]
    ds_read_b64_tr_b16 a[12:13], v117 offset:40960
    v_mfma_f32_16x16x32_bf16 v[68:71], a[24:27], a[32:35], v[68:71]
    buffer_load_dwordx4 v97, s[20:23], s44 offen offset:1024 lds
    v_mfma_f32_16x16x32_bf16 v[68:71], a[28:31], a[36:39], v[68:71]
    ds_read_b64_tr_b16 a[14:15], v117 offset:41984
    v_mfma_f32_16x16x32_bf16 v[76:79], a[24:27], a[40:43], v[76:79]
    buffer_load_dwordx4 v98, s[20:23], s44 offen offset:2048 lds
    v_mfma_f32_16x16x32_bf16 v[76:79], a[28:31], a[44:47], v[76:79]
    v_mfma_f32_16x16x32_bf16 v[84:87], a[24:27], a[48:51], v[84:87]
    v_mfma_f32_16x16x32_bf16 v[84:87], a[28:31], a[52:55], v[84:87]
    buffer_load_dwordx4 v99, s[20:23], s44 offen offset:3072 lds
    v_mfma_f32_16x16x32_bf16 v[92:95], a[24:27], a[56:59], v[92:95]
    v_mfma_f32_16x16x32_bf16 v[92:95], a[28:31], a[60:63], v[92:95]
    s_waitcnt lgkmcnt(0)
    v_mfma_f32_16x16x32_bf16 v[192:195], a[0:3], a[32:35], v[192:195]
    s_add_u32 m0, s46, 36864
    ds_read_b64_tr_b16 a[16:17], v118 offset:32768
    v_mfma_f32_16x16x32_bf16 v[192:195], a[4:7], a[36:39], v[192:195]
    ds_read_b64_tr_b16 a[18:19], v118 offset:33792
    v_mfma_f32_16x16x32_bf16 v[200:203], a[0:3], a[40:43], v[200:203]
    s_nop 0
    ds_read_b64_tr_b16 a[20:21], v118 offset:40960
    v_mfma_f32_16x16x32_bf16 v[200:203], a[4:7], a[44:47], v[200:203]
    ds_read_b64_tr_b16 a[22:23], v118 offset:41984
    v_mfma_f32_16x16x32_bf16 v[208:211], a[0:3], a[48:51], v[208:211]
    ds_read_b64_tr_b16 a[24:25], v119 offset:32768
    v_mfma_f32_16x16x32_bf16 v[208:211], a[4:7], a[52:55], v[208:211]
    buffer_load_dwordx4 v100, s[20:23], s44 offen offset:0 lds
    v_mfma_f32_16x16x32_bf16 v[216:219], a[0:3], a[56:59], v[216:219]
    ds_read_b64_tr_b16 a[26:27], v119 offset:33792
    v_mfma_f32_16x16x32_bf16 v[216:219], a[4:7], a[60:63], v[216:219]
    ds_read_b64_tr_b16 a[28:29], v119 offset:40960
    v_mfma_f32_16x16x32_bf16 v[196:199], a[8:11], a[32:35], v[196:199]
    buffer_load_dwordx4 v101, s[20:23], s44 offen offset:1024 lds
    v_mfma_f32_16x16x32_bf16 v[196:199], a[12:15], a[36:39], v[196:199]
    ds_read_b64_tr_b16 a[30:31], v119 offset:41984
    v_mfma_f32_16x16x32_bf16 v[204:207], a[8:11], a[40:43], v[204:207]
    buffer_load_dwordx4 v102, s[20:23], s44 offen offset:2048 lds
    v_mfma_f32_16x16x32_bf16 v[204:207], a[12:15], a[44:47], v[204:207]
    v_mfma_f32_16x16x32_bf16 v[212:215], a[8:11], a[48:51], v[212:215]
    v_mfma_f32_16x16x32_bf16 v[212:215], a[12:15], a[52:55], v[212:215]
    buffer_load_dwordx4 v103, s[20:23], s44 offen offset:3072 lds
    v_mfma_f32_16x16x32_bf16 v[220:223], a[8:11], a[56:59], v[220:223]
    v_mfma_f32_16x16x32_bf16 v[220:223], a[12:15], a[60:63], v[220:223]
    s_waitcnt vmcnt(14) lgkmcnt(0)
    s_barrier
    v_mfma_f32_16x16x32_bf16 v[224:227], a[16:19], a[32:35], v[224:227]
    s_add_u32 s50, s58, 24576
    ds_read_b128 a[96:99], v110 offset:0
    ds_read_b128 a[100:103], v111 offset:0
    v_mfma_f32_16x16x32_bf16 v[224:227], a[20:23], a[36:39], v[224:227]
    ds_read_b128 a[104:107], v110 offset:2048
    v_mfma_f32_16x16x32_bf16 v[232:235], a[16:19], a[40:43], v[232:235]
    ds_read_b128 a[108:111], v111 offset:2048
    v_mfma_f32_16x16x32_bf16 v[232:235], a[20:23], a[44:47], v[232:235]
    s_add_u32 m0, s57, 24576
    ds_read_b128 a[112:115], v110 offset:4096
    ds_read_b128 a[116:119], v111 offset:4096
    v_mfma_f32_16x16x32_bf16 v[240:243], a[16:19], a[48:51], v[240:243]
    ds_read_b128 a[120:123], v110 offset:6144
    v_mfma_f32_16x16x32_bf16 v[240:243], a[20:23], a[52:55], v[240:243]
    ds_read_b128 a[124:127], v111 offset:6144
    v_mfma_f32_16x16x32_bf16 v[248:251], a[16:19], a[56:59], v[248:251]
    s_and_b32 s50, s50, 0x1ffff
    ds_read_b64_tr_b16 a[0:1], v112 offset:0
    ds_read_b64_tr_b16 a[2:3], v112 offset:1024
    v_mfma_f32_16x16x32_bf16 v[248:251], a[20:23], a[60:63], v[248:251]
    ds_read_b64_tr_b16 a[4:5], v112 offset:8192
    v_mfma_f32_16x16x32_bf16 v[228:231], a[24:27], a[32:35], v[228:231]
    ds_read_b64_tr_b16 a[6:7], v112 offset:9216
    v_mfma_f32_16x16x32_bf16 v[228:231], a[28:31], a[36:39], v[228:231]
    buffer_load_dwordx4 v20, s[28:31], s50 offen offset:0 nt lds
    v_mfma_f32_16x16x32_bf16 v[236:239], a[24:27], a[40:43], v[236:239]
    ds_read_b64_tr_b16 a[8:9], v113 offset:0
    ds_read_b64_tr_b16 a[10:11], v113 offset:1024
    v_mfma_f32_16x16x32_bf16 v[236:239], a[28:31], a[44:47], v[236:239]
    ds_read_b64_tr_b16 a[12:13], v113 offset:8192
    v_mfma_f32_16x16x32_bf16 v[244:247], a[24:27], a[48:51], v[244:247]
    buffer_load_dwordx4 v21, s[28:31], s50 offen offset:1024 nt lds
    v_mfma_f32_16x16x32_bf16 v[244:247], a[28:31], a[52:55], v[244:247]
    ds_read_b64_tr_b16 a[14:15], v113 offset:9216
    v_mfma_f32_16x16x32_bf16 v[252:255], a[24:27], a[56:59], v[252:255]
    v_mfma_f32_16x16x32_bf16 v[252:255], a[28:31], a[60:63], v[252:255]
    s_waitcnt lgkmcnt(0)
    v_mfma_f32_16x16x32_bf16 v[32:35], a[0:3], a[96:99], v[32:35]
    s_add_u32 s49, s66, 7
    ds_read_b64_tr_b16 a[16:17], v114 offset:0
    v_mfma_f32_16x16x32_bf16 v[32:35], a[4:7], a[100:103], v[32:35]
    s_and_b32 s49, s49, 7
    ds_read_b64_tr_b16 a[18:19], v114 offset:1024
    v_mfma_f32_16x16x32_bf16 v[40:43], a[0:3], a[104:107], v[40:43]
    ds_read_b64_tr_b16 a[20:21], v114 offset:8192
    v_mfma_f32_16x16x32_bf16 v[40:43], a[4:7], a[108:111], v[40:43]
    s_lshl_b32 s44, s49, 7
    ds_read_b64_tr_b16 a[22:23], v114 offset:9216
    v_mfma_f32_16x16x32_bf16 v[48:51], a[0:3], a[112:115], v[48:51]
    v_mfma_f32_16x16x32_bf16 v[48:51], a[4:7], a[116:119], v[48:51]
    s_add_u32 m0, s56, 114688
    ds_read_b64_tr_b16 a[24:25], v115 offset:0
    v_mfma_f32_16x16x32_bf16 v[56:59], a[0:3], a[120:123], v[56:59]
    ds_read_b64_tr_b16 a[26:27], v115 offset:1024
    v_mfma_f32_16x16x32_bf16 v[56:59], a[4:7], a[124:127], v[56:59]
    s_lshl_b32 s45, s49, 19
    ds_read_b64_tr_b16 a[28:29], v115 offset:8192
    v_mfma_f32_16x16x32_bf16 v[36:39], a[8:11], a[96:99], v[36:39]
    buffer_load_dwordx4 v104, s[24:27], s45 offen offset:0 lds
    v_mfma_f32_16x16x32_bf16 v[36:39], a[12:15], a[100:103], v[36:39]
    ds_read_b64_tr_b16 a[30:31], v115 offset:9216
    v_mfma_f32_16x16x32_bf16 v[44:47], a[8:11], a[104:107], v[44:47]
    buffer_load_dwordx4 v105, s[24:27], s45 offen offset:1024 lds
    v_mfma_f32_16x16x32_bf16 v[44:47], a[12:15], a[108:111], v[44:47]
    v_mfma_f32_16x16x32_bf16 v[52:55], a[8:11], a[112:115], v[52:55]
    buffer_load_dwordx4 v106, s[24:27], s45 offen offset:2048 lds
    v_mfma_f32_16x16x32_bf16 v[52:55], a[12:15], a[116:119], v[52:55]
    v_mfma_f32_16x16x32_bf16 v[60:63], a[8:11], a[120:123], v[60:63]
    buffer_load_dwordx4 v107, s[24:27], s45 offen offset:3072 lds
    v_mfma_f32_16x16x32_bf16 v[60:63], a[12:15], a[124:127], v[60:63]
    s_waitcnt lgkmcnt(0)
    v_mfma_f32_16x16x32_bf16 v[64:67], a[16:19], a[96:99], v[64:67]
    s_add_u32 m0, s46, 131072
    ds_read_b64_tr_b16 a[0:1], v116 offset:0
    v_mfma_f32_16x16x32_bf16 v[64:67], a[20:23], a[100:103], v[64:67]
    ds_read_b64_tr_b16 a[2:3], v116 offset:1024
    v_mfma_f32_16x16x32_bf16 v[72:75], a[16:19], a[104:107], v[72:75]
    s_nop 0
    ds_read_b64_tr_b16 a[4:5], v116 offset:8192
    v_mfma_f32_16x16x32_bf16 v[72:75], a[20:23], a[108:111], v[72:75]
    ds_read_b64_tr_b16 a[6:7], v116 offset:9216
    v_mfma_f32_16x16x32_bf16 v[80:83], a[16:19], a[112:115], v[80:83]
    ds_read_b64_tr_b16 a[8:9], v117 offset:0
    v_mfma_f32_16x16x32_bf16 v[80:83], a[20:23], a[116:119], v[80:83]
    buffer_load_dwordx4 v96, s[20:23], s44 offen offset:0 lds
    v_mfma_f32_16x16x32_bf16 v[88:91], a[16:19], a[120:123], v[88:91]
    ds_read_b64_tr_b16 a[10:11], v117 offset:1024
    v_mfma_f32_16x16x32_bf16 v[88:91], a[20:23], a[124:127], v[88:91]
    ds_read_b64_tr_b16 a[12:13], v117 offset:8192
    v_mfma_f32_16x16x32_bf16 v[68:71], a[24:27], a[96:99], v[68:71]
    buffer_load_dwordx4 v97, s[20:23], s44 offen offset:1024 lds
    v_mfma_f32_16x16x32_bf16 v[68:71], a[28:31], a[100:103], v[68:71]
    ds_read_b64_tr_b16 a[14:15], v117 offset:9216
    v_mfma_f32_16x16x32_bf16 v[76:79], a[24:27], a[104:107], v[76:79]
    buffer_load_dwordx4 v98, s[20:23], s44 offen offset:2048 lds
    v_mfma_f32_16x16x32_bf16 v[76:79], a[28:31], a[108:111], v[76:79]
    v_mfma_f32_16x16x32_bf16 v[84:87], a[24:27], a[112:115], v[84:87]
    v_mfma_f32_16x16x32_bf16 v[84:87], a[28:31], a[116:119], v[84:87]
    buffer_load_dwordx4 v99, s[20:23], s44 offen offset:3072 lds
    v_mfma_f32_16x16x32_bf16 v[92:95], a[24:27], a[120:123], v[92:95]
    v_mfma_f32_16x16x32_bf16 v[92:95], a[28:31], a[124:127], v[92:95]
    s_waitcnt lgkmcnt(0)
    v_mfma_f32_16x16x32_bf16 v[192:195], a[0:3], a[96:99], v[192:195]
    s_add_u32 m0, s46, 135168
    ds_read_b64_tr_b16 a[16:17], v118 offset:0
    v_mfma_f32_16x16x32_bf16 v[192:195], a[4:7], a[100:103], v[192:195]
    ds_read_b64_tr_b16 a[18:19], v118 offset:1024
    v_mfma_f32_16x16x32_bf16 v[200:203], a[0:3], a[104:107], v[200:203]
    s_nop 0
    ds_read_b64_tr_b16 a[20:21], v118 offset:8192
    v_mfma_f32_16x16x32_bf16 v[200:203], a[4:7], a[108:111], v[200:203]
    ds_read_b64_tr_b16 a[22:23], v118 offset:9216
    v_mfma_f32_16x16x32_bf16 v[208:211], a[0:3], a[112:115], v[208:211]
    ds_read_b64_tr_b16 a[24:25], v119 offset:0
    v_mfma_f32_16x16x32_bf16 v[208:211], a[4:7], a[116:119], v[208:211]
    buffer_load_dwordx4 v100, s[20:23], s44 offen offset:0 lds
    v_mfma_f32_16x16x32_bf16 v[216:219], a[0:3], a[120:123], v[216:219]
    ds_read_b64_tr_b16 a[26:27], v119 offset:1024
    v_mfma_f32_16x16x32_bf16 v[216:219], a[4:7], a[124:127], v[216:219]
    ds_read_b64_tr_b16 a[28:29], v119 offset:8192
    v_mfma_f32_16x16x32_bf16 v[196:199], a[8:11], a[96:99], v[196:199]
    buffer_load_dwordx4 v101, s[20:23], s44 offen offset:1024 lds
    v_mfma_f32_16x16x32_bf16 v[196:199], a[12:15], a[100:103], v[196:199]
    ds_read_b64_tr_b16 a[30:31], v119 offset:9216
    v_mfma_f32_16x16x32_bf16 v[204:207], a[8:11], a[104:107], v[204:207]
    buffer_load_dwordx4 v102, s[20:23], s44 offen offset:2048 lds
    v_mfma_f32_16x16x32_bf16 v[204:207], a[12:15], a[108:111], v[204:207]
    v_mfma_f32_16x16x32_bf16 v[212:215], a[8:11], a[112:115], v[212:215]
    v_mfma_f32_16x16x32_bf16 v[212:215], a[12:15], a[116:119], v[212:215]
    buffer_load_dwordx4 v103, s[20:23], s44 offen offset:3072 lds
    v_mfma_f32_16x16x32_bf16 v[220:223], a[8:11], a[120:123], v[220:223]
    v_mfma_f32_16x16x32_bf16 v[220:223], a[12:15], a[124:127], v[220:223]
    s_waitcnt vmcnt(14) lgkmcnt(0)
    s_barrier
    v_mfma_f32_16x16x32_bf16 v[224:227], a[16:19], a[96:99], v[224:227]
    s_add_u32 s50, s58, 8192
    ds_read_b128 a[32:35], v108 offset:0
    ds_read_b128 a[36:39], v109 offset:0
    v_mfma_f32_16x16x32_bf16 v[224:227], a[20:23], a[100:103], v[224:227]
    s_add_u32 m0, s57, 73728
    ds_read_b128 a[40:43], v108 offset:2048
    v_mfma_f32_16x16x32_bf16 v[232:235], a[16:19], a[104:107], v[232:235]
    ds_read_b128 a[44:47], v109 offset:2048
    ds_read_b128 a[48:51], v108 offset:4096
    v_mfma_f32_16x16x32_bf16 v[232:235], a[20:23], a[108:111], v[232:235]
    s_and_b32 s50, s50, 0x1ffff
    ds_read_b128 a[52:55], v109 offset:4096
    v_mfma_f32_16x16x32_bf16 v[240:243], a[16:19], a[112:115], v[240:243]
    buffer_load_dwordx4 v22, s[32:35], s50 offen offset:0 nt lds
    v_mfma_f32_16x16x32_bf16 v[240:243], a[20:23], a[116:119], v[240:243]
    ds_read_b128 a[56:59], v108 offset:6144
    ds_read_b128 a[60:63], v109 offset:6144
    v_mfma_f32_16x16x32_bf16 v[248:251], a[16:19], a[120:123], v[248:251]
    buffer_load_dwordx4 v23, s[32:35], s50 offen offset:1024 nt lds
    v_mfma_f32_16x16x32_bf16 v[248:251], a[20:23], a[124:127], v[248:251]
    ds_read_b64_tr_b16 a[0:1], v112 offset:16384
    v_mfma_f32_16x16x32_bf16 v[228:231], a[24:27], a[96:99], v[228:231]
    s_add_u32 s50, s58, 16384
    ds_read_b64_tr_b16 a[2:3], v112 offset:17408
    ds_read_b64_tr_b16 a[4:5], v112 offset:24576
    v_mfma_f32_16x16x32_bf16 v[228:231], a[28:31], a[100:103], v[228:231]
    s_add_u32 m0, s57, 81920
    ds_read_b64_tr_b16 a[6:7], v112 offset:25600
    v_mfma_f32_16x16x32_bf16 v[236:239], a[24:27], a[104:107], v[236:239]
    ds_read_b64_tr_b16 a[8:9], v113 offset:16384
    ds_read_b64_tr_b16 a[10:11], v113 offset:17408
    v_mfma_f32_16x16x32_bf16 v[236:239], a[28:31], a[108:111], v[236:239]
    s_and_b32 s50, s50, 0x1ffff
    ds_read_b64_tr_b16 a[12:13], v113 offset:24576
    v_mfma_f32_16x16x32_bf16 v[244:247], a[24:27], a[112:115], v[244:247]
    buffer_load_dwordx4 v22, s[32:35], s50 offen offset:0 nt lds
    v_mfma_f32_16x16x32_bf16 v[244:247], a[28:31], a[116:119], v[244:247]
    ds_read_b64_tr_b16 a[14:15], v113 offset:25600
    v_mfma_f32_16x16x32_bf16 v[252:255], a[24:27], a[120:123], v[252:255]
    buffer_load_dwordx4 v23, s[32:35], s50 offen offset:1024 nt lds
    v_mfma_f32_16x16x32_bf16 v[252:255], a[28:31], a[124:127], v[252:255]
    s_waitcnt lgkmcnt(0)
    v_mfma_f32_16x16x32_bf16 v[32:35], a[0:3], a[32:35], v[32:35]
    s_add_u32 s50, s58, 24576
    ds_read_b64_tr_b16 a[16:17], v114 offset:16384
    v_and_b32 v2, 15, v0
    v_mfma_f32_16x16x32_bf16 v[32:35], a[4:7], a[36:39], v[32:35]
    ds_read_b64_tr_b16 a[18:19], v114 offset:17408
    s_and_b32 s51, s2, 8
    s_lshl_b32 s51, s51, 11
    v_mfma_f32_16x16x32_bf16 v[40:43], a[0:3], a[40:43], v[40:43]
    ds_read_b64_tr_b16 a[20:21], v114 offset:24576
    v_lshl_add_u32 v31, v2, 10, s51
    v_mfma_f32_16x16x32_bf16 v[40:43], a[4:7], a[44:47], v[40:43]
    s_add_u32 m0, s57, 90112
    v_bfe_u32 v3, v0, 4, 1
    v_lshrrev_b32 v4, 5, v0
    v_lshl_add_u32 v3, v3, 1, v4
    v_mfma_f32_16x16x32_bf16 v[48:51], a[0:3], a[48:51], v[48:51]
    ds_read_b64_tr_b16 a[22:23], v114 offset:25600
    v_xor_b32 v3, v3, v2
    v_mfma_f32_16x16x32_bf16 v[48:51], a[4:7], a[52:55], v[48:51]
    ds_read_b64_tr_b16 a[24:25], v115 offset:16384
    v_lshlrev_b32 v3, 4, v3
    v_mfma_f32_16x16x32_bf16 v[56:59], a[0:3], a[56:59], v[56:59]
    s_and_b32 s50, s50, 0x1ffff
    ds_read_b64_tr_b16 a[26:27], v115 offset:17408
    v_lshl_add_u32 v8, v2, 8, v3
    v_xor_b32 v9, 64, v8
    v_mfma_f32_16x16x32_bf16 v[56:59], a[4:7], a[60:63], v[56:59]
    v_xor_b32 v10, 128, v8
    v_xor_b32 v11, 192, v8
    v_lshrrev_b32 v2, 2, v0
    v_mfma_f32_16x16x32_bf16 v[36:39], a[8:11], a[32:35], v[36:39]
    ds_read_b64_tr_b16 a[28:29], v115 offset:24576
    v_and_b32 v3, 7, v2
    v_mfma_f32_16x16x32_bf16 v[36:39], a[12:15], a[36:39], v[36:39]
    buffer_load_dwordx4 v22, s[32:35], s50 offen offset:0 nt lds
    v_mfma_f32_16x16x32_bf16 v[44:47], a[8:11], a[40:43], v[44:47]
    ds_read_b64_tr_b16 a[30:31], v115 offset:25600
    v_lshlrev_b32 v3, 5, v3
    v_mfma_f32_16x16x32_bf16 v[44:47], a[12:15], a[44:47], v[44:47]
    v_lshl_add_u32 v3, v2, 8, v3
    v_and_b32 v4, 3, v0
    v_lshl_add_u32 v3, v4, 3, v3
    v_mfma_f32_16x16x32_bf16 v[52:55], a[8:11], a[48:51], v[52:55]
    buffer_load_dwordx4 v23, s[32:35], s50 offen offset:1024 nt lds
    v_mfma_f32_16x16x32_bf16 v[52:55], a[12:15], a[52:55], v[52:55]
    v_add_u32 v12, 65536, v3
    v_xor_b32 v13, 32, v12
    v_xor_b32 v14, 64, v12
    v_mfma_f32_16x16x32_bf16 v[60:63], a[8:11], a[56:59], v[60:63]
    v_xor_b32 v15, 96, v12
    v_xor_b32 v16, 128, v12
    v_mfma_f32_16x16x32_bf16 v[60:63], a[12:15], a[60:63], v[60:63]
    v_xor_b32 v17, 160, v12
    v_xor_b32 v18, 192, v12
    v_xor_b32 v19, 224, v12
    s_waitcnt lgkmcnt(0)
    v_mfma_f32_16x16x32_bf16 v[64:67], a[16:19], a[32:35], v[64:67]
    ds_read_b64_tr_b16 a[0:1], v116 offset:16384
    v_lshrrev_b32 v2, 2, v0
    v_mfma_f32_16x16x32_bf16 v[64:67], a[20:23], a[36:39], v[64:67]
    ds_read_b64_tr_b16 a[2:3], v116 offset:17408
    v_bfe_u32 v3, v0, 3, 2
    v_xor_b32 v3, s42, v3
    v_mfma_f32_16x16x32_bf16 v[72:75], a[16:19], a[40:43], v[72:75]
    v_lshlrev_b32 v3, 5, v3
    v_lshl_add_u32 v3, v2, 7, v3
    v_mfma_f32_16x16x32_bf16 v[72:75], a[20:23], a[44:47], v[72:75]
    ds_read_b64_tr_b16 a[4:5], v116 offset:24576
    v_and_b32 v4, 3, v0
    v_mfma_f32_16x16x32_bf16 v[80:83], a[16:19], a[48:51], v[80:83]
    ds_read_b64_tr_b16 a[6:7], v116 offset:25600
    v_lshl_add_u32 v3, v4, 3, v3
    v_add_u32 v3, s56, v3
    v_mfma_f32_16x16x32_bf16 v[80:83], a[20:23], a[52:55], v[80:83]
L_pad1:
    s_cbranch_execz L_ret0
    v_add_u32 v24, 131072, v3
    v_xor_b32 v25, 32, v24
    v_mfma_f32_16x16x32_bf16 v[88:91], a[16:19], a[56:59], v[88:91]
    ds_read_b64_tr_b16 a[8:9], v117 offset:16384
    v_xor_b32 v26, 64, v24
    v_mfma_f32_16x16x32_bf16 v[88:91], a[20:23], a[60:63], v[88:91]
    ds_read_b64_tr_b16 a[10:11], v117 offset:17408
    v_xor_b32 v27, 96, v24
    v_lshrrev_b32 v2, 3, v0
    v_mfma_f32_16x16x32_bf16 v[68:71], a[24:27], a[32:35], v[68:71]
    v_and_b32 v3, 7, v0
    v_and_b32 v4, 6, v2
    v_mfma_f32_16x16x32_bf16 v[68:71], a[28:31], a[36:39], v[68:71]
    ds_read_b64_tr_b16 a[12:13], v117 offset:24576
    v_xor_b32 v3, v3, v4
    v_mfma_f32_16x16x32_bf16 v[76:79], a[24:27], a[40:43], v[76:79]
    ds_read_b64_tr_b16 a[14:15], v117 offset:25600
    v_lshlrev_b32 v3, 4, v3
    v_lshl_add_u32 v28, v2, 10, v3
    v_mfma_f32_16x16x32_bf16 v[76:79], a[28:31], a[44:47], v[76:79]
    v_add_u32 v29, 7168, v28
    v_and_b32 v2, 3, v0
    v_mfma_f32_16x16x32_bf16 v[84:87], a[24:27], a[48:51], v[84:87]
    v_mov_b32 v3, 0x3f803f80
    v_cmp_eq_u32 vcc, 0, v2
    s_nop 1
    v_mfma_f32_16x16x32_bf16 v[84:87], a[28:31], a[52:55], v[84:87]
    v_cndmask_b32 v120, 0, v3, vcc
    v_cmp_eq_u32 vcc, 1, v2
    v_mfma_f32_16x16x32_bf16 v[92:95], a[24:27], a[56:59], v[92:95]
    v_mov_b32 v121, v120
    v_mov_b64 v[122:123], v[120:121]
    v_cndmask_b32 v124, 0, v3, vcc
    v_mfma_f32_16x16x32_bf16 v[92:95], a[28:31], a[60:63], v[92:95]
    v_mov_b32 v125, v124
    v_mov_b64 v[126:127], v[124:125]
    s_waitcnt lgkmcnt(0)
    v_mfma_f32_16x16x32_bf16 v[192:195], a[0:3], a[32:35], v[192:195]
    ds_read_b64_tr_b16 a[16:17], v118 offset:16384
    s_lshl_b32 s51, s40, 3
    s_add_u32 s51, s51, s42
    v_mfma_f32_16x16x32_bf16 v[192:195], a[4:7], a[36:39], v[192:195]
    ds_read_b64_tr_b16 a[18:19], v118 offset:17408
    s_lshl_b32 s51, s51, 5
    s_add_u32 s51, s51, s41
    v_mfma_f32_16x16x32_bf16 v[200:203], a[0:3], a[40:43], v[200:203]
    s_lshl_b32 s51, s51, 13
    s_add_u32 s36, s18, s51
    s_addc_u32 s37, s19, 0
    s_mov_b32 s38, 1056768
    s_mov_b32 s39, 0x00020000
    v_mfma_f32_16x16x32_bf16 v[200:203], a[4:7], a[44:47], v[200:203]
    ds_read_b64_tr_b16 a[20:21], v118 offset:24576
    s_lshl_b32 s51, s43, 3
    s_add_u32 s51, s51, s64
    v_mfma_f32_16x16x32_bf16 v[208:211], a[0:3], a[48:51], v[208:211]
    ds_read_b64_tr_b16 a[22:23], v118 offset:25600
    s_lshl_b32 s51, s51, 2
    s_add_u32 s51, s51, s42
    v_mfma_f32_16x16x32_bf16 v[208:211], a[4:7], a[52:55], v[208:211]
    s_lshl_b32 s51, s51, 16
    s_add_u32 s72, s18, s51
    s_addc_u32 s73, s19, 0
    s_mov_b32 s74, 1114112
    s_mov_b32 s75, 0x00020000
    v_mfma_f32_16x16x32_bf16 v[216:219], a[0:3], a[56:59], v[216:219]
    ds_read_b64_tr_b16 a[24:25], v119 offset:16384
    s_mul_i32 s51, s43, 245760
    s_add_u32 s76, s14, s51
    v_mfma_f32_16x16x32_bf16 v[216:219], a[4:7], a[60:63], v[216:219]
    ds_read_b64_tr_b16 a[26:27], v119 offset:17408
    s_addc_u32 s77, s15, 0
    s_mov_b32 s78, 245760
    v_mfma_f32_16x16x32_bf16 v[196:199], a[8:11], a[32:35], v[196:199]
    s_mov_b32 s79, 0x00020000
    s_mov_b32 s80, s16
    s_mov_b32 s81, s17
    s_mov_b32 s82, 256
    s_mov_b32 s83, 0x00020000
    v_mfma_f32_16x16x32_bf16 v[196:199], a[12:15], a[36:39], v[196:199]
    ds_read_b64_tr_b16 a[28:29], v119 offset:24576
    s_mov_b32 s51, 0x1000000
    s_add_u32 s4, s18, s51
    v_mfma_f32_16x16x32_bf16 v[204:207], a[8:11], a[40:43], v[204:207]
    ds_read_b64_tr_b16 a[30:31], v119 offset:25600
    s_addc_u32 s5, s19, 0
    s_mov_b32 s6, 262144
    v_mfma_f32_16x16x32_bf16 v[204:207], a[12:15], a[44:47], v[204:207]
    s_mov_b32 s7, 0x00020000
    s_mov_b32 s94, 0x3e0293ee
    s_mov_b32 s95, 0x3e0293ee
    s_lshl_b32 s51, s42, 20
    v_mfma_f32_16x16x32_bf16 v[212:215], a[8:11], a[48:51], v[212:215]
    s_lshl_b32 s52, s65, 7
    s_add_u32 s51, s51, s52
    s_add_u32 s68, s12, s51
    s_addc_u32 s69, s13, 0
    s_mov_b32 s70, 0
    v_mfma_f32_16x16x32_bf16 v[212:215], a[12:15], a[52:55], v[212:215]
    s_mov_b32 s71, 0x00020000
    s_sub_u32 s70, 4194304, s51
    s_lshl_b32 s8, s43, 2
    s_add_u32 s8, s8, s42
    v_mfma_f32_16x16x32_bf16 v[220:223], a[8:11], a[56:59], v[220:223]
    s_mov_b32 s51, 0x7f800000
    s_cmp_eq_u32 s42, 3
    s_cselect_b32 s54, 0xff800000, s51
    s_lshl_b32 s51, s42, 20
    s_add_u32 s51, s51, 384
    v_mfma_f32_16x16x32_bf16 v[220:223], a[12:15], a[60:63], v[220:223]
    s_add_u32 s12, s12, s51
    s_addc_u32 s13, s13, 0
    s_mov_b32 s14, 1048192
    s_mov_b32 s15, 0x00020000
    s_waitcnt vmcnt(6) lgkmcnt(0)
    s_barrier
    s_or_b32 s49, s2, s42
    s_cbranch_scc1 L_notag
    s_memrealtime s[90:91]
    s_waitcnt lgkmcnt(0)
    v_or_b32 v2, 1, s90
    v_or_b32 v3, 2.0, s91
    buffer_store_dwordx2 v[2:3], off, s[80:83], 0 sc1
L_notag:
    v_mfma_f32_16x16x32_bf16 v[224:227], a[16:19], a[32:35], v[224:227]
    s_add_u32 s50, s58, 32768
    ds_read_b128 a[96:99], v110 offset:0
    ds_read_b128 a[100:103], v111 offset:0
    v_mfma_f32_16x16x32_bf16 v[224:227], a[20:23], a[36:39], v[224:227]
    ds_read_b128 a[104:107], v110 offset:2048
    v_mfma_f32_16x16x32_bf16 v[232:235], a[16:19], a[40:43], v[232:235]
    ds_read_b128 a[108:111], v111 offset:2048
    v_mfma_f32_16x16x32_bf16 v[232:235], a[20:23], a[44:47], v[232:235]
    s_add_u32 m0, s57, 32768
    ds_read_b128 a[112:115], v110 offset:4096
    ds_read_b128 a[116:119], v111 offset:4096
    v_mfma_f32_16x16x32_bf16 v[240:243], a[16:19], a[48:51], v[240:243]
    ds_read_b128 a[120:123], v110 offset:6144
    v_mfma_f32_16x16x32_bf16 v[240:243], a[20:23], a[52:55], v[240:243]
    ds_read_b128 a[124:127], v111 offset:6144
    v_mfma_f32_16x16x32_bf16 v[248:251], a[16:19], a[56:59], v[248:251]
    s_and_b32 s50, s50, 0x1ffff
    ds_read_b64_tr_b16 a[0:1], v112 offset:32768
    ds_read_b64_tr_b16 a[2:3], v112 offset:33792
    v_mfma_f32_16x16x32_bf16 v[248:251], a[20:23], a[60:63], v[248:251]
    ds_read_b64_tr_b16 a[4:5], v112 offset:40960
    v_mfma_f32_16x16x32_bf16 v[228:231], a[24:27], a[32:35], v[228:231]
    ds_read_b64_tr_b16 a[6:7], v112 offset:41984
    v_mfma_f32_16x16x32_bf16 v[228:231], a[28:31], a[36:39], v[228:231]
    buffer_load_dwordx4 v20, s[28:31], s50 offen offset:0 nt lds
    v_mfma_f32_16x16x32_bf16 v[236:239], a[24:27], a[40:43], v[236:239]
    ds_read_b64_tr_b16 a[8:9], v113 offset:32768
    ds_read_b64_tr_b16 a[10:11], v113 offset:33792
    v_mfma_f32_16x16x32_bf16 v[236:239], a[28:31], a[44:47], v[236:239]
    ds_read_b64_tr_b16 a[12:13], v113 offset:40960
    v_mfma_f32_16x16x32_bf16 v[244:247], a[24:27], a[48:51], v[244:247]
    buffer_load_dwordx4 v21, s[28:31], s50 offen offset:1024 nt lds
    v_mfma_f32_16x16x32_bf16 v[244:247], a[28:31], a[52:55], v[244:247]
    ds_read_b64_tr_b16 a[14:15], v113 offset:41984
    v_mfma_f32_16x16x32_bf16 v[252:255], a[24:27], a[56:59], v[252:255]
    v_mfma_f32_16x16x32_bf16 v[252:255], a[28:31], a[60:63], v[252:255]
    s_waitcnt lgkmcnt(0)
    v_mfma_f32_16x16x32_bf16 v[32:35], a[0:3], a[96:99], v[32:35]
    s_add_u32 s50, s58, 40960
    ds_read_b64_tr_b16 a[16:17], v114 offset:32768
    v_mfma_f32_16x16x32_bf16 v[32:35], a[4:7], a[100:103], v[32:35]
    s_add_u32 m0, s57, 40960
    ds_read_b64_tr_b16 a[18:19], v114 offset:33792
    v_mfma_f32_16x16x32_bf16 v[40:43], a[0:3], a[104:107], v[40:43]
    s_and_b32 s50, s50, 0x1ffff
    ds_read_b64_tr_b16 a[20:21], v114 offset:40960
    v_mfma_f32_16x16x32_bf16 v[40:43], a[4:7], a[108:111], v[40:43]
    ds_read_b64_tr_b16 a[22:23], v114 offset:41984
    v_mfma_f32_16x16x32_bf16 v[48:51], a[0:3], a[112:115], v[48:51]
    buffer_load_dwordx4 v20, s[28:31], s50 offen offset:0 nt lds
    v_mfma_f32_16x16x32_bf16 v[48:51], a[4:7], a[116:119], v[48:51]
    buffer_load_dwordx4 v21, s[28:31], s50 offen offset:1024 nt lds
    v_mfma_f32_16x16x32_bf16 v[56:59], a[0:3], a[120:123], v[56:59]
    v_mfma_f32_16x16x32_bf16 v[56:59], a[4:7], a[124:127], v[56:59]
    s_lshr_b32 s51, s2, 4
    ds_read_b64_tr_b16 a[24:25], v115 offset:32768
    v_mfma_f32_16x16x32_bf16 v[36:39], a[8:11], a[96:99], v[36:39]
    s_add_u32 s51, s51, s8
    ds_read_b64_tr_b16 a[26:27], v115 offset:33792
    v_mfma_f32_16x16x32_bf16 v[36:39], a[12:15], a[100:103], v[36:39]
    ds_read_b64_tr_b16 a[28:29], v115 offset:40960
    v_mfma_f32_16x16x32_bf16 v[44:47], a[8:11], a[104:107], v[44:47]
    s_add_u32 s51, s51, 0
    ds_read_b64_tr_b16 a[30:31], v115 offset:41984
    v_mfma_f32_16x16x32_bf16 v[44:47], a[12:15], a[108:111], v[44:47]
    s_and_b32 s51, s51, 31
    v_mfma_f32_16x16x32_bf16 v[52:55], a[8:11], a[112:115], v[52:55]
    v_mfma_f32_16x16x32_bf16 v[52:55], a[12:15], a[116:119], v[52:55]
    s_lshl_b32 s51, s51, 15
    v_mfma_f32_16x16x32_bf16 v[60:63], a[8:11], a[120:123], v[60:63]
    buffer_load_dword v6, v31, s[12:15], s51 offen
    v_mfma_f32_16x16x32_bf16 v[60:63], a[12:15], a[124:127], v[60:63]
    s_waitcnt lgkmcnt(0)
    v_mfma_f32_16x16x32_bf16 v[64:67], a[16:19], a[96:99], v[64:67]
    s_add_u32 s50, s58, 32768
    ds_read_b64_tr_b16 a[0:1], v116 offset:32768
    v_mfma_f32_16x16x32_bf16 v[64:67], a[20:23], a[100:103], v[64:67]
    ds_read_b64_tr_b16 a[2:3], v116 offset:33792
    v_mfma_f32_16x16x32_bf16 v[72:75], a[16:19], a[104:107], v[72:75]
    ds_read_b64_tr_b16 a[4:5], v116 offset:40960
    v_mfma_f32_16x16x32_bf16 v[72:75], a[20:23], a[108:111], v[72:75]
    s_add_u32 m0, s57, 98304
    v_mfma_f32_16x16x32_bf16 v[80:83], a[16:19], a[112:115], v[80:83]
    ds_read_b64_tr_b16 a[6:7], v116 offset:41984
    v_mfma_f32_16x16x32_bf16 v[80:83], a[20:23], a[116:119], v[80:83]
    ds_read_b64_tr_b16 a[8:9], v117 offset:32768
    v_mul_f32 v32, s94, v32
    v_mul_f32 v33, s94, v33
    v_mul_f32 v34, s94, v34
    v_mul_f32 v35, s94, v35
    v_mfma_f32_16x16x32_bf16 v[88:91], a[16:19], a[120:123], v[88:91]
    s_and_b32 s50, s50, 0x1ffff
    ds_read_b64_tr_b16 a[10:11], v117 offset:33792
    v_mul_f32 v36, s94, v36
    v_mul_f32 v37, s94, v37
    v_mul_f32 v38, s94, v38
    v_mul_f32 v39, s94, v39
    v_mfma_f32_16x16x32_bf16 v[88:91], a[20:23], a[124:127], v[88:91]
    v_cvt_pk_bf16_f32 v128, v32, v33
    v_cvt_pk_bf16_f32 v130, v36, v37
    v_cvt_pk_bf16_f32 v129, v34, v35
    v_cvt_pk_bf16_f32 v131, v38, v39
    v_mul_f32 v40, s94, v40
    v_mul_f32 v41, s94, v41
    v_mul_f32 v42, s94, v42
    v_mul_f32 v43, s94, v43
    v_mfma_f32_16x16x32_bf16 v[68:71], a[24:27], a[96:99], v[68:71]
    ds_read_b64_tr_b16 a[12:13], v117 offset:40960
    v_mul_f32 v44, s94, v44
    v_mul_f32 v45, s94, v45
    v_mul_f32 v46, s94, v46
    v_mul_f32 v47, s94, v47
    v_mfma_f32_16x16x32_bf16 v[68:71], a[28:31], a[100:103], v[68:71]
    buffer_load_dwordx4 v22, s[32:35], s50 offen offset:0 nt lds
    v_mfma_f32_16x16x32_bf16 v[76:79], a[24:27], a[104:107], v[76:79]
    ds_read_b64_tr_b16 a[14:15], v117 offset:41984
    v_cvt_pk_bf16_f32 v144, v40, v41
    v_cvt_pk_bf16_f32 v146, v44, v45
    v_cvt_pk_bf16_f32 v145, v42, v43
    v_cvt_pk_bf16_f32 v147, v46, v47
    v_mfma_f32_16x16x32_bf16 v[76:79], a[28:31], a[108:111], v[76:79]
    v_permlane16_swap_b32 v128, v130
    v_permlane16_swap_b32 v129, v131
    v_mul_f32 v48, s94, v48
    v_mul_f32 v49, s94, v49
    v_mul_f32 v50, s94, v50
    v_mul_f32 v51, s94, v51
    v_mul_f32 v52, s94, v52
    v_mul_f32 v53, s94, v53
    v_mul_f32 v54, s94, v54
    v_mfma_f32_16x16x32_bf16 v[84:87], a[24:27], a[112:115], v[84:87]
    buffer_load_dwordx4 v23, s[32:35], s50 offen offset:1024 nt lds
    v_mfma_f32_16x16x32_bf16 v[84:87], a[28:31], a[116:119], v[84:87]
    v_mul_f32 v55, s94, v55
    v_cvt_pk_bf16_f32 v160, v48, v49
    v_cvt_pk_bf16_f32 v162, v52, v53
    v_cvt_pk_bf16_f32 v161, v50, v51
    v_cvt_pk_bf16_f32 v163, v54, v55
    v_permlane16_swap_b32 v144, v146
    v_permlane16_swap_b32 v145, v147
    v_mul_f32 v56, s94, v56
    v_mfma_f32_16x16x32_bf16 v[92:95], a[24:27], a[120:123], v[92:95]
    v_mul_f32 v57, s94, v57
    v_mul_f32 v58, s94, v58
    v_mul_f32 v59, s94, v59
    v_mul_f32 v60, s94, v60
    v_mul_f32 v61, s94, v61
    v_mul_f32 v62, s94, v62
    v_mul_f32 v63, s94, v63
    v_cvt_pk_bf16_f32 v176, v56, v57
    v_mfma_f32_16x16x32_bf16 v[92:95], a[28:31], a[124:127], v[92:95]
    v_cvt_pk_bf16_f32 v178, v60, v61
    v_cvt_pk_bf16_f32 v177, v58, v59
    v_cvt_pk_bf16_f32 v179, v62, v63
    v_permlane16_swap_b32 v160, v162
    v_permlane16_swap_b32 v161, v163
    s_nop 0
    v_permlane16_swap_b32 v176, v178
    v_permlane16_swap_b32 v177, v179
    s_waitcnt lgkmcnt(0)
    v_mfma_f32_16x16x32_bf16 v[192:195], a[0:3], a[96:99], v[192:195]
    ds_read_b64_tr_b16 a[16:17], v118 offset:32768
    v_mfma_f32_16x16x32_bf16 v[192:195], a[4:7], a[100:103], v[192:195]
    ds_read_b64_tr_b16 a[18:19], v118 offset:33792
    v_mfma_f32_16x16x32_bf16 v[200:203], a[0:3], a[104:107], v[200:203]
    v_mfma_f32_16x16x32_bf16 v[200:203], a[4:7], a[108:111], v[200:203]
    ds_read_b64_tr_b16 a[20:21], v118 offset:40960
    v_mfma_f32_16x16x32_bf16 v[208:211], a[0:3], a[112:115], v[208:211]
    ds_read_b64_tr_b16 a[22:23], v118 offset:41984
    v_mul_f32 v64, s94, v64
    v_mul_f32 v65, s94, v65
    v_mul_f32 v66, s94, v66
    v_mfma_f32_16x16x32_bf16 v[208:211], a[4:7], a[116:119], v[208:211]
    v_mul_f32 v67, s94, v67
    v_mul_f32 v68, s94, v68
    v_mul_f32 v69, s94, v69
    v_mul_f32 v70, s94, v70
    v_mul_f32 v71, s94, v71
    v_cvt_pk_bf16_f32 v132, v64, v65
    v_mfma_f32_16x16x32_bf16 v[216:219], a[0:3], a[120:123], v[216:219]
    ds_read_b64_tr_b16 a[24:25], v119 offset:32768
    v_cvt_pk_bf16_f32 v134, v68, v69
    v_cvt_pk_bf16_f32 v133, v66, v67
    v_cvt_pk_bf16_f32 v135, v70, v71
    v_mfma_f32_16x16x32_bf16 v[216:219], a[4:7], a[124:127], v[216:219]
    ds_read_b64_tr_b16 a[26:27], v119 offset:33792
    v_mul_f32 v72, s94, v72
    v_mul_f32 v73, s94, v73
    v_mul_f32 v74, s94, v74
    v_mfma_f32_16x16x32_bf16 v[196:199], a[8:11], a[96:99], v[196:199]
    v_mul_f32 v75, s94, v75
    v_mul_f32 v76, s94, v76
    v_mul_f32 v77, s94, v77
    v_mul_f32 v78, s94, v78
    v_mul_f32 v79, s94, v79
    v_cvt_pk_bf16_f32 v148, v72, v73
    v_mfma_f32_16x16x32_bf16 v[196:199], a[12:15], a[100:103], v[196:199]
    ds_read_b64_tr_b16 a[28:29], v119 offset:40960
    v_cvt_pk_bf16_f32 v150, v76, v77
    v_cvt_pk_bf16_f32 v149, v74, v75
    v_cvt_pk_bf16_f32 v151, v78, v79
    v_mfma_f32_16x16x32_bf16 v[204:207], a[8:11], a[104:107], v[204:207]
    ds_read_b64_tr_b16 a[30:31], v119 offset:41984
    v_permlane16_swap_b32 v132, v134
    v_permlane16_swap_b32 v133, v135
    v_mul_f32 v80, s94, v80
    v_mfma_f32_16x16x32_bf16 v[204:207], a[12:15], a[108:111], v[204:207]
    v_mul_f32 v81, s94, v81
    v_mul_f32 v82, s94, v82
    v_mul_f32 v83, s94, v83
    v_mul_f32 v84, s94, v84
    v_mul_f32 v85, s94, v85
    v_mul_f32 v86, s94, v86
    v_mfma_f32_16x16x32_bf16 v[212:215], a[8:11], a[112:115], v[212:215]
    v_mul_f32 v87, s94, v87
    v_cvt_pk_bf16_f32 v164, v80, v81
    v_cvt_pk_bf16_f32 v166, v84, v85
    v_cvt_pk_bf16_f32 v165, v82, v83
    v_cvt_pk_bf16_f32 v167, v86, v87
    v_permlane16_swap_b32 v148, v150
    v_mfma_f32_16x16x32_bf16 v[212:215], a[12:15], a[116:119], v[212:215]
    v_permlane16_swap_b32 v149, v151
    v_mul_f32 v88, s94, v88
    v_mul_f32 v89, s94, v89
    v_mul_f32 v90, s94, v90
    v_mul_f32 v91, s94, v91
    v_mul_f32 v92, s94, v92
    v_mfma_f32_16x16x32_bf16 v[220:223], a[8:11], a[120:123], v[220:223]
    v_mul_f32 v93, s94, v93
    v_mul_f32 v94, s94, v94
    v_mul_f32 v95, s94, v95
    v_cvt_pk_bf16_f32 v180, v88, v89
    v_cvt_pk_bf16_f32 v182, v92, v93
    v_cvt_pk_bf16_f32 v181, v90, v91
    v_mfma_f32_16x16x32_bf16 v[220:223], a[12:15], a[124:127], v[220:223]
    v_cvt_pk_bf16_f32 v183, v94, v95
    v_permlane16_swap_b32 v164, v166
    v_permlane16_swap_b32 v165, v167
    s_nop 0
    v_permlane16_swap_b32 v180, v182
    v_permlane16_swap_b32 v181, v183
    s_waitcnt lgkmcnt(0)
    s_barrier
    v_mfma_f32_16x16x32_bf16 v[224:227], a[16:19], a[96:99], v[224:227]
    ds_read_b128 a[64:67], v8 offset:0
    v_mfma_f32_16x16x32_bf16 v[224:227], a[20:23], a[100:103], v[224:227]
    ds_read_b128 a[68:71], v9 offset:0
    v_mfma_f32_16x16x32_bf16 v[232:235], a[16:19], a[104:107], v[232:235]
    v_mfma_f32_16x16x32_bf16 v[232:235], a[20:23], a[108:111], v[232:235]
    ds_read_b128 a[72:75], v10 offset:0
    v_mfma_f32_16x16x32_bf16 v[240:243], a[16:19], a[112:115], v[240:243]
    ds_read_b128 a[76:79], v11 offset:0
    v_mul_f32 v192, s94, v192
    v_mul_f32 v193, s94, v193
    v_mul_f32 v194, s94, v194
    v_mfma_f32_16x16x32_bf16 v[240:243], a[20:23], a[116:119], v[240:243]
    v_mul_f32 v195, s94, v195
    v_mul_f32 v196, s94, v196
    v_mul_f32 v197, s94, v197
    v_mul_f32 v198, s94, v198
    v_mul_f32 v199, s94, v199
    v_cvt_pk_bf16_f32 v136, v192, v193
    v_mfma_f32_16x16x32_bf16 v[248:251], a[16:19], a[120:123], v[248:251]
    ds_read_b128 a[80:83], v8 offset:4096
    v_cvt_pk_bf16_f32 v138, v196, v197
    v_cvt_pk_bf16_f32 v137, v194, v195
    v_cvt_pk_bf16_f32 v139, v198, v199
    v_mfma_f32_16x16x32_bf16 v[248:251], a[20:23], a[124:127], v[248:251]
    ds_read_b128 a[84:87], v9 offset:4096
    v_mul_f32 v200, s94, v200
    v_mul_f32 v201, s94, v201
    v_mul_f32 v202, s94, v202
    v_mfma_f32_16x16x32_bf16 v[228:231], a[24:27], a[96:99], v[228:231]
    v_mul_f32 v203, s94, v203
    v_mul_f32 v204, s94, v204
    v_mul_f32 v205, s94, v205
    v_mul_f32 v206, s94, v206
    v_mul_f32 v207, s94, v207
    v_cvt_pk_bf16_f32 v152, v200, v201
    v_mfma_f32_16x16x32_bf16 v[228:231], a[28:31], a[100:103], v[228:231]
    ds_read_b128 a[88:91], v10 offset:4096
    v_cvt_pk_bf16_f32 v154, v204, v205
    v_cvt_pk_bf16_f32 v153, v202, v203
    v_cvt_pk_bf16_f32 v155, v206, v207
    v_mfma_f32_16x16x32_bf16 v[236:239], a[24:27], a[104:107], v[236:239]
    ds_read_b128 a[92:95], v11 offset:4096
    v_permlane16_swap_b32 v136, v138
    v_permlane16_swap_b32 v137, v139
    v_mul_f32 v208, s94, v208
    v_mfma_f32_16x16x32_bf16 v[236:239], a[28:31], a[108:111], v[236:239]
    v_mul_f32 v209, s94, v209
    v_mul_f32 v210, s94, v210
    v_mul_f32 v211, s94, v211
    v_mul_f32 v212, s94, v212
    v_mul_f32 v213, s94, v213
    v_mul_f32 v214, s94, v214
    v_mfma_f32_16x16x32_bf16 v[244:247], a[24:27], a[112:115], v[244:247]
    v_mul_f32 v215, s94, v215
    v_cvt_pk_bf16_f32 v168, v208, v209
    v_cvt_pk_bf16_f32 v170, v212, v213
    v_cvt_pk_bf16_f32 v169, v210, v211
    v_cvt_pk_bf16_f32 v171, v214, v215
    v_permlane16_swap_b32 v152, v154
    v_mfma_f32_16x16x32_bf16 v[244:247], a[28:31], a[116:119], v[244:247]
    v_permlane16_swap_b32 v153, v155
    v_mul_f32 v216, s94, v216
    v_mul_f32 v217, s94, v217
    v_mul_f32 v218, s94, v218
    v_mul_f32 v219, s94, v219
    v_mul_f32 v220, s94, v220
    v_mfma_f32_16x16x32_bf16 v[252:255], a[24:27], a[120:123], v[252:255]
    v_mul_f32 v221, s94, v221
    v_mul_f32 v222, s94, v222
    v_mul_f32 v223, s94, v223
    v_cvt_pk_bf16_f32 v184, v216, v217
    v_cvt_pk_bf16_f32 v186, v220, v221
    v_cvt_pk_bf16_f32 v185, v218, v219
    v_mfma_f32_16x16x32_bf16 v[252:255], a[28:31], a[124:127], v[252:255]
    v_cvt_pk_bf16_f32 v187, v222, v223
    v_permlane16_swap_b32 v168, v170
    v_permlane16_swap_b32 v169, v171
    s_nop 0
    v_permlane16_swap_b32 v184, v186
    v_permlane16_swap_b32 v185, v187
    ds_read_b128 a[96:99], v8 offset:8192
    ds_read_b128 a[100:103], v9 offset:8192
    ds_read_b128 a[104:107], v10 offset:8192
    ds_read_b128 a[108:111], v11 offset:8192
    ds_read_b128 a[112:115], v8 offset:12288
    ds_read_b128 a[116:119], v9 offset:12288
    ds_read_b128 a[120:123], v10 offset:12288
    ds_read_b128 a[124:127], v11 offset:12288
    s_nop 1
    v_mul_f32 v224, s94, v224
    v_mul_f32 v225, s94, v225
    v_mul_f32 v226, s94, v226
    v_mul_f32 v227, s94, v227
    v_mul_f32 v228, s94, v228
    v_mul_f32 v229, s94, v229
    v_mul_f32 v230, s94, v230
    v_mul_f32 v231, s94, v231
    v_cvt_pk_bf16_f32 v140, v224, v225
    v_cvt_pk_bf16_f32 v142, v228, v229
    v_cvt_pk_bf16_f32 v141, v226, v227
    v_cvt_pk_bf16_f32 v143, v230, v231
    v_mul_f32 v232, s94, v232
    v_mul_f32 v233, s94, v233
    v_mul_f32 v234, s94, v234
    v_mul_f32 v235, s94, v235
    v_mul_f32 v236, s94, v236
    v_mul_f32 v237, s94, v237
    v_mul_f32 v238, s94, v238
    v_mul_f32 v239, s94, v239
    v_cvt_pk_bf16_f32 v156, v232, v233
    v_cvt_pk_bf16_f32 v158, v236, v237
    v_cvt_pk_bf16_f32 v157, v234, v235
    v_cvt_pk_bf16_f32 v159, v238, v239
    v_permlane16_swap_b32 v140, v142
    v_permlane16_swap_b32 v141, v143
    s_waitcnt lgkmcnt(8)
    s_nop 0
    v_mfma_f32_16x16x32_bf16 v[32:35], a[64:67], v[128:131], 0
    v_mul_f32 v240, s94, v240
    v_mul_f32 v241, s94, v241
    v_mfma_f32_16x16x32_bf16 v[32:35], a[68:71], v[132:135], v[32:35]
    v_mul_f32 v242, s94, v242
    v_mul_f32 v243, s94, v243
    v_mfma_f32_16x16x32_bf16 v[32:35], a[72:75], v[136:139], v[32:35]
    v_mul_f32 v244, s94, v244
    v_mul_f32 v245, s94, v245
    v_mfma_f32_16x16x32_bf16 v[32:35], a[76:79], v[140:143], v[32:35]
    v_mul_f32 v246, s94, v246
    v_mul_f32 v247, s94, v247
    v_mfma_f32_16x16x32_bf16 v[36:39], a[80:83], v[128:131], 0
    v_cvt_pk_bf16_f32 v172, v240, v241
    v_cvt_pk_bf16_f32 v174, v244, v245
    v_mfma_f32_16x16x32_bf16 v[36:39], a[84:87], v[132:135], v[36:39]
    v_cvt_pk_bf16_f32 v173, v242, v243
    v_cvt_pk_bf16_f32 v175, v246, v247
    v_mfma_f32_16x16x32_bf16 v[36:39], a[88:91], v[136:139], v[36:39]
    v_permlane16_swap_b32 v156, v158
    v_permlane16_swap_b32 v157, v159
    v_mfma_f32_16x16x32_bf16 v[36:39], a[92:95], v[140:143], v[36:39]
    s_nop 1
    v_mfma_f32_16x16x32_bf16 v[40:43], a[64:67], v[144:147], 0
    v_mul_f32 v248, s94, v248
    v_mul_f32 v249, s94, v249
    v_mfma_f32_16x16x32_bf16 v[40:43], a[68:71], v[148:151], v[40:43]
    v_mul_f32 v250, s94, v250
    v_mul_f32 v251, s94, v251
    v_mul_f32 v252, s94, v252
    v_mfma_f32_16x16x32_bf16 v[40:43], a[72:75], v[152:155], v[40:43]
    v_mul_f32 v253, s94, v253
    v_mul_f32 v254, s94, v254
    v_mfma_f32_16x16x32_bf16 v[40:43], a[76:79], v[156:159], v[40:43]
    v_mul_f32 v255, s94, v255
    v_cvt_pk_bf16_f32 v188, v248, v249
    v_cvt_pk_bf16_f32 v190, v252, v253
    v_mfma_f32_16x16x32_bf16 v[44:47], a[80:83], v[144:147], 0
    v_cvt_pk_bf16_f32 v189, v250, v251
    v_cvt_pk_bf16_f32 v191, v254, v255
    v_mfma_f32_16x16x32_bf16 v[44:47], a[84:87], v[148:151], v[44:47]
    v_permlane16_swap_b32 v172, v174
    v_permlane16_swap_b32 v173, v175
    s_nop 0
    v_mfma_f32_16x16x32_bf16 v[44:47], a[88:91], v[152:155], v[44:47]
    v_permlane16_swap_b32 v188, v190
    v_permlane16_swap_b32 v189, v191
    v_mfma_f32_16x16x32_bf16 v[44:47], a[92:95], v[156:159], v[44:47]
    s_nop 1
    v_mfma_f32_16x16x32_bf16 v[48:51], a[64:67], v[160:163], 0
    s_add_u32 s50, s58, 49152
    v_mfma_f32_16x16x32_bf16 v[48:51], a[68:71], v[164:167], v[48:51]
    s_add_u32 m0, s57, 49152
    v_mfma_f32_16x16x32_bf16 v[48:51], a[72:75], v[168:171], v[48:51]
    s_and_b32 s50, s50, 0x1ffff
    v_max3_f32 v1, v32, v33, v34
    v_max3_f32 v1, v1, v35, v36
    v_max3_f32 v1, v1, v37, v38
    v_mfma_f32_16x16x32_bf16 v[48:51], a[76:79], v[172:175], v[48:51]
    buffer_load_dwordx4 v20, s[28:31], s50 offen offset:0 nt lds
    v_mfma_f32_16x16x32_bf16 v[52:55], a[80:83], v[160:163], 0
    buffer_load_dwordx4 v21, s[28:31], s50 offen offset:1024 nt lds
    v_mfma_f32_16x16x32_bf16 v[52:55], a[84:87], v[164:167], v[52:55]
    v_max_f32 v1, v1, v39
    v_max3_f32 v2, v40, v41, v42
    v_mfma_f32_16x16x32_bf16 v[52:55], a[88:91], v[168:171], v[52:55]
    s_add_u32 s50, s58, 57344
    v_max3_f32 v2, v2, v43, v44
    v_max3_f32 v2, v2, v45, v46
    v_max_f32 v2, v2, v47
    v_mfma_f32_16x16x32_bf16 v[52:55], a[92:95], v[172:175], v[52:55]
    s_add_u32 m0, s57, 57344
    v_mov_b32 v3, v1
    v_mov_b32 v4, v2
    v_mfma_f32_16x16x32_bf16 v[56:59], a[64:67], v[176:179], 0
    s_and_b32 s50, s50, 0x1ffff
    s_nop 0
    v_permlane16_swap_b32 v1, v3
    v_permlane16_swap_b32 v2, v4
    v_mfma_f32_16x16x32_bf16 v[56:59], a[68:71], v[180:183], v[56:59]
    buffer_load_dwordx4 v20, s[28:31], s50 offen offset:0 nt lds
    v_mfma_f32_16x16x32_bf16 v[56:59], a[72:75], v[184:187], v[56:59]
    buffer_load_dwordx4 v21, s[28:31], s50 offen offset:1024 nt lds
    v_mfma_f32_16x16x32_bf16 v[56:59], a[76:79], v[188:191], v[56:59]
    v_max_f32 v1, v1, v3
    v_max_f32 v2, v2, v4
    v_mov_b32 v3, v1
    v_mfma_f32_16x16x32_bf16 v[60:63], a[80:83], v[176:179], 0
    v_mov_b32 v4, v2
    s_nop 0
    v_mfma_f32_16x16x32_bf16 v[60:63], a[84:87], v[180:183], v[60:63]
    v_permlane32_swap_b32 v1, v3
    v_permlane32_swap_b32 v2, v4
    v_min_f32 v96, -v1, -v3
    v_mfma_f32_16x16x32_bf16 v[60:63], a[88:91], v[184:187], v[60:63]
    v_min_f32 v100, -v2, -v4
    v_mov_b32 v97, v96
    v_mfma_f32_16x16x32_bf16 v[60:63], a[92:95], v[188:191], v[60:63]
    v_mov_b32 v101, v100
    v_mov_b64 v[98:99], v[96:97]
    v_mov_b64 v[102:103], v[100:101]
    s_waitcnt lgkmcnt(0)
    s_nop 0
    v_mfma_f32_16x16x32_bf16 v[64:67], a[96:99], v[128:131], v[96:99]
    ds_read_b64_tr_b16 a[64:65], v12 offset:0
    v_add_f32 v32, v32, v96
    v_add_f32 v33, v33, v96
    v_add_f32 v34, v34, v96
    v_exp_f32 v32, v32
    v_mfma_f32_16x16x32_bf16 v[64:67], a[100:103], v[132:135], v[64:67]
    ds_read_b64_tr_b16 a[66:67], v12 offset:4096
    v_add_f32 v35, v35, v96
    v_mfma_f32_16x16x32_bf16 v[64:67], a[104:107], v[136:139], v[64:67]
    ds_read_b64_tr_b16 a[68:69], v13 offset:0
    v_exp_f32 v33, v33
    v_add_f32 v36, v36, v96
    v_exp_f32 v34, v34
    v_mfma_f32_16x16x32_bf16 v[64:67], a[108:111], v[140:143], v[64:67]
    ds_read_b64_tr_b16 a[70:71], v13 offset:4096
    v_max3_f32 v1, v48, v49, v50
    v_max3_f32 v1, v1, v51, v52
    v_mfma_f32_16x16x32_bf16 v[68:71], a[112:115], v[128:131], v[96:99]
    ds_read_b64_tr_b16 a[72:73], v14 offset:0
    v_max3_f32 v1, v1, v53, v54
    v_max_f32 v1, v1, v55
    v_max3_f32 v2, v56, v57, v58
    v_mfma_f32_16x16x32_bf16 v[68:71], a[116:119], v[132:135], v[68:71]
    ds_read_b64_tr_b16 a[74:75], v14 offset:4096
    v_max3_f32 v2, v2, v59, v60
    v_max3_f32 v2, v2, v61, v62
    v_max_f32 v2, v2, v63
    v_mov_b32 v3, v1
    v_mfma_f32_16x16x32_bf16 v[68:71], a[120:123], v[136:139], v[68:71]
    ds_read_b64_tr_b16 a[76:77], v15 offset:0
    v_mov_b32 v4, v2
    s_nop 0
    v_mfma_f32_16x16x32_bf16 v[68:71], a[124:127], v[140:143], v[68:71]
    ds_read_b64_tr_b16 a[78:79], v15 offset:4096
    v_permlane16_swap_b32 v1, v3
    v_permlane16_swap_b32 v2, v4
    v_max_f32 v1, v1, v3
    v_max_f32 v2, v2, v4
    v_mov_b32 v3, v1
    v_mfma_f32_16x16x32_bf16 v[72:75], a[96:99], v[144:147], v[100:103]
    ds_read_b64_tr_b16 a[80:81], v16 offset:0
    v_mov_b32 v4, v2
    s_nop 0
    v_mfma_f32_16x16x32_bf16 v[72:75], a[100:103], v[148:151], v[72:75]
    ds_read_b64_tr_b16 a[82:83], v16 offset:4096
    v_permlane32_swap_b32 v1, v3
    v_permlane32_swap_b32 v2, v4
    v_mfma_f32_16x16x32_bf16 v[72:75], a[104:107], v[152:155], v[72:75]
    ds_read_b64_tr_b16 a[84:85], v17 offset:0
    v_min_f32 v104, -v1, -v3
    v_min_f32 v108, -v2, -v4
    v_min_f32 v108, s54, v108
    v_mov_b32 v105, v104
    v_mov_b32 v109, v108
    v_mfma_f32_16x16x32_bf16 v[72:75], a[108:111], v[156:159], v[72:75]
    ds_read_b64_tr_b16 a[86:87], v17 offset:4096
    v_mov_b64 v[106:107], v[104:105]
    v_mov_b64 v[110:111], v[108:109]
    v_mfma_f32_16x16x32_bf16 v[76:79], a[112:115], v[144:147], v[100:103]
    ds_read_b64_tr_b16 a[88:89], v18 offset:0
    v_add_f32 v37, v37, v96
    v_cvt_pk_bf16_f32 v32, v32, v33
    v_exp_f32 v35, v35
    v_mfma_f32_16x16x32_bf16 v[76:79], a[116:119], v[148:151], v[76:79]
L_pad2:
    s_cbranch_execz L_ret0
    ds_read_b64_tr_b16 a[90:91], v18 offset:4096
    v_add_f32 v38, v38, v96
    v_exp_f32 v36, v36
    v_mfma_f32_16x16x32_bf16 v[76:79], a[120:123], v[152:155], v[76:79]
    ds_read_b64_tr_b16 a[92:93], v19 offset:0
    v_add_f32 v39, v39, v96
    v_cvt_pk_bf16_f32 v33, v34, v35
    v_mfma_f32_16x16x32_bf16 v[76:79], a[124:127], v[156:159], v[76:79]
    ds_read_b64_tr_b16 a[94:95], v19 offset:4096
    v_exp_f32 v37, v37
    v_mfma_f32_16x16x32_bf16 v[80:83], a[96:99], v[160:163], v[104:107]
    s_add_u32 s50, s58, 40960
    v_add_f32 v40, v40, v100
    v_exp_f32 v38, v38
    v_add_f32 v41, v41, v100
    v_cvt_pk_bf16_f32 v34, v36, v37
    v_exp_f32 v39, v39
    v_mfma_f32_16x16x32_bf16 v[80:83], a[100:103], v[164:167], v[80:83]
    v_add_f32 v42, v42, v100
    v_exp_f32 v40, v40
    v_add_f32 v43, v43, v100
    v_cvt_pk_bf16_f32 v35, v38, v39
    v_exp_f32 v41, v41
    v_mfma_f32_16x16x32_bf16 v[80:83], a[104:107], v[168:171], v[80:83]
    s_add_u32 m0, s57, 106496
    v_add_f32 v44, v44, v100
    v_exp_f32 v42, v42
    v_add_f32 v45, v45, v100
    v_cvt_pk_bf16_f32 v40, v40, v41
    v_mfma_f32_16x16x32_bf16 v[80:83], a[108:111], v[172:175], v[80:83]
    v_exp_f32 v43, v43
    v_add_f32 v46, v46, v100
    v_exp_f32 v44, v44
    v_add_f32 v47, v47, v100
    v_cvt_pk_bf16_f32 v41, v42, v43
    v_mfma_f32_16x16x32_bf16 v[84:87], a[112:115], v[160:163], v[104:107]
    s_and_b32 s50, s50, 0x1ffff
    v_exp_f32 v45, v45
    v_exp_f32 v46, v46
    v_cvt_pk_bf16_f32 v42, v44, v45
    v_exp_f32 v47, v47
    v_mfma_f32_16x16x32_bf16 v[84:87], a[116:119], v[164:167], v[84:87]
    s_nop 0
    v_cvt_pk_bf16_f32 v43, v46, v47
    v_add_f32 v48, v48, v104
    v_add_f32 v49, v49, v104
    v_add_f32 v50, v50, v104
    v_exp_f32 v48, v48
    v_mfma_f32_16x16x32_bf16 v[84:87], a[120:123], v[168:171], v[84:87]
    v_add_f32 v51, v51, v104
    v_exp_f32 v49, v49
    v_add_f32 v52, v52, v104
    v_exp_f32 v50, v50
    v_mfma_f32_16x16x32_bf16 v[84:87], a[124:127], v[172:175], v[84:87]
    buffer_load_dwordx4 v22, s[32:35], s50 offen offset:0 nt lds
    v_mfma_f32_16x16x32_bf16 v[88:91], a[96:99], v[176:179], v[108:111]
    v_add_f32 v53, v53, v104
    v_cvt_pk_bf16_f32 v48, v48, v49
    v_exp_f32 v51, v51
    v_add_f32 v54, v54, v104
    v_exp_f32 v52, v52
    v_mfma_f32_16x16x32_bf16 v[88:91], a[100:103], v[180:183], v[88:91]
    buffer_load_dwordx4 v23, s[32:35], s50 offen offset:1024 nt lds
    v_mfma_f32_16x16x32_bf16 v[88:91], a[104:107], v[184:187], v[88:91]
    v_add_f32 v55, v55, v104
    v_cvt_pk_bf16_f32 v49, v50, v51
    v_exp_f32 v53, v53
    v_add_f32 v56, v56, v108
    v_exp_f32 v54, v54
    v_mfma_f32_16x16x32_bf16 v[88:91], a[108:111], v[188:191], v[88:91]
    v_add_f32 v57, v57, v108
    v_cvt_pk_bf16_f32 v50, v52, v53
    v_exp_f32 v55, v55
    v_add_f32 v58, v58, v108
    v_mfma_f32_16x16x32_bf16 v[92:95], a[112:115], v[176:179], v[108:111]
    v_exp_f32 v56, v56
    v_add_f32 v59, v59, v108
    v_cvt_pk_bf16_f32 v51, v54, v55
    v_exp_f32 v57, v57
    v_add_f32 v60, v60, v108
    v_mfma_f32_16x16x32_bf16 v[92:95], a[116:119], v[180:183], v[92:95]
    v_exp_f32 v58, v58
    v_add_f32 v61, v61, v108
    v_cvt_pk_bf16_f32 v56, v56, v57
    v_exp_f32 v59, v59
    v_add_f32 v62, v62, v108
    v_mfma_f32_16x16x32_bf16 v[92:95], a[120:123], v[184:187], v[92:95]
    v_exp_f32 v60, v60
    v_add_f32 v63, v63, v108
    v_cvt_pk_bf16_f32 v57, v58, v59
    v_exp_f32 v61, v61
    v_mfma_f32_16x16x32_bf16 v[92:95], a[124:127], v[188:191], v[92:95]
    v_exp_f32 v62, v62
    v_cvt_pk_bf16_f32 v58, v60, v61
    v_exp_f32 v63, v63
    s_nop 0
    v_cvt_pk_bf16_f32 v59, v62, v63
    s_waitcnt vmcnt(15) lgkmcnt(0)
    s_barrier
    v_mfma_f32_16x16x32_bf16 v[112:115], v[120:123], v[32:35], 0
    ds_read_b128 a[96:99], v8 offset:16384
    v_mfma_f32_16x16x32_bf16 a[0:3], a[64:67], v[32:35], 0
    s_add_u32 s50, s58, 49152
    v_exp_f32 v64, v64
    v_mfma_f32_16x16x32_bf16 a[4:7], a[68:71], v[32:35], 0
    v_exp_f32 v65, v65
    v_mfma_f32_16x16x32_bf16 a[8:11], a[72:75], v[32:35], 0
    ds_read_b128 a[100:103], v9 offset:16384
    v_mfma_f32_16x16x32_bf16 a[12:15], a[76:79], v[32:35], 0
    s_add_u32 m0, s57, 114688
    v_exp_f32 v66, v66
    v_mfma_f32_16x16x32_bf16 a[16:19], a[80:83], v[32:35], 0
    v_exp_f32 v67, v67
    v_mfma_f32_16x16x32_bf16 a[20:23], a[84:87], v[32:35], 0
    ds_read_b128 a[104:107], v10 offset:16384
    v_cvt_pk_bf16_f32 v64, v64, v65
    v_mfma_f32_16x16x32_bf16 a[24:27], a[88:91], v[32:35], 0
    s_and_b32 s50, s50, 0x1ffff
    v_exp_f32 v68, v68
    v_mfma_f32_16x16x32_bf16 a[28:31], a[92:95], v[32:35], 0
    v_exp_f32 v69, v69
    v_mfma_f32_16x16x32_bf16 v[112:115], v[124:127], v[40:43], v[112:115]
    v_exp_f32 v70, v70
    v_mfma_f32_16x16x32_bf16 a[32:35], a[64:67], v[40:43], 0
    buffer_load_dwordx4 v22, s[32:35], s50 offen offset:0 nt lds
    v_mfma_f32_16x16x32_bf16 a[36:39], a[68:71], v[40:43], 0
    ds_read_b128 a[108:111], v11 offset:16384
    v_cvt_pk_bf16_f32 v65, v66, v67
    v_mfma_f32_16x16x32_bf16 a[40:43], a[72:75], v[40:43], 0
    v_exp_f32 v71, v71
    v_mfma_f32_16x16x32_bf16 a[44:47], a[76:79], v[40:43], 0
    v_exp_f32 v72, v72
    v_mfma_f32_16x16x32_bf16 a[48:51], a[80:83], v[40:43], 0
    buffer_load_dwordx4 v23, s[32:35], s50 offen offset:1024 nt lds
    v_mfma_f32_16x16x32_bf16 a[52:55], a[84:87], v[40:43], 0
    ds_read_b128 a[112:115], v8 offset:20480
    v_mfma_f32_16x16x32_bf16 a[56:59], a[88:91], v[40:43], 0
    v_exp_f32 v73, v73
    v_mfma_f32_16x16x32_bf16 a[60:63], a[92:95], v[40:43], 0
    s_add_u32 s50, s58, 57344
    v_exp_f32 v74, v74
    v_mfma_f32_16x16x32_bf16 v[116:119], v[120:123], v[48:51], 0
    ds_read_b128 a[116:119], v9 offset:20480
    v_cvt_pk_bf16_f32 v66, v68, v69
    v_mfma_f32_16x16x32_bf16 v[192:195], a[64:67], v[48:51], 0
    v_mfma_f32_16x16x32_bf16 v[196:199], a[68:71], v[48:51], 0
    s_add_u32 m0, s57, 122880
    v_exp_f32 v75, v75
    v_mfma_f32_16x16x32_bf16 v[200:203], a[72:75], v[48:51], 0
    v_exp_f32 v76, v76
    v_mfma_f32_16x16x32_bf16 v[204:207], a[76:79], v[48:51], 0
    ds_read_b128 a[120:123], v10 offset:20480
    v_cvt_pk_bf16_f32 v67, v70, v71
    v_mfma_f32_16x16x32_bf16 v[208:211], a[80:83], v[48:51], 0
    v_exp_f32 v77, v77
    v_mfma_f32_16x16x32_bf16 v[212:215], a[84:87], v[48:51], 0
    s_and_b32 s50, s50, 0x1ffff
    v_exp_f32 v78, v78
    v_mfma_f32_16x16x32_bf16 v[216:219], a[88:91], v[48:51], 0
    ds_read_b128 a[124:127], v11 offset:20480
    v_cvt_pk_bf16_f32 v72, v72, v73
    v_mfma_f32_16x16x32_bf16 v[220:223], a[92:95], v[48:51], 0
    v_cvt_pk_bf16_f32 v73, v74, v75
    v_mfma_f32_16x16x32_bf16 v[116:119], v[124:127], v[56:59], v[116:119]
    buffer_load_dwordx4 v22, s[32:35], s50 offen offset:0 nt lds
    v_mfma_f32_16x16x32_bf16 v[224:227], a[64:67], v[56:59], 0
    v_cvt_pk_bf16_f32 v74, v76, v77
    v_mfma_f32_16x16x32_bf16 v[228:231], a[68:71], v[56:59], 0
    v_exp_f32 v79, v79
    v_mfma_f32_16x16x32_bf16 v[232:235], a[72:75], v[56:59], 0
    buffer_load_dwordx4 v23, s[32:35], s50 offen offset:1024 nt lds
    v_mfma_f32_16x16x32_bf16 v[236:239], a[76:79], v[56:59], 0
    v_exp_f32 v80, v80
    v_mfma_f32_16x16x32_bf16 v[240:243], a[80:83], v[56:59], 0
    v_exp_f32 v81, v81
    v_mfma_f32_16x16x32_bf16 v[244:247], a[84:87], v[56:59], 0
    v_exp_f32 v82, v82
    v_mfma_f32_16x16x32_bf16 v[248:251], a[88:91], v[56:59], 0
    v_exp_f32 v83, v83
    v_mfma_f32_16x16x32_bf16 v[252:255], a[92:95], v[56:59], 0
    s_waitcnt lgkmcnt(0)
    v_exp_f32 v84, v84
    v_mfma_f32_16x16x32_bf16 v[32:35], a[96:99], v[128:131], v[96:99]
    ds_read_b64_tr_b16 a[64:65], v12 offset:8192
    v_mfma_f32_16x16x32_bf16 v[32:35], a[100:103], v[132:135], v[32:35]
    ds_read_b64_tr_b16 a[66:67], v12 offset:12288
    v_cvt_pk_bf16_f32 v75, v78, v79
    v_mfma_f32_16x16x32_bf16 v[32:35], a[104:107], v[136:139], v[32:35]
    v_exp_f32 v85, v85
    v_mfma_f32_16x16x32_bf16 v[32:35], a[108:111], v[140:143], v[32:35]
    ds_read_b64_tr_b16 a[68:69], v13 offset:8192
    v_cvt_pk_bf16_f32 v80, v80, v81
    v_mfma_f32_16x16x32_bf16 v[36:39], a[112:115], v[128:131], v[96:99]
    ds_read_b64_tr_b16 a[70:71], v13 offset:12288
    v_cvt_pk_bf16_f32 v81, v82, v83
    v_mfma_f32_16x16x32_bf16 v[36:39], a[116:119], v[132:135], v[36:39]
    v_mfma_f32_16x16x32_bf16 v[36:39], a[120:123], v[136:139], v[36:39]
    ds_read_b64_tr_b16 a[72:73], v14 offset:8192
    v_mfma_f32_16x16x32_bf16 v[36:39], a[124:127], v[140:143], v[36:39]
    v_exp_f32 v86, v86
    v_mfma_f32_16x16x32_bf16 v[40:43], a[96:99], v[144:147], v[100:103]
    ds_read_b64_tr_b16 a[74:75], v14 offset:12288
    v_cvt_pk_bf16_f32 v82, v84, v85
    v_mfma_f32_16x16x32_bf16 v[40:43], a[100:103], v[148:151], v[40:43]
    ds_read_b64_tr_b16 a[76:77], v15 offset:8192
    v_mfma_f32_16x16x32_bf16 v[40:43], a[104:107], v[152:155], v[40:43]
    v_exp_f32 v87, v87
    v_mfma_f32_16x16x32_bf16 v[40:43], a[108:111], v[156:159], v[40:43]
    ds_read_b64_tr_b16 a[78:79], v15 offset:12288
    v_mfma_f32_16x16x32_bf16 v[44:47], a[112:115], v[144:147], v[100:103]
    v_exp_f32 v88, v88
    v_mfma_f32_16x16x32_bf16 v[44:47], a[116:119], v[148:151], v[44:47]
    ds_read_b64_tr_b16 a[80:81], v16 offset:8192
    v_cvt_pk_bf16_f32 v83, v86, v87
    v_mfma_f32_16x16x32_bf16 v[44:47], a[120:123], v[152:155], v[44:47]
    ds_read_b64_tr_b16 a[82:83], v16 offset:12288
    v_mfma_f32_16x16x32_bf16 v[44:47], a[124:127], v[156:159], v[44:47]
    v_exp_f32 v89, v89
    v_mfma_f32_16x16x32_bf16 v[48:51], a[96:99], v[160:163], v[104:107]
    ds_read_b64_tr_b16 a[84:85], v17 offset:8192
    v_mfma_f32_16x16x32_bf16 v[48:51], a[100:103], v[164:167], v[48:51]
    ds_read_b64_tr_b16 a[86:87], v17 offset:12288
    v_mfma_f32_16x16x32_bf16 v[48:51], a[104:107], v[168:171], v[48:51]
    v_exp_f32 v90, v90
    v_mfma_f32_16x16x32_bf16 v[48:51], a[108:111], v[172:175], v[48:51]
    ds_read_b64_tr_b16 a[88:89], v18 offset:8192
    v_cvt_pk_bf16_f32 v88, v88, v89
    v_mfma_f32_16x16x32_bf16 v[52:55], a[112:115], v[160:163], v[104:107]
    v_exp_f32 v91, v91
    v_mfma_f32_16x16x32_bf16 v[52:55], a[116:119], v[164:167], v[52:55]
    ds_read_b64_tr_b16 a[90:91], v18 offset:12288
    v_mfma_f32_16x16x32_bf16 v[52:55], a[120:123], v[168:171], v[52:55]
    ds_read_b64_tr_b16 a[92:93], v19 offset:8192
    v_mfma_f32_16x16x32_bf16 v[52:55], a[124:127], v[172:175], v[52:55]
    v_exp_f32 v92, v92
    v_mfma_f32_16x16x32_bf16 v[56:59], a[96:99], v[176:179], v[108:111]
    ds_read_b64_tr_b16 a[94:95], v19 offset:12288
    v_cvt_pk_bf16_f32 v89, v90, v91
    v_mfma_f32_16x16x32_bf16 v[56:59], a[100:103], v[180:183], v[56:59]
    v_exp_f32 v93, v93
    v_mfma_f32_16x16x32_bf16 v[56:59], a[104:107], v[184:187], v[56:59]
    v_exp_f32 v94, v94
    v_mfma_f32_16x16x32_bf16 v[56:59], a[108:111], v[188:191], v[56:59]
    v_cvt_pk_bf16_f32 v90, v92, v93
    v_mfma_f32_16x16x32_bf16 v[60:63], a[112:115], v[176:179], v[108:111]
    v_exp_f32 v95, v95
    v_mfma_f32_16x16x32_bf16 v[60:63], a[116:119], v[180:183], v[60:63]
    s_nop 0
    v_cvt_pk_bf16_f32 v91, v94, v95
    v_mfma_f32_16x16x32_bf16 v[60:63], a[120:123], v[184:187], v[60:63]
    v_mfma_f32_16x16x32_bf16 v[60:63], a[124:127], v[188:191], v[60:63]
    s_waitcnt lgkmcnt(0)
    v_mfma_f32_16x16x32_bf16 v[112:115], v[120:123], v[64:67], v[112:115]
    ds_read_b128 a[96:99], v8 offset:24576
    v_mfma_f32_16x16x32_bf16 a[0:3], a[64:67], v[64:67], a[0:3]
    s_add_u32 s50, s58, 65536
    v_exp_f32 v32, v32
    v_mfma_f32_16x16x32_bf16 a[4:7], a[68:71], v[64:67], a[4:7]
    v_exp_f32 v33, v33
    v_mfma_f32_16x16x32_bf16 a[8:11], a[72:75], v[64:67], a[8:11]
    ds_read_b128 a[100:103], v9 offset:24576
    v_mfma_f32_16x16x32_bf16 a[12:15], a[76:79], v[64:67], a[12:15]
    s_add_u32 m0, s57, 0
    v_exp_f32 v34, v34
    v_mfma_f32_16x16x32_bf16 a[16:19], a[80:83], v[64:67], a[16:19]
    v_exp_f32 v35, v35
    v_mfma_f32_16x16x32_bf16 a[20:23], a[84:87], v[64:67], a[20:23]
    ds_read_b128 a[104:107], v10 offset:24576
    v_cvt_pk_bf16_f32 v32, v32, v33
    v_mfma_f32_16x16x32_bf16 a[24:27], a[88:91], v[64:67], a[24:27]
    s_and_b32 s50, s50, 0x1ffff
    v_exp_f32 v36, v36
    v_mfma_f32_16x16x32_bf16 a[28:31], a[92:95], v[64:67], a[28:31]
    v_exp_f32 v37, v37
    v_mfma_f32_16x16x32_bf16 v[112:115], v[124:127], v[72:75], v[112:115]
    v_exp_f32 v38, v38
    v_mfma_f32_16x16x32_bf16 a[32:35], a[64:67], v[72:75], a[32:35]
    buffer_load_dwordx4 v20, s[28:31], s50 offen offset:0 nt lds
    v_mfma_f32_16x16x32_bf16 a[36:39], a[68:71], v[72:75], a[36:39]
    ds_read_b128 a[108:111], v11 offset:24576
    v_cvt_pk_bf16_f32 v33, v34, v35
    v_mfma_f32_16x16x32_bf16 a[40:43], a[72:75], v[72:75], a[40:43]
    v_exp_f32 v39, v39
    v_mfma_f32_16x16x32_bf16 a[44:47], a[76:79], v[72:75], a[44:47]
    v_exp_f32 v40, v40
    v_mfma_f32_16x16x32_bf16 a[48:51], a[80:83], v[72:75], a[48:51]
    buffer_load_dwordx4 v21, s[28:31], s50 offen offset:1024 nt lds
    v_mfma_f32_16x16x32_bf16 a[52:55], a[84:87], v[72:75], a[52:55]
    ds_read_b128 a[112:115], v8 offset:28672
    v_mfma_f32_16x16x32_bf16 a[56:59], a[88:91], v[72:75], a[56:59]
    v_exp_f32 v41, v41
    v_mfma_f32_16x16x32_bf16 a[60:63], a[92:95], v[72:75], a[60:63]
    s_add_u32 s50, s58, 73728
    v_exp_f32 v42, v42
    v_mfma_f32_16x16x32_bf16 v[116:119], v[120:123], v[80:83], v[116:119]
    ds_read_b128 a[116:119], v9 offset:28672
    v_cvt_pk_bf16_f32 v34, v36, v37
    v_mfma_f32_16x16x32_bf16 v[192:195], a[64:67], v[80:83], v[192:195]
    v_mfma_f32_16x16x32_bf16 v[196:199], a[68:71], v[80:83], v[196:199]
    s_add_u32 m0, s57, 8192
    v_exp_f32 v43, v43
    v_mfma_f32_16x16x32_bf16 v[200:203], a[72:75], v[80:83], v[200:203]
    v_exp_f32 v44, v44
    v_mfma_f32_16x16x32_bf16 v[204:207], a[76:79], v[80:83], v[204:207]
    ds_read_b128 a[120:123], v10 offset:28672
    v_cvt_pk_bf16_f32 v35, v38, v39
    v_mfma_f32_16x16x32_bf16 v[208:211], a[80:83], v[80:83], v[208:211]
    v_exp_f32 v45, v45
    v_mfma_f32_16x16x32_bf16 v[212:215], a[84:87], v[80:83], v[212:215]
    s_and_b32 s50, s50, 0x1ffff
    v_exp_f32 v46, v46
    v_mfma_f32_16x16x32_bf16 v[216:219], a[88:91], v[80:83], v[216:219]
    ds_read_b128 a[124:127], v11 offset:28672
    v_cvt_pk_bf16_f32 v40, v40, v41
    v_mfma_f32_16x16x32_bf16 v[220:223], a[92:95], v[80:83], v[220:223]
    v_cvt_pk_bf16_f32 v41, v42, v43
    v_mfma_f32_16x16x32_bf16 v[116:119], v[124:127], v[88:91], v[116:119]
    buffer_load_dwordx4 v20, s[28:31], s50 offen offset:0 nt lds
    v_mfma_f32_16x16x32_bf16 v[224:227], a[64:67], v[88:91], v[224:227]
    v_cvt_pk_bf16_f32 v42, v44, v45
    v_mfma_f32_16x16x32_bf16 v[228:231], a[68:71], v[88:91], v[228:231]
    v_exp_f32 v47, v47
    v_mfma_f32_16x16x32_bf16 v[232:235], a[72:75], v[88:91], v[232:235]
    buffer_load_dwordx4 v21, s[28:31], s50 offen offset:1024 nt lds
    v_mfma_f32_16x16x32_bf16 v[236:239], a[76:79], v[88:91], v[236:239]
    v_exp_f32 v48, v48
    v_mfma_f32_16x16x32_bf16 v[240:243], a[80:83], v[88:91], v[240:243]
    v_exp_f32 v49, v49
    v_mfma_f32_16x16x32_bf16 v[244:247], a[84:87], v[88:91], v[244:247]
    v_exp_f32 v50, v50
    v_mfma_f32_16x16x32_bf16 v[248:251], a[88:91], v[88:91], v[248:251]
    v_exp_f32 v51, v51
    v_mfma_f32_16x16x32_bf16 v[252:255], a[92:95], v[88:91], v[252:255]
    s_waitcnt lgkmcnt(0)
    v_exp_f32 v52, v52
    v_mfma_f32_16x16x32_bf16 v[64:67], a[96:99], v[128:131], v[96:99]
    ds_read_b64_tr_b16 a[64:65], v12 offset:16384
    v_mfma_f32_16x16x32_bf16 v[64:67], a[100:103], v[132:135], v[64:67]
    ds_read_b64_tr_b16 a[66:67], v12 offset:20480
    v_cvt_pk_bf16_f32 v43, v46, v47
    v_mfma_f32_16x16x32_bf16 v[64:67], a[104:107], v[136:139], v[64:67]
    v_exp_f32 v53, v53
    v_mfma_f32_16x16x32_bf16 v[64:67], a[108:111], v[140:143], v[64:67]
    ds_read_b64_tr_b16 a[68:69], v13 offset:16384
    v_cvt_pk_bf16_f32 v48, v48, v49
    v_mfma_f32_16x16x32_bf16 v[68:71], a[112:115], v[128:131], v[96:99]
    ds_read_b64_tr_b16 a[70:71], v13 offset:20480
    v_cvt_pk_bf16_f32 v49, v50, v51
    v_mfma_f32_16x16x32_bf16 v[68:71], a[116:119], v[132:135], v[68:71]
    v_mfma_f32_16x16x32_bf16 v[68:71], a[120:123], v[136:139], v[68:71]
    ds_read_b64_tr_b16 a[72:73], v14 offset:16384
    v_mfma_f32_16x16x32_bf16 v[68:71], a[124:127], v[140:143], v[68:71]
    v_exp_f32 v54, v54
    v_mfma_f32_16x16x32_bf16 v[72:75], a[96:99], v[144:147], v[100:103]
    ds_read_b64_tr_b16 a[74:75], v14 offset:20480
    v_cvt_pk_bf16_f32 v50, v52, v53
    v_mfma_f32_16x16x32_bf16 v[72:75], a[100:103], v[148:151], v[72:75]
    ds_read_b64_tr_b16 a[76:77], v15 offset:16384
    v_mfma_f32_16x16x32_bf16 v[72:75], a[104:107], v[152:155], v[72:75]
    v_exp_f32 v55, v55
    v_mfma_f32_16x16x32_bf16 v[72:75], a[108:111], v[156:159], v[72:75]
    ds_read_b64_tr_b16 a[78:79], v15 offset:20480
    v_mfma_f32_16x16x32_bf16 v[76:79], a[112:115], v[144:147], v[100:103]
    v_exp_f32 v56, v56
    v_mfma_f32_16x16x32_bf16 v[76:79], a[116:119], v[148:151], v[76:79]
    ds_read_b64_tr_b16 a[80:81], v16 offset:16384
    v_cvt_pk_bf16_f32 v51, v54, v55
    v_mfma_f32_16x16x32_bf16 v[76:79], a[120:123], v[152:155], v[76:79]
    ds_read_b64_tr_b16 a[82:83], v16 offset:20480
    v_mfma_f32_16x16x32_bf16 v[76:79], a[124:127], v[156:159], v[76:79]
    v_exp_f32 v57, v57
    v_mfma_f32_16x16x32_bf16 v[80:83], a[96:99], v[160:163], v[104:107]
    ds_read_b64_tr_b16 a[84:85], v17 offset:16384
    v_mfma_f32_16x16x32_bf16 v[80:83], a[100:103], v[164:167], v[80:83]
    ds_read_b64_tr_b16 a[86:87], v17 offset:20480
    v_mfma_f32_16x16x32_bf16 v[80:83], a[104:107], v[168:171], v[80:83]
    v_exp_f32 v58, v58
    v_mfma_f32_16x16x32_bf16 v[80:83], a[108:111], v[172:175], v[80:83]
    ds_read_b64_tr_b16 a[88:89], v18 offset:16384
    v_cvt_pk_bf16_f32 v56, v56, v57
    v_mfma_f32_16x16x32_bf16 v[84:87], a[112:115], v[160:163], v[104:107]
    v_exp_f32 v59, v59
    v_mfma_f32_16x16x32_bf16 v[84:87], a[116:119], v[164:167], v[84:87]
    ds_read_b64_tr_b16 a[90:91], v18 offset:20480
    v_mfma_f32_16x16x32_bf16 v[84:87], a[120:123], v[168:171], v[84:87]
    ds_read_b64_tr_b16 a[92:93], v19 offset:16384
    v_mfma_f32_16x16x32_bf16 v[84:87], a[124:127], v[172:175], v[84:87]
    v_exp_f32 v60, v60
    v_mfma_f32_16x16x32_bf16 v[88:91], a[96:99], v[176:179], v[108:111]
    ds_read_b64_tr_b16 a[94:95], v19 offset:20480
    v_cvt_pk_bf16_f32 v57, v58, v59
    v_mfma_f32_16x16x32_bf16 v[88:91], a[100:103], v[180:183], v[88:91]
    v_exp_f32 v61, v61
    v_mfma_f32_16x16x32_bf16 v[88:91], a[104:107], v[184:187], v[88:91]
    v_exp_f32 v62, v62
    v_mfma_f32_16x16x32_bf16 v[88:91], a[108:111], v[188:191], v[88:91]
    v_cvt_pk_bf16_f32 v58, v60, v61
    v_mfma_f32_16x16x32_bf16 v[92:95], a[112:115], v[176:179], v[108:111]
    v_exp_f32 v63, v63
    v_mfma_f32_16x16x32_bf16 v[92:95], a[116:119], v[180:183], v[92:95]
    s_nop 0
    v_cvt_pk_bf16_f32 v59, v62, v63
    v_mfma_f32_16x16x32_bf16 v[92:95], a[120:123], v[184:187], v[92:95]
    v_mfma_f32_16x16x32_bf16 v[92:95], a[124:127], v[188:191], v[92:95]
    s_waitcnt vmcnt(14) lgkmcnt(0)
    s_barrier
    v_mfma_f32_16x16x32_bf16 v[112:115], v[120:123], v[32:35], v[112:115]
    ds_read_b128 a[96:99], v8 offset:32768
    v_mfma_f32_16x16x32_bf16 a[0:3], a[64:67], v[32:35], a[0:3]
    s_add_u32 s50, s58, 65536
    v_exp_f32 v64, v64
    v_mfma_f32_16x16x32_bf16 a[4:7], a[68:71], v[32:35], a[4:7]
    v_exp_f32 v65, v65
    v_mfma_f32_16x16x32_bf16 a[8:11], a[72:75], v[32:35], a[8:11]
    ds_read_b128 a[100:103], v9 offset:32768
    v_mfma_f32_16x16x32_bf16 a[12:15], a[76:79], v[32:35], a[12:15]
    s_add_u32 m0, s57, 65536
    v_exp_f32 v66, v66
    v_mfma_f32_16x16x32_bf16 a[16:19], a[80:83], v[32:35], a[16:19]
    v_exp_f32 v67, v67
    v_mfma_f32_16x16x32_bf16 a[20:23], a[84:87], v[32:35], a[20:23]
    ds_read_b128 a[104:107], v10 offset:32768
    v_cvt_pk_bf16_f32 v64, v64, v65
    v_mfma_f32_16x16x32_bf16 a[24:27], a[88:91], v[32:35], a[24:27]
    s_and_b32 s50, s50, 0x1ffff
    v_exp_f32 v68, v68
    v_mfma_f32_16x16x32_bf16 a[28:31], a[92:95], v[32:35], a[28:31]
    v_exp_f32 v69, v69
    v_mfma_f32_16x16x32_bf16 v[112:115], v[124:127], v[40:43], v[112:115]
    v_exp_f32 v70, v70
    v_mfma_f32_16x16x32_bf16 a[32:35], a[64:67], v[40:43], a[32:35]
    buffer_load_dwordx4 v22, s[32:35], s50 offen offset:0 nt lds
    v_mfma_f32_16x16x32_bf16 a[36:39], a[68:71], v[40:43], a[36:39]
    ds_read_b128 a[108:111], v11 offset:32768
    v_cvt_pk_bf16_f32 v65, v66, v67
    v_mfma_f32_16x16x32_bf16 a[40:43], a[72:75], v[40:43], a[40:43]
    v_exp_f32 v71, v71
    v_mfma_f32_16x16x32_bf16 a[44:47], a[76:79], v[40:43], a[44:47]
    v_exp_f32 v72, v72
    v_mfma_f32_16x16x32_bf16 a[48:51], a[80:83], v[40:43], a[48:51]
    buffer_load_dwordx4 v23, s[32:35], s50 offen offset:1024 nt lds
    v_mfma_f32_16x16x32_bf16 a[52:55], a[84:87], v[40:43], a[52:55]
    ds_read_b128 a[112:115], v8 offset:36864
    v_mfma_f32_16x16x32_bf16 a[56:59], a[88:91], v[40:43], a[56:59]
    v_exp_f32 v73, v73
    v_mfma_f32_16x16x32_bf16 a[60:63], a[92:95], v[40:43], a[60:63]
    s_add_u32 s50, s58, 81920
    v_exp_f32 v74, v74
    v_mfma_f32_16x16x32_bf16 v[116:119], v[120:123], v[48:51], v[116:119]
    ds_read_b128 a[116:119], v9 offset:36864
    v_cvt_pk_bf16_f32 v66, v68, v69
    v_mfma_f32_16x16x32_bf16 v[192:195], a[64:67], v[48:51], v[192:195]
    v_mfma_f32_16x16x32_bf16 v[196:199], a[68:71], v[48:51], v[196:199]
    s_add_u32 m0, s57, 16384
    v_exp_f32 v75, v75
    v_mfma_f32_16x16x32_bf16 v[200:203], a[72:75], v[48:51], v[200:203]
    v_exp_f32 v76, v76
    v_mfma_f32_16x16x32_bf16 v[204:207], a[76:79], v[48:51], v[204:207]
    ds_read_b128 a[120:123], v10 offset:36864
    v_cvt_pk_bf16_f32 v67, v70, v71
    v_mfma_f32_16x16x32_bf16 v[208:211], a[80:83], v[48:51], v[208:211]
    v_exp_f32 v77, v77
    v_mfma_f32_16x16x32_bf16 v[212:215], a[84:87], v[48:51], v[212:215]
    s_and_b32 s50, s50, 0x1ffff
    v_exp_f32 v78, v78
    v_mfma_f32_16x16x32_bf16 v[216:219], a[88:91], v[48:51], v[216:219]
    ds_read_b128 a[124:127], v11 offset:36864
    v_cvt_pk_bf16_f32 v72, v72, v73
    v_mfma_f32_16x16x32_bf16 v[220:223], a[92:95], v[48:51], v[220:223]
    v_cvt_pk_bf16_f32 v73, v74, v75
    v_mfma_f32_16x16x32_bf16 v[116:119], v[124:127], v[56:59], v[116:119]
    buffer_load_dwordx4 v20, s[28:31], s50 offen offset:0 nt lds
    v_mfma_f32_16x16x32_bf16 v[224:227], a[64:67], v[56:59], v[224:227]
    v_cvt_pk_bf16_f32 v74, v76, v77
    v_mfma_f32_16x16x32_bf16 v[228:231], a[68:71], v[56:59], v[228:231]
    v_exp_f32 v79, v79
    v_mfma_f32_16x16x32_bf16 v[232:235], a[72:75], v[56:59], v[232:235]
    buffer_load_dwordx4 v21, s[28:31], s50 offen offset:1024 nt lds
    v_mfma_f32_16x16x32_bf16 v[236:239], a[76:79], v[56:59], v[236:239]
    v_exp_f32 v80, v80
    v_mfma_f32_16x16x32_bf16 v[240:243], a[80:83], v[56:59], v[240:243]
    v_exp_f32 v81, v81
    v_mfma_f32_16x16x32_bf16 v[244:247], a[84:87], v[56:59], v[244:247]
    v_exp_f32 v82, v82
    v_mfma_f32_16x16x32_bf16 v[248:251], a[88:91], v[56:59], v[248:251]
    v_exp_f32 v83, v83
    v_mfma_f32_16x16x32_bf16 v[252:255], a[92:95], v[56:59], v[252:255]
    s_waitcnt lgkmcnt(0)
    v_exp_f32 v84, v84
    v_mfma_f32_16x16x32_bf16 v[32:35], a[96:99], v[128:131], v[96:99]
    ds_read_b64_tr_b16 a[64:65], v12 offset:24576
    v_mfma_f32_16x16x32_bf16 v[32:35], a[100:103], v[132:135], v[32:35]
    ds_read_b64_tr_b16 a[66:67], v12 offset:28672
    v_cvt_pk_bf16_f32 v75, v78, v79
    v_mfma_f32_16x16x32_bf16 v[32:35], a[104:107], v[136:139], v[32:35]
    v_exp_f32 v85, v85
    v_mfma_f32_16x16x32_bf16 v[32:35], a[108:111], v[140:143], v[32:35]
    ds_read_b64_tr_b16 a[68:69], v13 offset:24576
    v_cvt_pk_bf16_f32 v80, v80, v81
    v_mfma_f32_16x16x32_bf16 v[36:39], a[112:115], v[128:131], v[96:99]
    ds_read_b64_tr_b16 a[70:71], v13 offset:28672
    v_cvt_pk_bf16_f32 v81, v82, v83
    v_mfma_f32_16x16x32_bf16 v[36:39], a[116:119], v[132:135], v[36:39]
    v_mfma_f32_16x16x32_bf16 v[36:39], a[120:123], v[136:139], v[36:39]
    ds_read_b64_tr_b16 a[72:73], v14 offset:24576
    v_mfma_f32_16x16x32_bf16 v[36:39], a[124:127], v[140:143], v[36:39]
    v_exp_f32 v86, v86
    v_mfma_f32_16x16x32_bf16 v[40:43], a[96:99], v[144:147], v[100:103]
    ds_read_b64_tr_b16 a[74:75], v14 offset:28672
    v_cvt_pk_bf16_f32 v82, v84, v85
    v_mfma_f32_16x16x32_bf16 v[40:43], a[100:103], v[148:151], v[40:43]
    ds_read_b64_tr_b16 a[76:77], v15 offset:24576
    v_mfma_f32_16x16x32_bf16 v[40:43], a[104:107], v[152:155], v[40:43]
    v_exp_f32 v87, v87
    v_mfma_f32_16x16x32_bf16 v[40:43], a[108:111], v[156:159], v[40:43]
    ds_read_b64_tr_b16 a[78:79], v15 offset:28672
    v_mfma_f32_16x16x32_bf16 v[44:47], a[112:115], v[144:147], v[100:103]
    v_exp_f32 v88, v88
    v_mfma_f32_16x16x32_bf16 v[44:47], a[116:119], v[148:151], v[44:47]
    ds_read_b64_tr_b16 a[80:81], v16 offset:24576
    v_cvt_pk_bf16_f32 v83, v86, v87
    v_mfma_f32_16x16x32_bf16 v[44:47], a[120:123], v[152:155], v[44:47]
    ds_read_b64_tr_b16 a[82:83], v16 offset:28672
    v_mfma_f32_16x16x32_bf16 v[44:47], a[124:127], v[156:159], v[44:47]
    v_exp_f32 v89, v89
    v_mfma_f32_16x16x32_bf16 v[48:51], a[96:99], v[160:163], v[104:107]
    ds_read_b64_tr_b16 a[84:85], v17 offset:24576
    v_mfma_f32_16x16x32_bf16 v[48:51], a[100:103], v[164:167], v[48:51]
    ds_read_b64_tr_b16 a[86:87], v17 offset:28672
    v_mfma_f32_16x16x32_bf16 v[48:51], a[104:107], v[168:171], v[48:51]
    v_exp_f32 v90, v90
    v_mfma_f32_16x16x32_bf16 v[48:51], a[108:111], v[172:175], v[48:51]
    ds_read_b64_tr_b16 a[88:89], v18 offset:24576
    v_cvt_pk_bf16_f32 v88, v88, v89
    v_mfma_f32_16x16x32_bf16 v[52:55], a[112:115], v[160:163], v[104:107]
    v_exp_f32 v91, v91
    v_mfma_f32_16x16x32_bf16 v[52:55], a[116:119], v[164:167], v[52:55]
    ds_read_b64_tr_b16 a[90:91], v18 offset:28672
    v_mfma_f32_16x16x32_bf16 v[52:55], a[120:123], v[168:171], v[52:55]
    ds_read_b64_tr_b16 a[92:93], v19 offset:24576
    v_mfma_f32_16x16x32_bf16 v[52:55], a[124:127], v[172:175], v[52:55]
    v_exp_f32 v92, v92
    v_mfma_f32_16x16x32_bf16 v[56:59], a[96:99], v[176:179], v[108:111]
    ds_read_b64_tr_b16 a[94:95], v19 offset:28672
    v_cvt_pk_bf16_f32 v89, v90, v91
    v_mfma_f32_16x16x32_bf16 v[56:59], a[100:103], v[180:183], v[56:59]
    v_exp_f32 v93, v93
    v_mfma_f32_16x16x32_bf16 v[56:59], a[104:107], v[184:187], v[56:59]
    v_exp_f32 v94, v94
    v_mfma_f32_16x16x32_bf16 v[56:59], a[108:111], v[188:191], v[56:59]
    v_cvt_pk_bf16_f32 v90, v92, v93
    v_mfma_f32_16x16x32_bf16 v[60:63], a[112:115], v[176:179], v[108:111]
    v_exp_f32 v95, v95
    v_mfma_f32_16x16x32_bf16 v[60:63], a[116:119], v[180:183], v[60:63]
    s_nop 0
    v_cvt_pk_bf16_f32 v91, v94, v95
    v_mfma_f32_16x16x32_bf16 v[60:63], a[120:123], v[184:187], v[60:63]
    v_mfma_f32_16x16x32_bf16 v[60:63], a[124:127], v[188:191], v[60:63]
    s_waitcnt lgkmcnt(0)
    v_mfma_f32_16x16x32_bf16 v[112:115], v[120:123], v[64:67], v[112:115]
    ds_read_b128 a[96:99], v8 offset:40960
    v_mfma_f32_16x16x32_bf16 a[0:3], a[64:67], v[64:67], a[0:3]
    s_add_u32 s50, s58, 90112
    v_exp_f32 v32, v32
    v_mfma_f32_16x16x32_bf16 a[4:7], a[68:71], v[64:67], a[4:7]
    v_exp_f32 v33, v33
    v_mfma_f32_16x16x32_bf16 a[8:11], a[72:75], v[64:67], a[8:11]
    ds_read_b128 a[100:103], v9 offset:40960
    v_mfma_f32_16x16x32_bf16 a[12:15], a[76:79], v[64:67], a[12:15]
    s_add_u32 m0, s57, 24576
    v_exp_f32 v34, v34
    v_mfma_f32_16x16x32_bf16 a[16:19], a[80:83], v[64:67], a[16:19]
    v_exp_f32 v35, v35
    v_mfma_f32_16x16x32_bf16 a[20:23], a[84:87], v[64:67], a[20:23]
    ds_read_b128 a[104:107], v10 offset:40960
    v_cvt_pk_bf16_f32 v32, v32, v33
    v_mfma_f32_16x16x32_bf16 a[24:27], a[88:91], v[64:67], a[24:27]
    s_and_b32 s50, s50, 0x1ffff
    v_exp_f32 v36, v36
    v_mfma_f32_16x16x32_bf16 a[28:31], a[92:95], v[64:67], a[28:31]
    v_exp_f32 v37, v37
    v_mfma_f32_16x16x32_bf16 v[112:115], v[124:127], v[72:75], v[112:115]
    v_exp_f32 v38, v38
    v_mfma_f32_16x16x32_bf16 a[32:35], a[64:67], v[72:75], a[32:35]
    buffer_load_dwordx4 v20, s[28:31], s50 offen offset:0 nt lds
    v_mfma_f32_16x16x32_bf16 a[36:39], a[68:71], v[72:75], a[36:39]
    ds_read_b128 a[108:111], v11 offset:40960
    v_cvt_pk_bf16_f32 v33, v34, v35
    v_mfma_f32_16x16x32_bf16 a[40:43], a[72:75], v[72:75], a[40:43]
    v_exp_f32 v39, v39
    v_mfma_f32_16x16x32_bf16 a[44:47], a[76:79], v[72:75], a[44:47]
    v_exp_f32 v40, v40
    v_mfma_f32_16x16x32_bf16 a[48:51], a[80:83], v[72:75], a[48:51]
    buffer_load_dwordx4 v21, s[28:31], s50 offen offset:1024 nt lds
    v_mfma_f32_16x16x32_bf16 a[52:55], a[84:87], v[72:75], a[52:55]
    ds_read_b128 a[112:115], v8 offset:45056
    v_mfma_f32_16x16x32_bf16 a[56:59], a[88:91], v[72:75], a[56:59]
L_pad3:
    s_cbranch_execz L_ret0
    v_exp_f32 v41, v41
    v_mfma_f32_16x16x32_bf16 a[60:63], a[92:95], v[72:75], a[60:63]
    s_add_u32 s50, s58, 73728
    v_exp_f32 v42, v42
    v_mfma_f32_16x16x32_bf16 v[116:119], v[120:123], v[80:83], v[116:119]
    ds_read_b128 a[116:119], v9 offset:45056
    v_cvt_pk_bf16_f32 v34, v36, v37
    v_mfma_f32_16x16x32_bf16 v[192:195], a[64:67], v[80:83], v[192:195]
    v_mfma_f32_16x16x32_bf16 v[196:199], a[68:71], v[80:83], v[196:199]
    s_add_u32 m0, s57, 73728
    v_exp_f32 v43, v43
    v_mfma_f32_16x16x32_bf16 v[200:203], a[72:75], v[80:83], v[200:203]
    v_exp_f32 v44, v44
    v_mfma_f32_16x16x32_bf16 v[204:207], a[76:79], v[80:83], v[204:207]
    ds_read_b128 a[120:123], v10 offset:45056
    v_cvt_pk_bf16_f32 v35, v38, v39
    v_mfma_f32_16x16x32_bf16 v[208:211], a[80:83], v[80:83], v[208:211]
    v_exp_f32 v45, v45
    v_mfma_f32_16x16x32_bf16 v[212:215], a[84:87], v[80:83], v[212:215]
    s_and_b32 s50, s50, 0x1ffff
    v_exp_f32 v46, v46
    v_mfma_f32_16x16x32_bf16 v[216:219], a[88:91], v[80:83], v[216:219]
    ds_read_b128 a[124:127], v11 offset:45056
    v_cvt_pk_bf16_f32 v40, v40, v41
    v_mfma_f32_16x16x32_bf16 v[220:223], a[92:95], v[80:83], v[220:223]
    v_cvt_pk_bf16_f32 v41, v42, v43
    v_mfma_f32_16x16x32_bf16 v[116:119], v[124:127], v[88:91], v[116:119]
    buffer_load_dwordx4 v22, s[32:35], s50 offen offset:0 nt lds
    v_mfma_f32_16x16x32_bf16 v[224:227], a[64:67], v[88:91], v[224:227]
    v_cvt_pk_bf16_f32 v42, v44, v45
    v_mfma_f32_16x16x32_bf16 v[228:231], a[68:71], v[88:91], v[228:231]
    v_exp_f32 v47, v47
    v_mfma_f32_16x16x32_bf16 v[232:235], a[72:75], v[88:91], v[232:235]
    buffer_load_dwordx4 v23, s[32:35], s50 offen offset:1024 nt lds
    v_mfma_f32_16x16x32_bf16 v[236:239], a[76:79], v[88:91], v[236:239]
    v_exp_f32 v48, v48
    v_mfma_f32_16x16x32_bf16 v[240:243], a[80:83], v[88:91], v[240:243]
    v_exp_f32 v49, v49
    v_mfma_f32_16x16x32_bf16 v[244:247], a[84:87], v[88:91], v[244:247]
    v_exp_f32 v50, v50
    v_mfma_f32_16x16x32_bf16 v[248:251], a[88:91], v[88:91], v[248:251]
    v_exp_f32 v51, v51
    v_mfma_f32_16x16x32_bf16 v[252:255], a[92:95], v[88:91], v[252:255]
    s_waitcnt lgkmcnt(0)
    v_exp_f32 v52, v52
    v_mfma_f32_16x16x32_bf16 v[64:67], a[96:99], v[128:131], v[96:99]
    ds_read_b64_tr_b16 a[64:65], v12 offset:32768
    v_mfma_f32_16x16x32_bf16 v[64:67], a[100:103], v[132:135], v[64:67]
    ds_read_b64_tr_b16 a[66:67], v12 offset:36864
    v_cvt_pk_bf16_f32 v43, v46, v47
    v_mfma_f32_16x16x32_bf16 v[64:67], a[104:107], v[136:139], v[64:67]
    v_exp_f32 v53, v53
    v_mfma_f32_16x16x32_bf16 v[64:67], a[108:111], v[140:143], v[64:67]
    ds_read_b64_tr_b16 a[68:69], v13 offset:32768
    v_cvt_pk_bf16_f32 v48, v48, v49
    v_mfma_f32_16x16x32_bf16 v[68:71], a[112:115], v[128:131], v[96:99]
    ds_read_b64_tr_b16 a[70:71], v13 offset:36864
    v_cvt_pk_bf16_f32 v49, v50, v51
    v_mfma_f32_16x16x32_bf16 v[68:71], a[116:119], v[132:135], v[68:71]
    v_mfma_f32_16x16x32_bf16 v[68:71], a[120:123], v[136:139], v[68:71]
    ds_read_b64_tr_b16 a[72:73], v14 offset:32768
    v_mfma_f32_16x16x32_bf16 v[68:71], a[124:127], v[140:143], v[68:71]
    v_exp_f32 v54, v54
    v_mfma_f32_16x16x32_bf16 v[72:75], a[96:99], v[144:147], v[100:103]
    ds_read_b64_tr_b16 a[74:75], v14 offset:36864
    v_cvt_pk_bf16_f32 v50, v52, v53
    v_mfma_f32_16x16x32_bf16 v[72:75], a[100:103], v[148:151], v[72:75]
    ds_read_b64_tr_b16 a[76:77], v15 offset:32768
    v_mfma_f32_16x16x32_bf16 v[72:75], a[104:107], v[152:155], v[72:75]
    v_exp_f32 v55, v55
    v_mfma_f32_16x16x32_bf16 v[72:75], a[108:111], v[156:159], v[72:75]
    ds_read_b64_tr_b16 a[78:79], v15 offset:36864
    v_mfma_f32_16x16x32_bf16 v[76:79], a[112:115], v[144:147], v[100:103]
    v_exp_f32 v56, v56
    v_mfma_f32_16x16x32_bf16 v[76:79], a[116:119], v[148:151], v[76:79]
    ds_read_b64_tr_b16 a[80:81], v16 offset:32768
    v_cvt_pk_bf16_f32 v51, v54, v55
    v_mfma_f32_16x16x32_bf16 v[76:79], a[120:123], v[152:155], v[76:79]
    ds_read_b64_tr_b16 a[82:83], v16 offset:36864
    v_mfma_f32_16x16x32_bf16 v[76:79], a[124:127], v[156:159], v[76:79]
    v_exp_f32 v57, v57
    v_mfma_f32_16x16x32_bf16 v[80:83], a[96:99], v[160:163], v[104:107]
    ds_read_b64_tr_b16 a[84:85], v17 offset:32768
    v_mfma_f32_16x16x32_bf16 v[80:83], a[100:103], v[164:167], v[80:83]
    ds_read_b64_tr_b16 a[86:87], v17 offset:36864
    v_mfma_f32_16x16x32_bf16 v[80:83], a[104:107], v[168:171], v[80:83]
    v_exp_f32 v58, v58
    v_mfma_f32_16x16x32_bf16 v[80:83], a[108:111], v[172:175], v[80:83]
    ds_read_b64_tr_b16 a[88:89], v18 offset:32768
    v_cvt_pk_bf16_f32 v56, v56, v57
    v_mfma_f32_16x16x32_bf16 v[84:87], a[112:115], v[160:163], v[104:107]
    v_exp_f32 v59, v59
    v_mfma_f32_16x16x32_bf16 v[84:87], a[116:119], v[164:167], v[84:87]
    ds_read_b64_tr_b16 a[90:91], v18 offset:36864
    v_mfma_f32_16x16x32_bf16 v[84:87], a[120:123], v[168:171], v[84:87]
    ds_read_b64_tr_b16 a[92:93], v19 offset:32768
    v_mfma_f32_16x16x32_bf16 v[84:87], a[124:127], v[172:175], v[84:87]
    v_exp_f32 v60, v60
    v_mfma_f32_16x16x32_bf16 v[88:91], a[96:99], v[176:179], v[108:111]
    ds_read_b64_tr_b16 a[94:95], v19 offset:36864
    v_cvt_pk_bf16_f32 v57, v58, v59
    v_mfma_f32_16x16x32_bf16 v[88:91], a[100:103], v[180:183], v[88:91]
    v_exp_f32 v61, v61
    v_mfma_f32_16x16x32_bf16 v[88:91], a[104:107], v[184:187], v[88:91]
    v_exp_f32 v62, v62
    v_mfma_f32_16x16x32_bf16 v[88:91], a[108:111], v[188:191], v[88:91]
    v_cvt_pk_bf16_f32 v58, v60, v61
    v_mfma_f32_16x16x32_bf16 v[92:95], a[112:115], v[176:179], v[108:111]
    v_exp_f32 v63, v63
    v_mfma_f32_16x16x32_bf16 v[92:95], a[116:119], v[180:183], v[92:95]
    s_nop 0
    v_cvt_pk_bf16_f32 v59, v62, v63
    v_mfma_f32_16x16x32_bf16 v[92:95], a[120:123], v[184:187], v[92:95]
    v_mfma_f32_16x16x32_bf16 v[92:95], a[124:127], v[188:191], v[92:95]
    s_waitcnt vmcnt(14) lgkmcnt(0)
    s_barrier
    v_mfma_f32_16x16x32_bf16 v[112:115], v[120:123], v[32:35], v[112:115]
    ds_read_b128 a[96:99], v8 offset:49152
    v_mfma_f32_16x16x32_bf16 a[0:3], a[64:67], v[32:35], a[0:3]
    s_add_u32 s50, s58, 81920
    v_exp_f32 v64, v64
    v_mfma_f32_16x16x32_bf16 a[4:7], a[68:71], v[32:35], a[4:7]
    v_exp_f32 v65, v65
    v_mfma_f32_16x16x32_bf16 a[8:11], a[72:75], v[32:35], a[8:11]
    ds_read_b128 a[100:103], v9 offset:49152
    v_mfma_f32_16x16x32_bf16 a[12:15], a[76:79], v[32:35], a[12:15]
    s_add_u32 m0, s57, 81920
    v_exp_f32 v66, v66
    v_mfma_f32_16x16x32_bf16 a[16:19], a[80:83], v[32:35], a[16:19]
    v_exp_f32 v67, v67
    v_mfma_f32_16x16x32_bf16 a[20:23], a[84:87], v[32:35], a[20:23]
    ds_read_b128 a[104:107], v10 offset:49152
    v_cvt_pk_bf16_f32 v64, v64, v65
    v_mfma_f32_16x16x32_bf16 a[24:27], a[88:91], v[32:35], a[24:27]
    s_and_b32 s50, s50, 0x1ffff
    v_exp_f32 v68, v68
    v_mfma_f32_16x16x32_bf16 a[28:31], a[92:95], v[32:35], a[28:31]
    v_exp_f32 v69, v69
    v_mfma_f32_16x16x32_bf16 v[112:115], v[124:127], v[40:43], v[112:115]
    v_exp_f32 v70, v70
    v_mfma_f32_16x16x32_bf16 a[32:35], a[64:67], v[40:43], a[32:35]
    buffer_load_dwordx4 v22, s[32:35], s50 offen offset:0 nt lds
    v_mfma_f32_16x16x32_bf16 a[36:39], a[68:71], v[40:43], a[36:39]
    ds_read_b128 a[108:111], v11 offset:49152
    v_cvt_pk_bf16_f32 v65, v66, v67
    v_mfma_f32_16x16x32_bf16 a[40:43], a[72:75], v[40:43], a[40:43]
    v_exp_f32 v71, v71
    v_mfma_f32_16x16x32_bf16 a[44:47], a[76:79], v[40:43], a[44:47]
    v_exp_f32 v72, v72
    v_mfma_f32_16x16x32_bf16 a[48:51], a[80:83], v[40:43], a[48:51]
    buffer_load_dwordx4 v23, s[32:35], s50 offen offset:1024 nt lds
    v_mfma_f32_16x16x32_bf16 a[52:55], a[84:87], v[40:43], a[52:55]
    ds_read_b128 a[112:115], v8 offset:53248
    v_cvt_pk_bf16_f32 v66, v68, v69
    v_mfma_f32_16x16x32_bf16 a[56:59], a[88:91], v[40:43], a[56:59]
    v_exp_f32 v73, v73
    v_mfma_f32_16x16x32_bf16 a[60:63], a[92:95], v[40:43], a[60:63]
    s_add_u32 s50, s58, 98304
    v_exp_f32 v74, v74
    v_mfma_f32_16x16x32_bf16 v[116:119], v[120:123], v[48:51], v[116:119]
    ds_read_b128 a[116:119], v9 offset:53248
    v_cvt_pk_bf16_f32 v67, v70, v71
    v_mfma_f32_16x16x32_bf16 v[192:195], a[64:67], v[48:51], v[192:195]
    v_exp_f32 v75, v75
    v_mfma_f32_16x16x32_bf16 v[196:199], a[68:71], v[48:51], v[196:199]
    s_add_u32 m0, s57, 32768
    v_exp_f32 v76, v76
    v_mfma_f32_16x16x32_bf16 v[200:203], a[72:75], v[48:51], v[200:203]
    v_exp_f32 v77, v77
    v_mfma_f32_16x16x32_bf16 v[204:207], a[76:79], v[48:51], v[204:207]
    ds_read_b128 a[120:123], v10 offset:53248
    v_cvt_pk_bf16_f32 v72, v72, v73
    v_mfma_f32_16x16x32_bf16 v[208:211], a[80:83], v[48:51], v[208:211]
    v_exp_f32 v78, v78
    v_mfma_f32_16x16x32_bf16 v[212:215], a[84:87], v[48:51], v[212:215]
    s_and_b32 s50, s50, 0x1ffff
    v_exp_f32 v79, v79
    v_mfma_f32_16x16x32_bf16 v[216:219], a[88:91], v[48:51], v[216:219]
    ds_read_b128 a[124:127], v11 offset:53248
    v_cvt_pk_bf16_f32 v73, v74, v75
    v_mfma_f32_16x16x32_bf16 v[220:223], a[92:95], v[48:51], v[220:223]
    v_cvt_pk_bf16_f32 v74, v76, v77
    v_mfma_f32_16x16x32_bf16 v[116:119], v[124:127], v[56:59], v[116:119]
    buffer_load_dwordx4 v20, s[28:31], s50 offen offset:0 nt lds
    v_mfma_f32_16x16x32_bf16 v[224:227], a[64:67], v[56:59], v[224:227]
    v_exp_f32 v80, v80
    v_mfma_f32_16x16x32_bf16 v[228:231], a[68:71], v[56:59], v[228:231]
    v_cvt_pk_bf16_f32 v75, v78, v79
    v_mfma_f32_16x16x32_bf16 v[232:235], a[72:75], v[56:59], v[232:235]
    buffer_load_dwordx4 v21, s[28:31], s50 offen offset:1024 nt lds
    v_mfma_f32_16x16x32_bf16 v[236:239], a[76:79], v[56:59], v[236:239]
    v_exp_f32 v81, v81
    v_mfma_f32_16x16x32_bf16 v[240:243], a[80:83], v[56:59], v[240:243]
    v_exp_f32 v82, v82
    v_mfma_f32_16x16x32_bf16 v[244:247], a[84:87], v[56:59], v[244:247]
    v_exp_f32 v83, v83
    v_mfma_f32_16x16x32_bf16 v[248:251], a[88:91], v[56:59], v[248:251]
    v_exp_f32 v84, v84
    v_mfma_f32_16x16x32_bf16 v[252:255], a[92:95], v[56:59], v[252:255]
    s_waitcnt lgkmcnt(0)
    v_exp_f32 v85, v85
    v_mfma_f32_16x16x32_bf16 v[32:35], a[96:99], v[128:131], v[96:99]
    ds_read_b64_tr_b16 a[64:65], v12 offset:40960
    v_cvt_pk_bf16_f32 v80, v80, v81
    v_mfma_f32_16x16x32_bf16 v[32:35], a[100:103], v[132:135], v[32:35]
    s_add_u32 s49, s8, 0
    ds_read_b64_tr_b16 a[66:67], v12 offset:45056
    v_cvt_pk_bf16_f32 v81, v82, v83
    v_mfma_f32_16x16x32_bf16 v[32:35], a[104:107], v[136:139], v[32:35]
    ds_read_b64_tr_b16 a[68:69], v13 offset:40960
    v_mfma_f32_16x16x32_bf16 v[32:35], a[108:111], v[140:143], v[32:35]
    v_exp_f32 v86, v86
    v_mfma_f32_16x16x32_bf16 v[36:39], a[112:115], v[128:131], v[96:99]
    s_and_b32 s49, s49, 31
    ds_read_b64_tr_b16 a[70:71], v13 offset:45056
    v_cvt_pk_bf16_f32 v82, v84, v85
    v_mfma_f32_16x16x32_bf16 v[36:39], a[116:119], v[132:135], v[36:39]
    ds_read_b64_tr_b16 a[72:73], v14 offset:40960
    v_mfma_f32_16x16x32_bf16 v[36:39], a[120:123], v[136:139], v[36:39]
    v_exp_f32 v87, v87
    v_mfma_f32_16x16x32_bf16 v[36:39], a[124:127], v[140:143], v[36:39]
    s_add_u32 m0, s56, 131072
    ds_read_b64_tr_b16 a[74:75], v14 offset:45056
    v_mfma_f32_16x16x32_bf16 v[40:43], a[96:99], v[144:147], v[100:103]
    ds_read_b64_tr_b16 a[76:77], v15 offset:40960
    v_mfma_f32_16x16x32_bf16 v[40:43], a[100:103], v[148:151], v[40:43]
    v_exp_f32 v88, v88
    v_mfma_f32_16x16x32_bf16 v[40:43], a[104:107], v[152:155], v[40:43]
    ds_read_b64_tr_b16 a[78:79], v15 offset:45056
    v_cvt_pk_bf16_f32 v83, v86, v87
    v_mfma_f32_16x16x32_bf16 v[40:43], a[108:111], v[156:159], v[40:43]
    s_lshl_b32 s52, s49, 15
    ds_read_b64_tr_b16 a[80:81], v16 offset:40960
    v_mfma_f32_16x16x32_bf16 v[44:47], a[112:115], v[144:147], v[100:103]
    ds_read_b64_tr_b16 a[82:83], v16 offset:45056
    v_mfma_f32_16x16x32_bf16 v[44:47], a[116:119], v[148:151], v[44:47]
    v_exp_f32 v89, v89
    v_mfma_f32_16x16x32_bf16 v[44:47], a[120:123], v[152:155], v[44:47]
    buffer_load_dwordx4 v28, s[68:71], s52 offen offset:0 lds
    v_mfma_f32_16x16x32_bf16 v[44:47], a[124:127], v[156:159], v[44:47]
    ds_read_b64_tr_b16 a[84:85], v17 offset:40960
    v_mfma_f32_16x16x32_bf16 v[48:51], a[96:99], v[160:163], v[104:107]
    ds_read_b64_tr_b16 a[86:87], v17 offset:45056
    v_mfma_f32_16x16x32_bf16 v[48:51], a[100:103], v[164:167], v[48:51]
    v_exp_f32 v90, v90
    v_mfma_f32_16x16x32_bf16 v[48:51], a[104:107], v[168:171], v[48:51]
    s_add_u32 s53, s52, 14336
    ds_read_b64_tr_b16 a[88:89], v18 offset:40960
    v_cvt_pk_bf16_f32 v88, v88, v89
    v_mfma_f32_16x16x32_bf16 v[48:51], a[108:111], v[172:175], v[48:51]
    ds_read_b64_tr_b16 a[90:91], v18 offset:45056
    v_mfma_f32_16x16x32_bf16 v[52:55], a[112:115], v[160:163], v[104:107]
    v_exp_f32 v91, v91
    v_mfma_f32_16x16x32_bf16 v[52:55], a[116:119], v[164:167], v[52:55]
    buffer_load_dwordx4 v29, s[68:71], s52 offen offset:1024 lds
    v_mfma_f32_16x16x32_bf16 v[52:55], a[120:123], v[168:171], v[52:55]
    ds_read_b64_tr_b16 a[92:93], v19 offset:40960
    v_mfma_f32_16x16x32_bf16 v[52:55], a[124:127], v[172:175], v[52:55]
    ds_read_b64_tr_b16 a[94:95], v19 offset:45056
    v_mfma_f32_16x16x32_bf16 v[56:59], a[96:99], v[176:179], v[108:111]
    v_exp_f32 v92, v92
    v_mfma_f32_16x16x32_bf16 v[56:59], a[100:103], v[180:183], v[56:59]
    buffer_load_dwordx4 v28, s[68:71], s53 offen offset:2048 lds
    v_mfma_f32_16x16x32_bf16 v[56:59], a[104:107], v[184:187], v[56:59]
    v_exp_f32 v93, v93
    v_mfma_f32_16x16x32_bf16 v[56:59], a[108:111], v[188:191], v[56:59]
    v_exp_f32 v94, v94
    v_mfma_f32_16x16x32_bf16 v[60:63], a[112:115], v[176:179], v[108:111]
    buffer_load_dwordx4 v29, s[68:71], s53 offen offset:3072 lds
    v_mfma_f32_16x16x32_bf16 v[60:63], a[116:119], v[180:183], v[60:63]
    v_exp_f32 v95, v95
    v_mfma_f32_16x16x32_bf16 v[60:63], a[120:123], v[184:187], v[60:63]
    v_cvt_pk_bf16_f32 v89, v90, v91
    v_cvt_pk_bf16_f32 v90, v92, v93
    s_nop 0
    v_cvt_pk_bf16_f32 v91, v94, v95
    v_mfma_f32_16x16x32_bf16 v[60:63], a[124:127], v[188:191], v[60:63]
    s_waitcnt lgkmcnt(0)
    v_mfma_f32_16x16x32_bf16 v[112:115], v[120:123], v[64:67], v[112:115]
    ds_read_b128 a[96:99], v8 offset:57344
    v_mfma_f32_16x16x32_bf16 a[0:3], a[64:67], v[64:67], a[0:3]
    s_add_u32 s50, s58, 106496
    v_exp_f32 v32, v32
    v_mfma_f32_16x16x32_bf16 a[4:7], a[68:71], v[64:67], a[4:7]
    v_exp_f32 v33, v33
    v_mfma_f32_16x16x32_bf16 a[8:11], a[72:75], v[64:67], a[8:11]
    ds_read_b128 a[100:103], v9 offset:57344
    v_mfma_f32_16x16x32_bf16 a[12:15], a[76:79], v[64:67], a[12:15]
    s_add_u32 m0, s57, 40960
    v_exp_f32 v34, v34
    v_mfma_f32_16x16x32_bf16 a[16:19], a[80:83], v[64:67], a[16:19]
    v_exp_f32 v35, v35
    v_mfma_f32_16x16x32_bf16 a[20:23], a[84:87], v[64:67], a[20:23]
    ds_read_b128 a[104:107], v10 offset:57344
    v_cvt_pk_bf16_f32 v32, v32, v33
    v_mfma_f32_16x16x32_bf16 a[24:27], a[88:91], v[64:67], a[24:27]
    s_and_b32 s50, s50, 0x1ffff
    v_exp_f32 v36, v36
    v_mfma_f32_16x16x32_bf16 a[28:31], a[92:95], v[64:67], a[28:31]
    v_exp_f32 v37, v37
    v_mfma_f32_16x16x32_bf16 v[112:115], v[124:127], v[72:75], v[112:115]
    v_exp_f32 v38, v38
    v_mfma_f32_16x16x32_bf16 a[32:35], a[64:67], v[72:75], a[32:35]
    buffer_load_dwordx4 v20, s[28:31], s50 offen offset:0 nt lds
    v_mfma_f32_16x16x32_bf16 a[36:39], a[68:71], v[72:75], a[36:39]
    ds_read_b128 a[108:111], v11 offset:57344
    v_cvt_pk_bf16_f32 v33, v34, v35
    v_mfma_f32_16x16x32_bf16 a[40:43], a[72:75], v[72:75], a[40:43]
    v_exp_f32 v39, v39
    v_mfma_f32_16x16x32_bf16 a[44:47], a[76:79], v[72:75], a[44:47]
    v_exp_f32 v40, v40
    v_mfma_f32_16x16x32_bf16 a[48:51], a[80:83], v[72:75], a[48:51]
    buffer_load_dwordx4 v21, s[28:31], s50 offen offset:1024 nt lds
    v_mfma_f32_16x16x32_bf16 a[52:55], a[84:87], v[72:75], a[52:55]
    ds_read_b128 a[112:115], v8 offset:61440
    v_cvt_pk_bf16_f32 v34, v36, v37
    v_mfma_f32_16x16x32_bf16 a[56:59], a[88:91], v[72:75], a[56:59]
    v_exp_f32 v41, v41
    v_mfma_f32_16x16x32_bf16 a[60:63], a[92:95], v[72:75], a[60:63]
    s_add_u32 s50, s58, 90112
    v_exp_f32 v42, v42
    v_mfma_f32_16x16x32_bf16 v[116:119], v[120:123], v[80:83], v[116:119]
    ds_read_b128 a[116:119], v9 offset:61440
    v_cvt_pk_bf16_f32 v35, v38, v39
    v_mfma_f32_16x16x32_bf16 v[192:195], a[64:67], v[80:83], v[192:195]
    v_exp_f32 v43, v43
    v_mfma_f32_16x16x32_bf16 v[196:199], a[68:71], v[80:83], v[196:199]
    s_add_u32 m0, s57, 90112
    v_exp_f32 v44, v44
    v_mfma_f32_16x16x32_bf16 v[200:203], a[72:75], v[80:83], v[200:203]
    v_exp_f32 v45, v45
    v_mfma_f32_16x16x32_bf16 v[204:207], a[76:79], v[80:83], v[204:207]
    ds_read_b128 a[120:123], v10 offset:61440
    v_cvt_pk_bf16_f32 v40, v40, v41
    v_mfma_f32_16x16x32_bf16 v[208:211], a[80:83], v[80:83], v[208:211]
    v_exp_f32 v46, v46
    v_mfma_f32_16x16x32_bf16 v[212:215], a[84:87], v[80:83], v[212:215]
    s_and_b32 s50, s50, 0x1ffff
    v_exp_f32 v47, v47
    v_mfma_f32_16x16x32_bf16 v[216:219], a[88:91], v[80:83], v[216:219]
    ds_read_b128 a[124:127], v11 offset:61440
    v_cvt_pk_bf16_f32 v41, v42, v43
    v_mfma_f32_16x16x32_bf16 v[220:223], a[92:95], v[80:83], v[220:223]
    v_cvt_pk_bf16_f32 v42, v44, v45
    v_mfma_f32_16x16x32_bf16 v[116:119], v[124:127], v[88:91], v[116:119]
    buffer_load_dwordx4 v22, s[32:35], s50 offen offset:0 nt lds
    v_mfma_f32_16x16x32_bf16 v[224:227], a[64:67], v[88:91], v[224:227]
    v_exp_f32 v48, v48
    v_mfma_f32_16x16x32_bf16 v[228:231], a[68:71], v[88:91], v[228:231]
    v_cvt_pk_bf16_f32 v43, v46, v47
    v_mfma_f32_16x16x32_bf16 v[232:235], a[72:75], v[88:91], v[232:235]
    buffer_load_dwordx4 v23, s[32:35], s50 offen offset:1024 nt lds
    v_mfma_f32_16x16x32_bf16 v[236:239], a[76:79], v[88:91], v[236:239]
    v_exp_f32 v49, v49
    v_mfma_f32_16x16x32_bf16 v[240:243], a[80:83], v[88:91], v[240:243]
    v_exp_f32 v50, v50
    v_mfma_f32_16x16x32_bf16 v[244:247], a[84:87], v[88:91], v[244:247]
    v_exp_f32 v51, v51
    v_mfma_f32_16x16x32_bf16 v[248:251], a[88:91], v[88:91], v[248:251]
    v_exp_f32 v52, v52
    v_mfma_f32_16x16x32_bf16 v[252:255], a[92:95], v[88:91], v[252:255]
    s_waitcnt lgkmcnt(0)
    v_exp_f32 v53, v53
    v_mfma_f32_16x16x32_bf16 v[64:67], a[96:99], v[128:131], v[96:99]
    ds_read_b64_tr_b16 a[64:65], v12 offset:49152
    v_cvt_pk_bf16_f32 v48, v48, v49
    v_mfma_f32_16x16x32_bf16 v[64:67], a[100:103], v[132:135], v[64:67]
    s_add_u32 s49, s8, 1
    ds_read_b64_tr_b16 a[66:67], v12 offset:53248
    v_cvt_pk_bf16_f32 v49, v50, v51
    v_mfma_f32_16x16x32_bf16 v[64:67], a[104:107], v[136:139], v[64:67]
    ds_read_b64_tr_b16 a[68:69], v13 offset:49152
    v_mfma_f32_16x16x32_bf16 v[64:67], a[108:111], v[140:143], v[64:67]
    v_exp_f32 v54, v54
    v_mfma_f32_16x16x32_bf16 v[68:71], a[112:115], v[128:131], v[96:99]
    s_and_b32 s49, s49, 31
    ds_read_b64_tr_b16 a[70:71], v13 offset:53248
    v_cvt_pk_bf16_f32 v50, v52, v53
    v_mfma_f32_16x16x32_bf16 v[68:71], a[116:119], v[132:135], v[68:71]
    ds_read_b64_tr_b16 a[72:73], v14 offset:49152
    v_mfma_f32_16x16x32_bf16 v[68:71], a[120:123], v[136:139], v[68:71]
    v_exp_f32 v55, v55
    v_mfma_f32_16x16x32_bf16 v[68:71], a[124:127], v[140:143], v[68:71]
    s_add_u32 m0, s56, 147456
    ds_read_b64_tr_b16 a[74:75], v14 offset:53248
    v_mfma_f32_16x16x32_bf16 v[72:75], a[96:99], v[144:147], v[100:103]
    ds_read_b64_tr_b16 a[76:77], v15 offset:49152
    v_mfma_f32_16x16x32_bf16 v[72:75], a[100:103], v[148:151], v[72:75]
    v_exp_f32 v56, v56
    v_mfma_f32_16x16x32_bf16 v[72:75], a[104:107], v[152:155], v[72:75]
    ds_read_b64_tr_b16 a[78:79], v15 offset:53248
    v_cvt_pk_bf16_f32 v51, v54, v55
    v_mfma_f32_16x16x32_bf16 v[72:75], a[108:111], v[156:159], v[72:75]
    s_lshl_b32 s52, s49, 15
    ds_read_b64_tr_b16 a[80:81], v16 offset:49152
    v_mfma_f32_16x16x32_bf16 v[76:79], a[112:115], v[144:147], v[100:103]
    ds_read_b64_tr_b16 a[82:83], v16 offset:53248
    v_mfma_f32_16x16x32_bf16 v[76:79], a[116:119], v[148:151], v[76:79]
    v_exp_f32 v57, v57
    v_mfma_f32_16x16x32_bf16 v[76:79], a[120:123], v[152:155], v[76:79]
    buffer_load_dwordx4 v28, s[68:71], s52 offen offset:0 lds
    v_mfma_f32_16x16x32_bf16 v[76:79], a[124:127], v[156:159], v[76:79]
    ds_read_b64_tr_b16 a[84:85], v17 offset:49152
    v_mfma_f32_16x16x32_bf16 v[80:83], a[96:99], v[160:163], v[104:107]
    ds_read_b64_tr_b16 a[86:87], v17 offset:53248
    v_mfma_f32_16x16x32_bf16 v[80:83], a[100:103], v[164:167], v[80:83]
    v_exp_f32 v58, v58
    v_mfma_f32_16x16x32_bf16 v[80:83], a[104:107], v[168:171], v[80:83]
    s_add_u32 s53, s52, 14336
    ds_read_b64_tr_b16 a[88:89], v18 offset:49152
    v_cvt_pk_bf16_f32 v56, v56, v57
    v_mfma_f32_16x16x32_bf16 v[80:83], a[108:111], v[172:175], v[80:83]
    ds_read_b64_tr_b16 a[90:91], v18 offset:53248
    v_mfma_f32_16x16x32_bf16 v[84:87], a[112:115], v[160:163], v[104:107]
    v_exp_f32 v59, v59
    v_mfma_f32_16x16x32_bf16 v[84:87], a[116:119], v[164:167], v[84:87]
    buffer_load_dwordx4 v29, s[68:71], s52 offen offset:1024 lds
    v_mfma_f32_16x16x32_bf16 v[84:87], a[120:123], v[168:171], v[84:87]
    ds_read_b64_tr_b16 a[92:93], v19 offset:49152
    v_mfma_f32_16x16x32_bf16 v[84:87], a[124:127], v[172:175], v[84:87]
    ds_read_b64_tr_b16 a[94:95], v19 offset:53248
    v_mfma_f32_16x16x32_bf16 v[88:91], a[96:99], v[176:179], v[108:111]
    v_exp_f32 v60, v60
    v_mfma_f32_16x16x32_bf16 v[88:91], a[100:103], v[180:183], v[88:91]
    buffer_load_dwordx4 v28, s[68:71], s53 offen offset:2048 lds
    v_mfma_f32_16x16x32_bf16 v[88:91], a[104:107], v[184:187], v[88:91]
    v_exp_f32 v61, v61
    v_mfma_f32_16x16x32_bf16 v[88:91], a[108:111], v[188:191], v[88:91]
    v_exp_f32 v62, v62
    v_mfma_f32_16x16x32_bf16 v[92:95], a[112:115], v[176:179], v[108:111]
    buffer_load_dwordx4 v29, s[68:71], s53 offen offset:3072 lds
    v_mfma_f32_16x16x32_bf16 v[92:95], a[116:119], v[180:183], v[92:95]
    v_exp_f32 v63, v63
    v_mfma_f32_16x16x32_bf16 v[92:95], a[120:123], v[184:187], v[92:95]
    v_cvt_pk_bf16_f32 v57, v58, v59
    v_cvt_pk_bf16_f32 v58, v60, v61
    s_nop 0
    v_cvt_pk_bf16_f32 v59, v62, v63
    v_mfma_f32_16x16x32_bf16 v[92:95], a[124:127], v[188:191], v[92:95]
    s_waitcnt vmcnt(22) lgkmcnt(0)
    s_barrier
    v_mfma_f32_16x16x32_bf16 v[112:115], v[120:123], v[32:35], v[112:115]
    ds_read_b128 a[96:99], v8 offset:0
    v_exp_f32 v64, v64
    v_mfma_f32_16x16x32_bf16 a[0:3], a[64:67], v[32:35], a[0:3]
    s_add_u32 s50, s58, 98304
    ds_read_b128 a[100:103], v9 offset:0
    v_mfma_f32_16x16x32_bf16 a[4:7], a[68:71], v[32:35], a[4:7]
    v_exp_f32 v65, v65
    v_mfma_f32_16x16x32_bf16 a[8:11], a[72:75], v[32:35], a[8:11]
    ds_read_b128 a[104:107], v10 offset:0
    v_mfma_f32_16x16x32_bf16 a[12:15], a[76:79], v[32:35], a[12:15]
    s_add_u32 m0, s57, 98304
    v_exp_f32 v66, v66
    v_mfma_f32_16x16x32_bf16 a[16:19], a[80:83], v[32:35], a[16:19]
    ds_read_b128 a[108:111], v11 offset:0
    v_cvt_pk_bf16_f32 v64, v64, v65
    v_mfma_f32_16x16x32_bf16 a[20:23], a[84:87], v[32:35], a[20:23]
    ds_read_b128 a[112:115], v8 offset:4096
    v_exp_f32 v67, v67
    v_mfma_f32_16x16x32_bf16 a[24:27], a[88:91], v[32:35], a[24:27]
    s_and_b32 s50, s50, 0x1ffff
    v_exp_f32 v68, v68
    v_mfma_f32_16x16x32_bf16 a[28:31], a[92:95], v[32:35], a[28:31]
    ds_read_b128 a[116:119], v9 offset:4096
    v_cvt_pk_bf16_f32 v65, v66, v67
    v_mfma_f32_16x16x32_bf16 v[112:115], v[124:127], v[40:43], v[112:115]
    v_exp_f32 v69, v69
    v_mfma_f32_16x16x32_bf16 a[32:35], a[64:67], v[40:43], a[32:35]
    buffer_load_dwordx4 v22, s[32:35], s50 offen offset:0 nt lds
    v_mfma_f32_16x16x32_bf16 a[36:39], a[68:71], v[40:43], a[36:39]
    ds_read_b128 a[120:123], v10 offset:4096
    v_mfma_f32_16x16x32_bf16 a[40:43], a[72:75], v[40:43], a[40:43]
    ds_read_b128 a[124:127], v11 offset:4096
    v_mfma_f32_16x16x32_bf16 a[44:47], a[76:79], v[40:43], a[44:47]
    v_exp_f32 v70, v70
    v_mfma_f32_16x16x32_bf16 a[48:51], a[80:83], v[40:43], a[48:51]
    buffer_load_dwordx4 v23, s[32:35], s50 offen offset:1024 nt lds
    v_mfma_f32_16x16x32_bf16 a[52:55], a[84:87], v[40:43], a[52:55]
    s_waitcnt vmcnt(10)
    ds_read_b64_tr_b16 a[128:129], v24 offset:0
    v_cvt_pk_bf16_f32 v66, v68, v69
    v_mfma_f32_16x16x32_bf16 a[56:59], a[88:91], v[40:43], a[56:59]
    v_exp_f32 v71, v71
    v_mfma_f32_16x16x32_bf16 a[60:63], a[92:95], v[40:43], a[60:63]
    s_add_u32 s50, s58, 114688
    ds_read_b64_tr_b16 a[130:131], v24 offset:2048
    v_exp_f32 v72, v72
    v_mfma_f32_16x16x32_bf16 v[116:119], v[120:123], v[48:51], v[116:119]
    ds_read_b64_tr_b16 a[132:133], v25 offset:0
    v_cvt_pk_bf16_f32 v67, v70, v71
    v_mfma_f32_16x16x32_bf16 v[192:195], a[64:67], v[48:51], v[192:195]
    v_exp_f32 v73, v73
    v_mfma_f32_16x16x32_bf16 v[196:199], a[68:71], v[48:51], v[196:199]
    s_add_u32 m0, s57, 49152
    ds_read_b64_tr_b16 a[134:135], v25 offset:2048
    v_mfma_f32_16x16x32_bf16 v[200:203], a[72:75], v[48:51], v[200:203]
    v_exp_f32 v74, v74
    v_mfma_f32_16x16x32_bf16 v[204:207], a[76:79], v[48:51], v[204:207]
    ds_read_b64_tr_b16 a[136:137], v26 offset:0
    v_cvt_pk_bf16_f32 v72, v72, v73
    v_mfma_f32_16x16x32_bf16 v[208:211], a[80:83], v[48:51], v[208:211]
    ds_read_b64_tr_b16 a[138:139], v26 offset:2048
    v_exp_f32 v75, v75
    v_mfma_f32_16x16x32_bf16 v[212:215], a[84:87], v[48:51], v[212:215]
    s_and_b32 s50, s50, 0x1ffff
    v_exp_f32 v76, v76
    v_mfma_f32_16x16x32_bf16 v[216:219], a[88:91], v[48:51], v[216:219]
    ds_read_b64_tr_b16 a[140:141], v27 offset:0
    v_cvt_pk_bf16_f32 v73, v74, v75
    v_mfma_f32_16x16x32_bf16 v[220:223], a[92:95], v[48:51], v[220:223]
    v_exp_f32 v77, v77
    v_mfma_f32_16x16x32_bf16 v[116:119], v[124:127], v[56:59], v[116:119]
    buffer_load_dwordx4 v20, s[28:31], s50 offen offset:0 nt lds
    v_mfma_f32_16x16x32_bf16 v[224:227], a[64:67], v[56:59], v[224:227]
    ds_read_b64_tr_b16 a[142:143], v27 offset:2048
    v_mfma_f32_16x16x32_bf16 v[228:231], a[68:71], v[56:59], v[228:231]
    v_exp_f32 v78, v78
    v_mfma_f32_16x16x32_bf16 v[232:235], a[72:75], v[56:59], v[232:235]
    buffer_load_dwordx4 v21, s[28:31], s50 offen offset:1024 nt lds
    v_mfma_f32_16x16x32_bf16 v[236:239], a[76:79], v[56:59], v[236:239]
    v_exp_f32 v79, v79
    v_mfma_f32_16x16x32_bf16 v[240:243], a[80:83], v[56:59], v[240:243]
    v_exp_f32 v80, v80
    v_mfma_f32_16x16x32_bf16 v[244:247], a[84:87], v[56:59], v[244:247]
    v_exp_f32 v81, v81
    v_mfma_f32_16x16x32_bf16 v[248:251], a[88:91], v[56:59], v[248:251]
    v_exp_f32 v82, v82
    v_mfma_f32_16x16x32_bf16 v[252:255], a[92:95], v[56:59], v[252:255]
    s_waitcnt lgkmcnt(0)
    v_exp_f32 v83, v83
    v_mfma_f32_16x16x32_bf16 v[32:35], a[96:99], v[128:131], v[96:99]
    ds_read_b64_tr_b16 a[64:65], v12 offset:57344
    v_cvt_pk_bf16_f32 v74, v76, v77
    v_mfma_f32_16x16x32_bf16 v[32:35], a[100:103], v[132:135], v[32:35]
    s_add_u32 s49, s8, 2
    ds_read_b64_tr_b16 a[66:67], v12 offset:61440
    v_cvt_pk_bf16_f32 v75, v78, v79
    v_mfma_f32_16x16x32_bf16 v[32:35], a[104:107], v[136:139], v[32:35]
    ds_read_b64_tr_b16 a[68:69], v13 offset:57344
    v_exp_f32 v84, v84
    v_mfma_f32_16x16x32_bf16 v[32:35], a[108:111], v[140:143], v[32:35]
    v_exp_f32 v85, v85
    v_mfma_f32_16x16x32_bf16 v[36:39], a[112:115], v[128:131], v[96:99]
    s_and_b32 s49, s49, 31
    ds_read_b64_tr_b16 a[70:71], v13 offset:61440
    v_cvt_pk_bf16_f32 v80, v80, v81
    v_mfma_f32_16x16x32_bf16 v[36:39], a[116:119], v[132:135], v[36:39]
    ds_read_b64_tr_b16 a[72:73], v14 offset:57344
    v_cvt_pk_bf16_f32 v81, v82, v83
    v_mfma_f32_16x16x32_bf16 v[36:39], a[120:123], v[136:139], v[36:39]
    ds_read_b64_tr_b16 a[74:75], v14 offset:61440
    v_mfma_f32_16x16x32_bf16 v[36:39], a[124:127], v[140:143], v[36:39]
    s_add_u32 m0, s56, 131072
    v_exp_f32 v86, v86
    v_mfma_f32_16x16x32_bf16 v[40:43], a[96:99], v[144:147], v[100:103]
    ds_read_b64_tr_b16 a[76:77], v15 offset:57344
    v_exp_f32 v87, v87
    v_mfma_f32_16x16x32_bf16 v[40:43], a[100:103], v[148:151], v[40:43]
    ds_read_b64_tr_b16 a[78:79], v15 offset:61440
    v_cvt_pk_bf16_f32 v82, v84, v85
    v_mfma_f32_16x16x32_bf16 v[40:43], a[104:107], v[152:155], v[40:43]
    s_lshl_b32 s52, s49, 15
    v_exp_f32 v88, v88
    v_mfma_f32_16x16x32_bf16 v[40:43], a[108:111], v[156:159], v[40:43]
    ds_read_b64_tr_b16 a[80:81], v16 offset:57344
    v_cvt_pk_bf16_f32 v83, v86, v87
    v_mfma_f32_16x16x32_bf16 v[44:47], a[112:115], v[144:147], v[100:103]
    ds_read_b64_tr_b16 a[82:83], v16 offset:61440
    v_mfma_f32_16x16x32_bf16 v[44:47], a[116:119], v[148:151], v[44:47]
    buffer_load_dwordx4 v28, s[68:71], s52 offen offset:0 lds
    v_mfma_f32_16x16x32_bf16 v[44:47], a[120:123], v[152:155], v[44:47]
    ds_read_b64_tr_b16 a[84:85], v17 offset:57344
    v_mfma_f32_16x16x32_bf16 v[44:47], a[124:127], v[156:159], v[44:47]
    v_exp_f32 v89, v89
    v_mfma_f32_16x16x32_bf16 v[48:51], a[96:99], v[160:163], v[104:107]
    s_add_u32 s53, s52, 14336
    ds_read_b64_tr_b16 a[86:87], v17 offset:61440
    v_exp_f32 v90, v90
    v_mfma_f32_16x16x32_bf16 v[48:51], a[100:103], v[164:167], v[48:51]
L_pad4:
    s_cbranch_execz L_ret1
    ds_read_b64_tr_b16 a[88:89], v18 offset:57344
    v_cvt_pk_bf16_f32 v88, v88, v89
    v_mfma_f32_16x16x32_bf16 v[48:51], a[104:107], v[168:171], v[48:51]
    ds_read_b64_tr_b16 a[90:91], v18 offset:61440
    v_mfma_f32_16x16x32_bf16 v[48:51], a[108:111], v[172:175], v[48:51]
    buffer_load_dwordx4 v29, s[68:71], s52 offen offset:1024 lds
    v_mfma_f32_16x16x32_bf16 v[52:55], a[112:115], v[160:163], v[104:107]
    v_exp_f32 v91, v91
    v_mfma_f32_16x16x32_bf16 v[52:55], a[116:119], v[164:167], v[52:55]
    ds_read_b64_tr_b16 a[92:93], v19 offset:57344
    v_mfma_f32_16x16x32_bf16 v[52:55], a[120:123], v[168:171], v[52:55]
    buffer_load_dwordx4 v28, s[68:71], s53 offen offset:2048 lds
    v_mfma_f32_16x16x32_bf16 v[52:55], a[124:127], v[172:175], v[52:55]
    ds_read_b64_tr_b16 a[94:95], v19 offset:61440
    v_mfma_f32_16x16x32_bf16 v[56:59], a[96:99], v[176:179], v[108:111]
    v_exp_f32 v92, v92
    v_mfma_f32_16x16x32_bf16 v[56:59], a[100:103], v[180:183], v[56:59]
    buffer_load_dwordx4 v29, s[68:71], s53 offen offset:3072 lds
    v_mfma_f32_16x16x32_bf16 v[56:59], a[104:107], v[184:187], v[56:59]
    v_exp_f32 v93, v93
    v_mfma_f32_16x16x32_bf16 v[56:59], a[108:111], v[188:191], v[56:59]
    v_exp_f32 v94, v94
    v_mfma_f32_16x16x32_bf16 v[60:63], a[112:115], v[176:179], v[108:111]
    buffer_load_dwordx2 v[2:3], off, s[80:83], 0 sc1
    v_mfma_f32_16x16x32_bf16 v[60:63], a[116:119], v[180:183], v[60:63]
    v_exp_f32 v95, v95
    v_mfma_f32_16x16x32_bf16 v[60:63], a[120:123], v[184:187], v[60:63]
    v_cvt_pk_bf16_f32 v89, v90, v91
    v_cvt_pk_bf16_f32 v90, v92, v93
    s_nop 0
    v_cvt_pk_bf16_f32 v91, v94, v95
    v_mfma_f32_16x16x32_bf16 v[60:63], a[124:127], v[188:191], v[60:63]
    s_waitcnt lgkmcnt(0)
    v_mfma_f32_16x16x32_bf16 v[112:115], v[120:123], v[64:67], v[112:115]
    ds_read_b128 a[96:99], v8 offset:8192
    v_exp_f32 v32, v32
    v_mfma_f32_16x16x32_bf16 a[0:3], a[64:67], v[64:67], a[0:3]
    s_add_u32 s50, s58, 122880
    ds_read_b128 a[100:103], v9 offset:8192
    v_mfma_f32_16x16x32_bf16 a[4:7], a[68:71], v[64:67], a[4:7]
    v_exp_f32 v33, v33
    v_mfma_f32_16x16x32_bf16 a[8:11], a[72:75], v[64:67], a[8:11]
    ds_read_b128 a[104:107], v10 offset:8192
    v_mfma_f32_16x16x32_bf16 a[12:15], a[76:79], v[64:67], a[12:15]
    s_add_u32 m0, s57, 57344
    v_exp_f32 v34, v34
    v_mfma_f32_16x16x32_bf16 a[16:19], a[80:83], v[64:67], a[16:19]
    ds_read_b128 a[108:111], v11 offset:8192
    v_cvt_pk_bf16_f32 v32, v32, v33
    v_mfma_f32_16x16x32_bf16 a[20:23], a[84:87], v[64:67], a[20:23]
    ds_read_b128 a[112:115], v8 offset:12288
    v_mfma_f32_16x16x32_bf16 a[24:27], a[88:91], v[64:67], a[24:27]
    s_and_b32 s50, s50, 0x1ffff
    v_exp_f32 v35, v35
    v_mfma_f32_16x16x32_bf16 a[28:31], a[92:95], v[64:67], a[28:31]
    ds_read_b128 a[116:119], v9 offset:12288
    v_exp_f32 v36, v36
    v_mfma_f32_16x16x32_bf16 v[112:115], v[124:127], v[72:75], v[112:115]
    v_exp_f32 v37, v37
    v_mfma_f32_16x16x32_bf16 a[32:35], a[64:67], v[72:75], a[32:35]
    buffer_load_dwordx4 v20, s[28:31], s50 offen offset:0 nt lds
    v_mfma_f32_16x16x32_bf16 a[36:39], a[68:71], v[72:75], a[36:39]
    ds_read_b128 a[120:123], v10 offset:12288
    v_cvt_pk_bf16_f32 v33, v34, v35
    v_mfma_f32_16x16x32_bf16 a[40:43], a[72:75], v[72:75], a[40:43]
    ds_read_b128 a[124:127], v11 offset:12288
    v_mfma_f32_16x16x32_bf16 a[44:47], a[76:79], v[72:75], a[44:47]
    v_exp_f32 v38, v38
    v_mfma_f32_16x16x32_bf16 a[48:51], a[80:83], v[72:75], a[48:51]
    buffer_load_dwordx4 v21, s[28:31], s50 offen offset:1024 nt lds
    v_mfma_f32_16x16x32_bf16 a[52:55], a[84:87], v[72:75], a[52:55]
    s_waitcnt vmcnt(11)
    ds_read_b64_tr_b16 a[144:145], v24 offset:16384
    v_cvt_pk_bf16_f32 v34, v36, v37
    v_mfma_f32_16x16x32_bf16 a[56:59], a[88:91], v[72:75], a[56:59]
    v_exp_f32 v39, v39
    v_mfma_f32_16x16x32_bf16 a[60:63], a[92:95], v[72:75], a[60:63]
    s_add_u32 s50, s58, 106496
    ds_read_b64_tr_b16 a[146:147], v24 offset:18432
    v_mfma_f32_16x16x32_bf16 v[116:119], v[120:123], v[80:83], v[116:119]
    ds_read_b64_tr_b16 a[148:149], v25 offset:16384
    v_exp_f32 v40, v40
    v_mfma_f32_16x16x32_bf16 v[192:195], a[64:67], v[80:83], v[192:195]
    v_exp_f32 v41, v41
    v_mfma_f32_16x16x32_bf16 v[196:199], a[68:71], v[80:83], v[196:199]
    s_add_u32 m0, s57, 106496
    ds_read_b64_tr_b16 a[150:151], v25 offset:18432
    v_cvt_pk_bf16_f32 v35, v38, v39
    v_mfma_f32_16x16x32_bf16 v[200:203], a[72:75], v[80:83], v[200:203]
    v_exp_f32 v42, v42
    v_mfma_f32_16x16x32_bf16 v[204:207], a[76:79], v[80:83], v[204:207]
    ds_read_b64_tr_b16 a[152:153], v26 offset:16384
    v_cvt_pk_bf16_f32 v40, v40, v41
    v_mfma_f32_16x16x32_bf16 v[208:211], a[80:83], v[80:83], v[208:211]
    ds_read_b64_tr_b16 a[154:155], v26 offset:18432
    v_mfma_f32_16x16x32_bf16 v[212:215], a[84:87], v[80:83], v[212:215]
    s_and_b32 s50, s50, 0x1ffff
    v_exp_f32 v43, v43
    v_mfma_f32_16x16x32_bf16 v[216:219], a[88:91], v[80:83], v[216:219]
    ds_read_b64_tr_b16 a[156:157], v27 offset:16384
    v_mfma_f32_16x16x32_bf16 v[220:223], a[92:95], v[80:83], v[220:223]
    v_exp_f32 v44, v44
    v_mfma_f32_16x16x32_bf16 v[116:119], v[124:127], v[88:91], v[116:119]
    buffer_load_dwordx4 v22, s[32:35], s50 offen offset:0 nt lds
    v_mfma_f32_16x16x32_bf16 v[224:227], a[64:67], v[88:91], v[224:227]
    ds_read_b64_tr_b16 a[158:159], v27 offset:18432
    v_cvt_pk_bf16_f32 v41, v42, v43
    v_mfma_f32_16x16x32_bf16 v[228:231], a[68:71], v[88:91], v[228:231]
    v_exp_f32 v45, v45
    v_mfma_f32_16x16x32_bf16 v[232:235], a[72:75], v[88:91], v[232:235]
    buffer_load_dwordx4 v23, s[32:35], s50 offen offset:1024 nt lds
    v_mfma_f32_16x16x32_bf16 v[236:239], a[76:79], v[88:91], v[236:239]
    v_exp_f32 v46, v46
    v_mfma_f32_16x16x32_bf16 v[240:243], a[80:83], v[88:91], v[240:243]
    v_exp_f32 v47, v47
    v_mfma_f32_16x16x32_bf16 v[244:247], a[84:87], v[88:91], v[244:247]
    v_exp_f32 v48, v48
    v_mfma_f32_16x16x32_bf16 v[248:251], a[88:91], v[88:91], v[248:251]
    v_exp_f32 v49, v49
    v_mfma_f32_16x16x32_bf16 v[252:255], a[92:95], v[88:91], v[252:255]
    s_waitcnt lgkmcnt(0)
    v_exp_f32 v50, v50
    v_mfma_f32_16x16x32_bf16 v[64:67], a[96:99], v[128:131], v[96:99]
    ds_read_b64_tr_b16 a[64:65], v12 offset:0
    v_exp_f32 v51, v51
    v_mfma_f32_16x16x32_bf16 v[64:67], a[100:103], v[132:135], v[64:67]
    s_add_u32 s49, s8, 3
    ds_read_b64_tr_b16 a[66:67], v12 offset:4096
    v_cvt_pk_bf16_f32 v42, v44, v45
    v_mfma_f32_16x16x32_bf16 v[64:67], a[104:107], v[136:139], v[64:67]
    ds_read_b64_tr_b16 a[68:69], v13 offset:0
    v_cvt_pk_bf16_f32 v43, v46, v47
    v_mfma_f32_16x16x32_bf16 v[64:67], a[108:111], v[140:143], v[64:67]
    v_exp_f32 v52, v52
    v_mfma_f32_16x16x32_bf16 v[68:71], a[112:115], v[128:131], v[96:99]
    s_and_b32 s49, s49, 31
    ds_read_b64_tr_b16 a[70:71], v13 offset:4096
    v_cvt_pk_bf16_f32 v48, v48, v49
    v_mfma_f32_16x16x32_bf16 v[68:71], a[116:119], v[132:135], v[68:71]
    ds_read_b64_tr_b16 a[72:73], v14 offset:0
    v_cvt_pk_bf16_f32 v49, v50, v51
    v_mfma_f32_16x16x32_bf16 v[68:71], a[120:123], v[136:139], v[68:71]
    v_exp_f32 v53, v53
    v_mfma_f32_16x16x32_bf16 v[68:71], a[124:127], v[140:143], v[68:71]
    s_add_u32 m0, s56, 147456
    ds_read_b64_tr_b16 a[74:75], v14 offset:4096
    v_exp_f32 v54, v54
    v_mfma_f32_16x16x32_bf16 v[72:75], a[96:99], v[144:147], v[100:103]
    ds_read_b64_tr_b16 a[76:77], v15 offset:0
    v_cvt_pk_bf16_f32 v50, v52, v53
    v_mfma_f32_16x16x32_bf16 v[72:75], a[100:103], v[148:151], v[72:75]
    v_exp_f32 v55, v55
    v_mfma_f32_16x16x32_bf16 v[72:75], a[104:107], v[152:155], v[72:75]
    ds_read_b64_tr_b16 a[78:79], v15 offset:4096
    v_mfma_f32_16x16x32_bf16 v[72:75], a[108:111], v[156:159], v[72:75]
    s_lshl_b32 s52, s49, 15
    ds_read_b64_tr_b16 a[80:81], v16 offset:0
    v_mfma_f32_16x16x32_bf16 v[76:79], a[112:115], v[144:147], v[100:103]
    ds_read_b64_tr_b16 a[82:83], v16 offset:4096
    v_mfma_f32_16x16x32_bf16 v[76:79], a[116:119], v[148:151], v[76:79]
    v_exp_f32 v56, v56
    v_mfma_f32_16x16x32_bf16 v[76:79], a[120:123], v[152:155], v[76:79]
    buffer_load_dwordx4 v28, s[68:71], s52 offen offset:0 lds
    v_mfma_f32_16x16x32_bf16 v[76:79], a[124:127], v[156:159], v[76:79]
    ds_read_b64_tr_b16 a[84:85], v17 offset:0
    v_exp_f32 v57, v57
    v_mfma_f32_16x16x32_bf16 v[80:83], a[96:99], v[160:163], v[104:107]
    ds_read_b64_tr_b16 a[86:87], v17 offset:4096
    v_cvt_pk_bf16_f32 v51, v54, v55
    v_mfma_f32_16x16x32_bf16 v[80:83], a[100:103], v[164:167], v[80:83]
    v_exp_f32 v58, v58
    v_mfma_f32_16x16x32_bf16 v[80:83], a[104:107], v[168:171], v[80:83]
    s_add_u32 s53, s52, 14336
    ds_read_b64_tr_b16 a[88:89], v18 offset:0
    v_cvt_pk_bf16_f32 v56, v56, v57
    v_mfma_f32_16x16x32_bf16 v[80:83], a[108:111], v[172:175], v[80:83]
    ds_read_b64_tr_b16 a[90:91], v18 offset:4096
    v_mfma_f32_16x16x32_bf16 v[84:87], a[112:115], v[160:163], v[104:107]
    v_exp_f32 v59, v59
    v_mfma_f32_16x16x32_bf16 v[84:87], a[116:119], v[164:167], v[84:87]
    buffer_load_dwordx4 v29, s[68:71], s52 offen offset:1024 lds
    v_mfma_f32_16x16x32_bf16 v[84:87], a[120:123], v[168:171], v[84:87]
    ds_read_b64_tr_b16 a[92:93], v19 offset:0
    v_mfma_f32_16x16x32_bf16 v[84:87], a[124:127], v[172:175], v[84:87]
    ds_read_b64_tr_b16 a[94:95], v19 offset:4096
    v_mfma_f32_16x16x32_bf16 v[88:91], a[96:99], v[176:179], v[108:111]
    v_exp_f32 v60, v60
    v_mfma_f32_16x16x32_bf16 v[88:91], a[100:103], v[180:183], v[88:91]
    buffer_load_dwordx4 v28, s[68:71], s53 offen offset:2048 lds
    v_mfma_f32_16x16x32_bf16 v[88:91], a[104:107], v[184:187], v[88:91]
    v_exp_f32 v61, v61
    v_mfma_f32_16x16x32_bf16 v[88:91], a[108:111], v[188:191], v[88:91]
    v_exp_f32 v62, v62
    v_mfma_f32_16x16x32_bf16 v[92:95], a[112:115], v[176:179], v[108:111]
    buffer_load_dwordx4 v29, s[68:71], s53 offen offset:3072 lds
    v_mfma_f32_16x16x32_bf16 v[92:95], a[116:119], v[180:183], v[92:95]
    v_exp_f32 v63, v63
    v_mfma_f32_16x16x32_bf16 v[92:95], a[120:123], v[184:187], v[92:95]
    v_cvt_pk_bf16_f32 v57, v58, v59
    v_cvt_pk_bf16_f32 v58, v60, v61
    s_nop 0
    v_cvt_pk_bf16_f32 v59, v62, v63
    v_mfma_f32_16x16x32_bf16 v[92:95], a[124:127], v[188:191], v[92:95]
    s_waitcnt lgkmcnt(0)
    s_barrier
    v_mfma_f32_16x16x32_bf16 v[112:115], v[120:123], v[32:35], v[112:115]
    ds_read_b128 a[96:99], v8 offset:16384
    v_exp_f32 v64, v64
    v_mfma_f32_16x16x32_bf16 a[0:3], a[64:67], v[32:35], a[0:3]
    s_add_u32 s50, s58, 114688
    ds_read_b128 a[100:103], v9 offset:16384
    v_mfma_f32_16x16x32_bf16 a[4:7], a[68:71], v[32:35], a[4:7]
    v_exp_f32 v65, v65
    v_mfma_f32_16x16x32_bf16 a[8:11], a[72:75], v[32:35], a[8:11]
    ds_read_b128 a[104:107], v10 offset:16384
    v_mfma_f32_16x16x32_bf16 a[12:15], a[76:79], v[32:35], a[12:15]
    v_exp_f32 v66, v66
    v_mfma_f32_16x16x32_bf16 a[16:19], a[80:83], v[32:35], a[16:19]
    ds_read_b128 a[108:111], v11 offset:16384
    v_cvt_pk_bf16_f32 v64, v64, v65
    v_mfma_f32_16x16x32_bf16 a[20:23], a[84:87], v[32:35], a[20:23]
    v_exp_f32 v67, v67
    v_mfma_f32_16x16x32_bf16 a[24:27], a[88:91], v[32:35], a[24:27]
    s_add_u32 m0, s57, 114688
    ds_read_b128 a[112:115], v8 offset:20480
    v_exp_f32 v68, v68
    v_mfma_f32_16x16x32_bf16 a[28:31], a[92:95], v[32:35], a[28:31]
    ds_read_b128 a[116:119], v9 offset:20480
    v_cvt_pk_bf16_f32 v65, v66, v67
    v_mfma_f32_16x16x32_bf16 v[112:115], v[124:127], v[40:43], v[112:115]
    v_exp_f32 v69, v69
    v_mfma_f32_16x16x32_bf16 a[32:35], a[64:67], v[40:43], a[32:35]
    ds_read_b128 a[120:123], v10 offset:20480
    v_mfma_f32_16x16x32_bf16 a[36:39], a[68:71], v[40:43], a[36:39]
    v_exp_f32 v70, v70
    v_mfma_f32_16x16x32_bf16 a[40:43], a[72:75], v[40:43], a[40:43]
    ds_read_b128 a[124:127], v11 offset:20480
    v_cvt_pk_bf16_f32 v66, v68, v69
    v_mfma_f32_16x16x32_bf16 a[44:47], a[76:79], v[40:43], a[44:47]
    v_exp_f32 v71, v71
    v_mfma_f32_16x16x32_bf16 a[48:51], a[80:83], v[40:43], a[48:51]
    s_and_b32 s50, s50, 0x1ffff
    s_waitcnt vmcnt(9)
    ds_read_b64_tr_b16 a[160:161], v24 offset:0
    v_exp_f32 v72, v72
    v_mfma_f32_16x16x32_bf16 a[52:55], a[84:87], v[40:43], a[52:55]
    ds_read_b64_tr_b16 a[162:163], v24 offset:2048
    v_cvt_pk_bf16_f32 v67, v70, v71
    v_mfma_f32_16x16x32_bf16 a[56:59], a[88:91], v[40:43], a[56:59]
    v_exp_f32 v73, v73
    v_mfma_f32_16x16x32_bf16 a[60:63], a[92:95], v[40:43], a[60:63]
    ds_read_b64_tr_b16 a[164:165], v25 offset:0
    v_mfma_f32_16x16x32_bf16 v[116:119], v[120:123], v[48:51], v[116:119]
    v_exp_f32 v74, v74
    v_mfma_f32_16x16x32_bf16 v[192:195], a[64:67], v[48:51], v[192:195]
    ds_read_b64_tr_b16 a[166:167], v25 offset:2048
    v_cvt_pk_bf16_f32 v72, v72, v73
    v_mfma_f32_16x16x32_bf16 v[196:199], a[68:71], v[48:51], v[196:199]
    buffer_load_dwordx4 v22, s[32:35], s50 offen offset:0 nt lds
    v_mfma_f32_16x16x32_bf16 v[200:203], a[72:75], v[48:51], v[200:203]
    v_exp_f32 v75, v75
    v_mfma_f32_16x16x32_bf16 v[204:207], a[76:79], v[48:51], v[204:207]
    ds_read_b64_tr_b16 a[168:169], v26 offset:0
    v_exp_f32 v76, v76
    v_mfma_f32_16x16x32_bf16 v[208:211], a[80:83], v[48:51], v[208:211]
    ds_read_b64_tr_b16 a[170:171], v26 offset:2048
    v_cvt_pk_bf16_f32 v73, v74, v75
    v_mfma_f32_16x16x32_bf16 v[212:215], a[84:87], v[48:51], v[212:215]
    v_exp_f32 v77, v77
    v_mfma_f32_16x16x32_bf16 v[216:219], a[88:91], v[48:51], v[216:219]
    ds_read_b64_tr_b16 a[172:173], v27 offset:0
    v_mfma_f32_16x16x32_bf16 v[220:223], a[92:95], v[48:51], v[220:223]
    v_exp_f32 v78, v78
    v_mfma_f32_16x16x32_bf16 v[116:119], v[124:127], v[56:59], v[116:119]
    buffer_load_dwordx4 v23, s[32:35], s50 offen offset:1024 nt lds
    v_mfma_f32_16x16x32_bf16 v[224:227], a[64:67], v[56:59], v[224:227]
    ds_read_b64_tr_b16 a[174:175], v27 offset:2048
    v_cvt_pk_bf16_f32 v74, v76, v77
    v_mfma_f32_16x16x32_bf16 v[228:231], a[68:71], v[56:59], v[228:231]
    v_exp_f32 v79, v79
    v_mfma_f32_16x16x32_bf16 v[232:235], a[72:75], v[56:59], v[232:235]
    v_exp_f32 v80, v80
    v_mfma_f32_16x16x32_bf16 v[236:239], a[76:79], v[56:59], v[236:239]
    v_exp_f32 v81, v81
    v_mfma_f32_16x16x32_bf16 v[240:243], a[80:83], v[56:59], v[240:243]
    v_exp_f32 v82, v82
    v_mfma_f32_16x16x32_bf16 v[244:247], a[84:87], v[56:59], v[244:247]
    v_exp_f32 v83, v83
    v_mfma_f32_16x16x32_bf16 v[248:251], a[88:91], v[56:59], v[248:251]
    v_exp_f32 v84, v84
    v_mfma_f32_16x16x32_bf16 v[252:255], a[92:95], v[56:59], v[252:255]
    s_waitcnt lgkmcnt(0)
    v_exp_f32 v85, v85
    v_mfma_f32_16x16x32_bf16 v[32:35], a[96:99], v[128:131], v[96:99]
    ds_read_b64_tr_b16 a[64:65], v12 offset:8192
    v_exp_f32 v86, v86
    v_mfma_f32_16x16x32_bf16 v[32:35], a[100:103], v[132:135], v[32:35]
    s_add_u32 s49, s8, 4
    ds_read_b64_tr_b16 a[66:67], v12 offset:12288
    v_cvt_pk_bf16_f32 v75, v78, v79
    v_mfma_f32_16x16x32_bf16 v[32:35], a[104:107], v[136:139], v[32:35]
    s_and_b32 s49, s49, 31
    ds_read_b64_tr_b16 a[68:69], v13 offset:8192
    v_cvt_pk_bf16_f32 v80, v80, v81
    v_mfma_f32_16x16x32_bf16 v[32:35], a[108:111], v[140:143], v[32:35]
    s_add_u32 m0, s56, 0
    ds_read_b64_tr_b16 a[70:71], v13 offset:12288
    v_cvt_pk_bf16_f32 v81, v82, v83
    v_mfma_f32_16x16x32_bf16 v[36:39], a[112:115], v[128:131], v[96:99]
    s_lshl_b32 s52, s49, 15
    ds_read_b64_tr_b16 a[72:73], v14 offset:8192
    v_exp_f32 v87, v87
    v_mfma_f32_16x16x32_bf16 v[36:39], a[116:119], v[132:135], v[36:39]
    ds_read_b64_tr_b16 a[74:75], v14 offset:12288
    v_cvt_pk_bf16_f32 v82, v84, v85
    v_mfma_f32_16x16x32_bf16 v[36:39], a[120:123], v[136:139], v[36:39]
    buffer_load_dwordx4 v28, s[68:71], s52 offen offset:0 lds
    v_mfma_f32_16x16x32_bf16 v[36:39], a[124:127], v[140:143], v[36:39]
    s_add_u32 s53, s52, 14336
    ds_read_b64_tr_b16 a[76:77], v15 offset:8192
    v_mfma_f32_16x16x32_bf16 v[40:43], a[96:99], v[144:147], v[100:103]
    buffer_load_dwordx4 v29, s[68:71], s52 offen offset:1024 lds
    v_mfma_f32_16x16x32_bf16 v[40:43], a[100:103], v[148:151], v[40:43]
    ds_read_b64_tr_b16 a[78:79], v15 offset:12288
    v_mfma_f32_16x16x32_bf16 v[40:43], a[104:107], v[152:155], v[40:43]
    buffer_load_dwordx4 v28, s[68:71], s53 offen offset:2048 lds
    v_mfma_f32_16x16x32_bf16 v[40:43], a[108:111], v[156:159], v[40:43]
    buffer_load_dwordx4 v29, s[68:71], s53 offen offset:3072 lds
    v_mfma_f32_16x16x32_bf16 v[44:47], a[112:115], v[144:147], v[100:103]
    s_add_u32 s49, s8, 5
    v_exp_f32 v88, v88
    v_mfma_f32_16x16x32_bf16 v[44:47], a[116:119], v[148:151], v[44:47]
    s_and_b32 s49, s49, 31
    ds_read_b64_tr_b16 a[80:81], v16 offset:8192
    v_exp_f32 v89, v89
    v_mfma_f32_16x16x32_bf16 v[44:47], a[120:123], v[152:155], v[44:47]
    ds_read_b64_tr_b16 a[82:83], v16 offset:12288
    v_cvt_pk_bf16_f32 v83, v86, v87
    v_mfma_f32_16x16x32_bf16 v[44:47], a[124:127], v[156:159], v[44:47]
    s_add_u32 m0, s56, 131072
    ds_read_b64_tr_b16 a[84:85], v17 offset:8192
    v_mfma_f32_16x16x32_bf16 v[48:51], a[96:99], v[160:163], v[104:107]
    s_lshl_b32 s52, s49, 15
    ds_read_b64_tr_b16 a[86:87], v17 offset:12288
    v_mfma_f32_16x16x32_bf16 v[48:51], a[100:103], v[164:167], v[48:51]
    buffer_load_dwordx4 v28, s[68:71], s52 offen offset:0 lds
    v_mfma_f32_16x16x32_bf16 v[48:51], a[104:107], v[168:171], v[48:51]
    ds_read_b64_tr_b16 a[88:89], v18 offset:8192
    v_exp_f32 v90, v90
    v_mfma_f32_16x16x32_bf16 v[48:51], a[108:111], v[172:175], v[48:51]
    s_add_u32 s53, s52, 14336
    ds_read_b64_tr_b16 a[90:91], v18 offset:12288
    v_cvt_pk_bf16_f32 v88, v88, v89
    v_mfma_f32_16x16x32_bf16 v[52:55], a[112:115], v[160:163], v[104:107]
    buffer_load_dwordx4 v29, s[68:71], s52 offen offset:1024 lds
    v_mfma_f32_16x16x32_bf16 v[52:55], a[116:119], v[164:167], v[52:55]
    buffer_load_dwordx4 v28, s[68:71], s53 offen offset:2048 lds
    v_mfma_f32_16x16x32_bf16 v[52:55], a[120:123], v[168:171], v[52:55]
    buffer_load_dwordx4 v29, s[68:71], s53 offen offset:3072 lds
    v_mfma_f32_16x16x32_bf16 v[52:55], a[124:127], v[172:175], v[52:55]
    ds_read_b64_tr_b16 a[92:93], v19 offset:8192
    v_mfma_f32_16x16x32_bf16 v[56:59], a[96:99], v[176:179], v[108:111]
    s_lshr_b32 s51, s2, 4
    ds_read_b64_tr_b16 a[94:95], v19 offset:12288
    v_mfma_f32_16x16x32_bf16 v[56:59], a[100:103], v[180:183], v[56:59]
    s_add_u32 s51, s51, s8
    v_exp_f32 v91, v91
    v_mfma_f32_16x16x32_bf16 v[56:59], a[104:107], v[184:187], v[56:59]
    s_add_u32 s51, s51, 16
    v_exp_f32 v92, v92
    v_mfma_f32_16x16x32_bf16 v[56:59], a[108:111], v[188:191], v[56:59]
    v_exp_f32 v93, v93
    v_mfma_f32_16x16x32_bf16 v[60:63], a[112:115], v[176:179], v[108:111]
    s_and_b32 s51, s51, 31
    v_exp_f32 v94, v94
    v_mfma_f32_16x16x32_bf16 v[60:63], a[116:119], v[180:183], v[60:63]
    s_lshl_b32 s51, s51, 15
    v_exp_f32 v95, v95
    v_mfma_f32_16x16x32_bf16 v[60:63], a[120:123], v[184:187], v[60:63]
    buffer_load_dword v6, v31, s[12:15], s51 offen
    v_cvt_pk_bf16_f32 v89, v90, v91
    v_cvt_pk_bf16_f32 v90, v92, v93
    s_nop 0
    v_cvt_pk_bf16_f32 v91, v94, v95
    v_mfma_f32_16x16x32_bf16 v[60:63], a[124:127], v[188:191], v[60:63]
    s_waitcnt lgkmcnt(0)
    v_mfma_f32_16x16x32_bf16 v[112:115], v[120:123], v[64:67], v[112:115]
    ds_read_b128 a[96:99], v8 offset:24576
    v_exp_f32 v32, v32
    v_mfma_f32_16x16x32_bf16 a[0:3], a[64:67], v[64:67], a[0:3]
    s_add_u32 s50, s58, 122880
    ds_read_b128 a[100:103], v9 offset:24576
    v_mfma_f32_16x16x32_bf16 a[4:7], a[68:71], v[64:67], a[4:7]
    v_exp_f32 v33, v33
    v_mfma_f32_16x16x32_bf16 a[8:11], a[72:75], v[64:67], a[8:11]
    ds_read_b128 a[104:107], v10 offset:24576
    v_mfma_f32_16x16x32_bf16 a[12:15], a[76:79], v[64:67], a[12:15]
    v_exp_f32 v34, v34
    v_mfma_f32_16x16x32_bf16 a[16:19], a[80:83], v[64:67], a[16:19]
    ds_read_b128 a[108:111], v11 offset:24576
    v_cvt_pk_bf16_f32 v32, v32, v33
    v_mfma_f32_16x16x32_bf16 a[20:23], a[84:87], v[64:67], a[20:23]
    v_exp_f32 v35, v35
    v_mfma_f32_16x16x32_bf16 a[24:27], a[88:91], v[64:67], a[24:27]
    s_add_u32 m0, s57, 122880
    ds_read_b128 a[112:115], v8 offset:28672
    v_mfma_f32_16x16x32_bf16 a[28:31], a[92:95], v[64:67], a[28:31]
    ds_read_b128 a[116:119], v9 offset:28672
    v_mfma_f32_16x16x32_bf16 v[112:115], v[124:127], v[72:75], v[112:115]
    v_exp_f32 v36, v36
    v_mfma_f32_16x16x32_bf16 a[32:35], a[64:67], v[72:75], a[32:35]
    ds_read_b128 a[120:123], v10 offset:28672
    v_cvt_pk_bf16_f32 v33, v34, v35
    v_mfma_f32_16x16x32_bf16 a[36:39], a[68:71], v[72:75], a[36:39]
    v_exp_f32 v37, v37
    v_mfma_f32_16x16x32_bf16 a[40:43], a[72:75], v[72:75], a[40:43]
    ds_read_b128 a[124:127], v11 offset:28672
    v_mfma_f32_16x16x32_bf16 a[44:47], a[76:79], v[72:75], a[44:47]
    v_exp_f32 v38, v38
    v_mfma_f32_16x16x32_bf16 a[48:51], a[80:83], v[72:75], a[48:51]
    s_and_b32 s50, s50, 0x1ffff
    s_waitcnt vmcnt(11)
    ds_read_b64_tr_b16 a[176:177], v24 offset:16384
    v_exp_f32 v39, v39
    v_mfma_f32_16x16x32_bf16 a[52:55], a[84:87], v[72:75], a[52:55]
    ds_read_b64_tr_b16 a[178:179], v24 offset:18432
    v_cvt_pk_bf16_f32 v34, v36, v37
    v_mfma_f32_16x16x32_bf16 a[56:59], a[88:91], v[72:75], a[56:59]
    v_exp_f32 v40, v40
    v_mfma_f32_16x16x32_bf16 a[60:63], a[92:95], v[72:75], a[60:63]
    ds_read_b64_tr_b16 a[180:181], v25 offset:16384
    v_cvt_pk_bf16_f32 v35, v38, v39
    v_mfma_f32_16x16x32_bf16 v[116:119], v[120:123], v[80:83], v[116:119]
    v_exp_f32 v41, v41
    v_mfma_f32_16x16x32_bf16 v[192:195], a[64:67], v[80:83], v[192:195]
    ds_read_b64_tr_b16 a[182:183], v25 offset:18432
    v_mfma_f32_16x16x32_bf16 v[196:199], a[68:71], v[80:83], v[196:199]
    buffer_load_dwordx4 v22, s[32:35], s50 offen offset:0 nt lds
    v_mfma_f32_16x16x32_bf16 v[200:203], a[72:75], v[80:83], v[200:203]
    v_exp_f32 v42, v42
    v_mfma_f32_16x16x32_bf16 v[204:207], a[76:79], v[80:83], v[204:207]
    ds_read_b64_tr_b16 a[184:185], v26 offset:16384
    v_cvt_pk_bf16_f32 v40, v40, v41
    v_mfma_f32_16x16x32_bf16 v[208:211], a[80:83], v[80:83], v[208:211]
    ds_read_b64_tr_b16 a[186:187], v26 offset:18432
    v_mfma_f32_16x16x32_bf16 v[212:215], a[84:87], v[80:83], v[212:215]
    v_exp_f32 v43, v43
    v_mfma_f32_16x16x32_bf16 v[216:219], a[88:91], v[80:83], v[216:219]
    ds_read_b64_tr_b16 a[188:189], v27 offset:16384
    v_mfma_f32_16x16x32_bf16 v[220:223], a[92:95], v[80:83], v[220:223]
    v_exp_f32 v44, v44
    v_mfma_f32_16x16x32_bf16 v[116:119], v[124:127], v[88:91], v[116:119]
    buffer_load_dwordx4 v23, s[32:35], s50 offen offset:1024 nt lds
    v_mfma_f32_16x16x32_bf16 v[224:227], a[64:67], v[88:91], v[224:227]
    ds_read_b64_tr_b16 a[190:191], v27 offset:18432
    v_cvt_pk_bf16_f32 v41, v42, v43
    v_mfma_f32_16x16x32_bf16 v[228:231], a[68:71], v[88:91], v[228:231]
    v_exp_f32 v45, v45
    v_mfma_f32_16x16x32_bf16 v[232:235], a[72:75], v[88:91], v[232:235]
    v_exp_f32 v46, v46
    v_mfma_f32_16x16x32_bf16 v[236:239], a[76:79], v[88:91], v[236:239]
    v_exp_f32 v47, v47
    v_mfma_f32_16x16x32_bf16 v[240:243], a[80:83], v[88:91], v[240:243]
    v_exp_f32 v48, v48
    v_mfma_f32_16x16x32_bf16 v[244:247], a[84:87], v[88:91], v[244:247]
    v_exp_f32 v49, v49
    v_mfma_f32_16x16x32_bf16 v[248:251], a[88:91], v[88:91], v[248:251]
    v_exp_f32 v50, v50
    v_mfma_f32_16x16x32_bf16 v[252:255], a[92:95], v[88:91], v[252:255]
    s_waitcnt lgkmcnt(0)
    v_exp_f32 v51, v51
    v_mfma_f32_16x16x32_bf16 v[64:67], a[96:99], v[128:131], v[96:99]
    ds_read_b64_tr_b16 a[64:65], v12 offset:16384
    v_exp_f32 v52, v52
    v_mfma_f32_16x16x32_bf16 v[64:67], a[100:103], v[132:135], v[64:67]
    s_add_u32 s49, s8, 6
    ds_read_b64_tr_b16 a[66:67], v12 offset:20480
    v_cvt_pk_bf16_f32 v42, v44, v45
    v_mfma_f32_16x16x32_bf16 v[64:67], a[104:107], v[136:139], v[64:67]
    ds_read_b64_tr_b16 a[68:69], v13 offset:16384
    v_cvt_pk_bf16_f32 v43, v46, v47
    v_mfma_f32_16x16x32_bf16 v[64:67], a[108:111], v[140:143], v[64:67]
    v_exp_f32 v53, v53
    v_mfma_f32_16x16x32_bf16 v[68:71], a[112:115], v[128:131], v[96:99]
    s_and_b32 s49, s49, 31
    ds_read_b64_tr_b16 a[70:71], v13 offset:20480
    v_cvt_pk_bf16_f32 v48, v48, v49
    v_mfma_f32_16x16x32_bf16 v[68:71], a[116:119], v[132:135], v[68:71]
    ds_read_b64_tr_b16 a[72:73], v14 offset:16384
    v_cvt_pk_bf16_f32 v49, v50, v51
    v_mfma_f32_16x16x32_bf16 v[68:71], a[120:123], v[136:139], v[68:71]
    v_exp_f32 v54, v54
    v_mfma_f32_16x16x32_bf16 v[68:71], a[124:127], v[140:143], v[68:71]
    s_add_u32 m0, s56, 147456
    ds_read_b64_tr_b16 a[74:75], v14 offset:20480
    v_cvt_pk_bf16_f32 v50, v52, v53
    v_mfma_f32_16x16x32_bf16 v[72:75], a[96:99], v[144:147], v[100:103]
    ds_read_b64_tr_b16 a[76:77], v15 offset:16384
    v_mfma_f32_16x16x32_bf16 v[72:75], a[100:103], v[148:151], v[72:75]
    v_exp_f32 v55, v55
    v_mfma_f32_16x16x32_bf16 v[72:75], a[104:107], v[152:155], v[72:75]
    ds_read_b64_tr_b16 a[78:79], v15 offset:20480
    v_mfma_f32_16x16x32_bf16 v[72:75], a[108:111], v[156:159], v[72:75]
    s_lshl_b32 s52, s49, 15
    ds_read_b64_tr_b16 a[80:81], v16 offset:16384
    v_exp_f32 v56, v56
    v_mfma_f32_16x16x32_bf16 v[76:79], a[112:115], v[144:147], v[100:103]
    ds_read_b64_tr_b16 a[82:83], v16 offset:20480
    v_cvt_pk_bf16_f32 v51, v54, v55
    v_mfma_f32_16x16x32_bf16 v[76:79], a[116:119], v[148:151], v[76:79]
    v_exp_f32 v57, v57
    v_mfma_f32_16x16x32_bf16 v[76:79], a[120:123], v[152:155], v[76:79]
    buffer_load_dwordx4 v28, s[68:71], s52 offen offset:0 lds
    v_mfma_f32_16x16x32_bf16 v[76:79], a[124:127], v[156:159], v[76:79]
    ds_read_b64_tr_b16 a[84:85], v17 offset:16384
    v_mfma_f32_16x16x32_bf16 v[80:83], a[96:99], v[160:163], v[104:107]
    ds_read_b64_tr_b16 a[86:87], v17 offset:20480
    v_mfma_f32_16x16x32_bf16 v[80:83], a[100:103], v[164:167], v[80:83]
    v_exp_f32 v58, v58
    v_mfma_f32_16x16x32_bf16 v[80:83], a[104:107], v[168:171], v[80:83]
    s_add_u32 s53, s52, 14336
    ds_read_b64_tr_b16 a[88:89], v18 offset:16384
    v_cvt_pk_bf16_f32 v56, v56, v57
    v_mfma_f32_16x16x32_bf16 v[80:83], a[108:111], v[172:175], v[80:83]
    ds_read_b64_tr_b16 a[90:91], v18 offset:20480
    v_mfma_f32_16x16x32_bf16 v[84:87], a[112:115], v[160:163], v[104:107]
    v_exp_f32 v59, v59
    v_mfma_f32_16x16x32_bf16 v[84:87], a[116:119], v[164:167], v[84:87]
    buffer_load_dwordx4 v29, s[68:71], s52 offen offset:1024 lds
    v_mfma_f32_16x16x32_bf16 v[84:87], a[120:123], v[168:171], v[84:87]
    ds_read_b64_tr_b16 a[92:93], v19 offset:16384
    v_mfma_f32_16x16x32_bf16 v[84:87], a[124:127], v[172:175], v[84:87]
    ds_read_b64_tr_b16 a[94:95], v19 offset:20480
    v_mfma_f32_16x16x32_bf16 v[88:91], a[96:99], v[176:179], v[108:111]
    v_exp_f32 v60, v60
    v_mfma_f32_16x16x32_bf16 v[88:91], a[100:103], v[180:183], v[88:91]
    buffer_load_dwordx4 v28, s[68:71], s53 offen offset:2048 lds
    v_mfma_f32_16x16x32_bf16 v[88:91], a[104:107], v[184:187], v[88:91]
    v_exp_f32 v61, v61
    v_mfma_f32_16x16x32_bf16 v[88:91], a[108:111], v[188:191], v[88:91]
    v_exp_f32 v62, v62
    v_mfma_f32_16x16x32_bf16 v[92:95], a[112:115], v[176:179], v[108:111]
    buffer_load_dwordx4 v29, s[68:71], s53 offen offset:3072 lds
    v_mfma_f32_16x16x32_bf16 v[92:95], a[116:119], v[180:183], v[92:95]
    v_exp_f32 v63, v63
    v_mfma_f32_16x16x32_bf16 v[92:95], a[120:123], v[184:187], v[92:95]
    v_cvt_pk_bf16_f32 v57, v58, v59
    v_cvt_pk_bf16_f32 v58, v60, v61
    s_nop 0
    v_cvt_pk_bf16_f32 v59, v62, v63
    v_mfma_f32_16x16x32_bf16 v[92:95], a[124:127], v[188:191], v[92:95]
    s_waitcnt lgkmcnt(0)
    s_barrier
    v_readfirstlane_b32 s90, v2
    v_readfirstlane_b32 s91, v3
    s_nop 2
    s_mov_b32 s48, 0x40000
L_tag:
    s_and_b32 s49, s90, 1
    s_cselect_b32 s49, s91, 0
    s_cmp_lg_u32 s49, 0
    s_cbranch_scc1 L_tagok
    buffer_load_dwordx2 v[2:3], off, s[80:83], 0 sc1
    s_waitcnt vmcnt(0)
    v_readfirstlane_b32 s90, v2
    v_readfirstlane_b32 s91, v3
    s_sub_u32 s48, s48, 1
    s_nop 2
    s_cbranch_scc0 L_tag
L_tagok:
    v_mfma_f32_16x16x32_bf16 v[112:115], v[120:123], v[32:35], v[112:115]
    ds_read_b128 a[96:99], v8 offset:32768
    v_exp_f32 v64, v64
    v_mfma_f32_16x16x32_bf16 a[0:3], a[64:67], v[32:35], a[0:3]
    ds_read_b128 a[100:103], v9 offset:32768
    v_mfma_f32_16x16x32_bf16 a[4:7], a[68:71], v[32:35], a[4:7]
    v_exp_f32 v65, v65
    v_mfma_f32_16x16x32_bf16 a[8:11], a[72:75], v[32:35], a[8:11]
    ds_read_b128 a[104:107], v10 offset:32768
    v_mfma_f32_16x16x32_bf16 a[12:15], a[76:79], v[32:35], a[12:15]
    v_exp_f32 v66, v66
    v_mfma_f32_16x16x32_bf16 a[16:19], a[80:83], v[32:35], a[16:19]
    ds_read_b128 a[108:111], v11 offset:32768
    v_cvt_pk_bf16_f32 v64, v64, v65
    v_mfma_f32_16x16x32_bf16 a[20:23], a[84:87], v[32:35], a[20:23]
    v_exp_f32 v67, v67
    v_mfma_f32_16x16x32_bf16 a[24:27], a[88:91], v[32:35], a[24:27]
    ds_read_b128 a[112:115], v8 offset:36864
    v_mfma_f32_16x16x32_bf16 a[28:31], a[92:95], v[32:35], a[28:31]
L_pad5:
    s_cbranch_execz L_ret1
    v_exp_f32 v68, v68
    v_mfma_f32_16x16x32_bf16 v[112:115], v[124:127], v[40:43], v[112:115]
    ds_read_b128 a[116:119], v9 offset:36864
    v_cvt_pk_bf16_f32 v65, v66, v67
    v_mfma_f32_16x16x32_bf16 a[32:35], a[64:67], v[40:43], a[32:35]
    v_exp_f32 v69, v69
    v_mfma_f32_16x16x32_bf16 a[36:39], a[68:71], v[40:43], a[36:39]
    ds_read_b128 a[120:123], v10 offset:36864
    v_exp_f32 v70, v70
    v_mfma_f32_16x16x32_bf16 a[40:43], a[72:75], v[40:43], a[40:43]
    v_exp_f32 v71, v71
    v_mfma_f32_16x16x32_bf16 a[44:47], a[76:79], v[40:43], a[44:47]
    ds_read_b128 a[124:127], v11 offset:36864
    v_cvt_pk_bf16_f32 v66, v68, v69
    v_mfma_f32_16x16x32_bf16 a[48:51], a[80:83], v[40:43], a[48:51]
    v_exp_f32 v72, v72
    v_mfma_f32_16x16x32_bf16 a[52:55], a[84:87], v[40:43], a[52:55]
    s_waitcnt vmcnt(7)
    ds_read_b64_tr_b16 a[192:193], v24 offset:0
    v_cvt_pk_bf16_f32 v67, v70, v71
    v_mfma_f32_16x16x32_bf16 a[56:59], a[88:91], v[40:43], a[56:59]
    ds_read_b64_tr_b16 a[194:195], v24 offset:2048
    v_mfma_f32_16x16x32_bf16 a[60:63], a[92:95], v[40:43], a[60:63]
    v_exp_f32 v73, v73
    v_mfma_f32_16x16x32_bf16 v[116:119], v[120:123], v[48:51], v[116:119]
    ds_read_b64_tr_b16 a[196:197], v25 offset:0
    v_mfma_f32_16x16x32_bf16 v[192:195], a[64:67], v[48:51], v[192:195]
    v_exp_f32 v74, v74
    v_mfma_f32_16x16x32_bf16 v[196:199], a[68:71], v[48:51], v[196:199]
    ds_read_b64_tr_b16 a[198:199], v25 offset:2048
    v_cvt_pk_bf16_f32 v72, v72, v73
    v_mfma_f32_16x16x32_bf16 v[200:203], a[72:75], v[48:51], v[200:203]
    v_exp_f32 v75, v75
    v_mfma_f32_16x16x32_bf16 v[204:207], a[76:79], v[48:51], v[204:207]
    ds_read_b64_tr_b16 a[200:201], v26 offset:0
    v_exp_f32 v76, v76
    v_mfma_f32_16x16x32_bf16 v[208:211], a[80:83], v[48:51], v[208:211]
    v_exp_f32 v77, v77
    v_mfma_f32_16x16x32_bf16 v[212:215], a[84:87], v[48:51], v[212:215]
    ds_read_b64_tr_b16 a[202:203], v26 offset:2048
    v_cvt_pk_bf16_f32 v73, v74, v75
    v_mfma_f32_16x16x32_bf16 v[216:219], a[88:91], v[48:51], v[216:219]
    v_exp_f32 v78, v78
    v_mfma_f32_16x16x32_bf16 v[220:223], a[92:95], v[48:51], v[220:223]
    ds_read_b64_tr_b16 a[204:205], v27 offset:0
    v_cvt_pk_bf16_f32 v74, v76, v77
    v_mfma_f32_16x16x32_bf16 v[116:119], v[124:127], v[56:59], v[116:119]
    v_exp_f32 v79, v79
    v_mfma_f32_16x16x32_bf16 v[224:227], a[64:67], v[56:59], v[224:227]
    ds_read_b64_tr_b16 a[206:207], v27 offset:2048
    v_mfma_f32_16x16x32_bf16 v[228:231], a[68:71], v[56:59], v[228:231]
    v_exp_f32 v80, v80
    v_mfma_f32_16x16x32_bf16 v[232:235], a[72:75], v[56:59], v[232:235]
    v_exp_f32 v81, v81
    v_mfma_f32_16x16x32_bf16 v[236:239], a[76:79], v[56:59], v[236:239]
    v_exp_f32 v82, v82
    v_mfma_f32_16x16x32_bf16 v[240:243], a[80:83], v[56:59], v[240:243]
    v_exp_f32 v83, v83
    v_mfma_f32_16x16x32_bf16 v[244:247], a[84:87], v[56:59], v[244:247]
    v_exp_f32 v84, v84
    v_mfma_f32_16x16x32_bf16 v[248:251], a[88:91], v[56:59], v[248:251]
    v_exp_f32 v85, v85
    v_mfma_f32_16x16x32_bf16 v[252:255], a[92:95], v[56:59], v[252:255]
    s_waitcnt lgkmcnt(0)
    v_exp_f32 v86, v86
    v_mfma_f32_16x16x32_bf16 v[32:35], a[96:99], v[128:131], v[96:99]
    ds_read_b64_tr_b16 a[64:65], v12 offset:24576
    v_cvt_pk_bf16_f32 v75, v78, v79
    v_mfma_f32_16x16x32_bf16 v[32:35], a[100:103], v[132:135], v[32:35]
    s_add_u32 s49, s8, 7
    ds_read_b64_tr_b16 a[66:67], v12 offset:28672
    v_cvt_pk_bf16_f32 v80, v80, v81
    v_mfma_f32_16x16x32_bf16 v[32:35], a[104:107], v[136:139], v[32:35]
    s_and_b32 s49, s49, 31
    ds_read_b64_tr_b16 a[68:69], v13 offset:24576
    v_cvt_pk_bf16_f32 v81, v82, v83
    v_mfma_f32_16x16x32_bf16 v[32:35], a[108:111], v[140:143], v[32:35]
    ds_read_b64_tr_b16 a[70:71], v13 offset:28672
    v_exp_f32 v87, v87
    v_mfma_f32_16x16x32_bf16 v[36:39], a[112:115], v[128:131], v[96:99]
    s_add_u32 m0, s56, 16384
    v_exp_f32 v88, v88
    v_mfma_f32_16x16x32_bf16 v[36:39], a[116:119], v[132:135], v[36:39]
    ds_read_b64_tr_b16 a[72:73], v14 offset:24576
    v_cvt_pk_bf16_f32 v82, v84, v85
    v_mfma_f32_16x16x32_bf16 v[36:39], a[120:123], v[136:139], v[36:39]
    s_lshl_b32 s52, s49, 15
    ds_read_b64_tr_b16 a[74:75], v14 offset:28672
    v_cvt_pk_bf16_f32 v83, v86, v87
    v_mfma_f32_16x16x32_bf16 v[36:39], a[124:127], v[140:143], v[36:39]
    buffer_load_dwordx4 v28, s[68:71], s52 offen offset:0 lds
    v_mfma_f32_16x16x32_bf16 v[40:43], a[96:99], v[144:147], v[100:103]
    ds_read_b64_tr_b16 a[76:77], v15 offset:24576
    v_mfma_f32_16x16x32_bf16 v[40:43], a[100:103], v[148:151], v[40:43]
    s_add_u32 s53, s52, 14336
    v_exp_f32 v89, v89
    v_mfma_f32_16x16x32_bf16 v[40:43], a[104:107], v[152:155], v[40:43]
    ds_read_b64_tr_b16 a[78:79], v15 offset:28672
    v_mfma_f32_16x16x32_bf16 v[40:43], a[108:111], v[156:159], v[40:43]
    buffer_load_dwordx4 v29, s[68:71], s52 offen offset:1024 lds
    v_mfma_f32_16x16x32_bf16 v[44:47], a[112:115], v[144:147], v[100:103]
    ds_read_b64_tr_b16 a[80:81], v16 offset:24576
    v_mfma_f32_16x16x32_bf16 v[44:47], a[116:119], v[148:151], v[44:47]
    buffer_load_dwordx4 v28, s[68:71], s53 offen offset:2048 lds
    v_mfma_f32_16x16x32_bf16 v[44:47], a[120:123], v[152:155], v[44:47]
    buffer_load_dwordx4 v29, s[68:71], s53 offen offset:3072 lds
    v_mfma_f32_16x16x32_bf16 v[44:47], a[124:127], v[156:159], v[44:47]
    ds_read_b64_tr_b16 a[82:83], v16 offset:28672
    v_exp_f32 v90, v90
    v_mfma_f32_16x16x32_bf16 v[48:51], a[96:99], v[160:163], v[104:107]
    s_add_u32 s49, s8, 8
    v_exp_f32 v91, v91
    v_mfma_f32_16x16x32_bf16 v[48:51], a[100:103], v[164:167], v[48:51]
    ds_read_b64_tr_b16 a[84:85], v17 offset:24576
    v_cvt_pk_bf16_f32 v88, v88, v89
    v_mfma_f32_16x16x32_bf16 v[48:51], a[104:107], v[168:171], v[48:51]
    s_and_b32 s49, s49, 31
    ds_read_b64_tr_b16 a[86:87], v17 offset:28672
    v_mfma_f32_16x16x32_bf16 v[48:51], a[108:111], v[172:175], v[48:51]
    s_add_u32 m0, s56, 131072
    ds_read_b64_tr_b16 a[88:89], v18 offset:24576
    v_mfma_f32_16x16x32_bf16 v[52:55], a[112:115], v[160:163], v[104:107]
    v_exp_f32 v92, v92
    v_mfma_f32_16x16x32_bf16 v[52:55], a[116:119], v[164:167], v[52:55]
    s_lshl_b32 s52, s49, 15
    ds_read_b64_tr_b16 a[90:91], v18 offset:28672
    v_cvt_pk_bf16_f32 v89, v90, v91
    v_mfma_f32_16x16x32_bf16 v[52:55], a[120:123], v[168:171], v[52:55]
    ds_read_b64_tr_b16 a[92:93], v19 offset:24576
    v_mfma_f32_16x16x32_bf16 v[52:55], a[124:127], v[172:175], v[52:55]
    buffer_load_dwordx4 v28, s[68:71], s52 offen offset:0 lds
    v_mfma_f32_16x16x32_bf16 v[56:59], a[96:99], v[176:179], v[108:111]
    ds_read_b64_tr_b16 a[94:95], v19 offset:28672
    v_mfma_f32_16x16x32_bf16 v[56:59], a[100:103], v[180:183], v[56:59]
    s_add_u32 s53, s52, 14336
    v_exp_f32 v93, v93
    v_mfma_f32_16x16x32_bf16 v[56:59], a[104:107], v[184:187], v[56:59]
    buffer_load_dwordx4 v29, s[68:71], s52 offen offset:1024 lds
    v_mfma_f32_16x16x32_bf16 v[56:59], a[108:111], v[188:191], v[56:59]
    v_exp_f32 v94, v94
    v_mfma_f32_16x16x32_bf16 v[60:63], a[112:115], v[176:179], v[108:111]
    buffer_load_dwordx4 v28, s[68:71], s53 offen offset:2048 lds
    v_mfma_f32_16x16x32_bf16 v[60:63], a[116:119], v[180:183], v[60:63]
    v_exp_f32 v95, v95
    v_mfma_f32_16x16x32_bf16 v[60:63], a[120:123], v[184:187], v[60:63]
    buffer_load_dwordx4 v29, s[68:71], s53 offen offset:3072 lds
    v_cvt_pk_bf16_f32 v90, v92, v93
    s_nop 0
    v_cvt_pk_bf16_f32 v91, v94, v95
    v_mfma_f32_16x16x32_bf16 v[60:63], a[124:127], v[188:191], v[60:63]
    s_waitcnt lgkmcnt(0)
    v_mfma_f32_16x16x32_bf16 v[112:115], v[120:123], v[64:67], v[112:115]
    s_add_u32 s49, s8, 9
    ds_read_b128 a[96:99], v8 offset:40960
    v_exp_f32 v48, v48
    v_mfma_f32_16x16x32_bf16 a[0:3], a[64:67], v[64:67], a[0:3]
    v_exp_f32 v49, v49
    v_mfma_f32_16x16x32_bf16 a[4:7], a[68:71], v[64:67], a[4:7]
    v_exp_f32 v50, v50
    v_cvt_pk_bf16_f32 v48, v48, v49
    v_mfma_f32_16x16x32_bf16 a[8:11], a[72:75], v[64:67], a[8:11]
    ds_read_b128 a[100:103], v9 offset:40960
    v_mfma_f32_16x16x32_bf16 a[12:15], a[76:79], v[64:67], a[12:15]
    s_and_b32 s49, s49, 31
    v_exp_f32 v51, v51
    v_exp_f32 v52, v52
    v_mfma_f32_16x16x32_bf16 a[16:19], a[80:83], v[64:67], a[16:19]
    v_cvt_pk_bf16_f32 v49, v50, v51
    v_mfma_f32_16x16x32_bf16 a[20:23], a[84:87], v[64:67], a[20:23]
    v_exp_f32 v53, v53
    v_mfma_f32_16x16x32_bf16 a[24:27], a[88:91], v[64:67], a[24:27]
    ds_read_b128 a[104:107], v10 offset:40960
    v_exp_f32 v54, v54
    v_mfma_f32_16x16x32_bf16 a[28:31], a[92:95], v[64:67], a[28:31]
    s_add_u32 m0, s56, 65536
    v_cvt_pk_bf16_f32 v50, v52, v53
    v_exp_f32 v55, v55
    v_mfma_f32_16x16x32_bf16 v[112:115], v[124:127], v[72:75], v[112:115]
    v_exp_f32 v56, v56
    v_mfma_f32_16x16x32_bf16 a[32:35], a[64:67], v[72:75], a[32:35]
    ds_read_b128 a[108:111], v11 offset:40960
    v_cvt_pk_bf16_f32 v51, v54, v55
    v_mfma_f32_16x16x32_bf16 a[36:39], a[68:71], v[72:75], a[36:39]
    v_exp_f32 v57, v57
    v_exp_f32 v58, v58
    v_mfma_f32_16x16x32_bf16 a[40:43], a[72:75], v[72:75], a[40:43]
    s_lshl_b32 s52, s49, 15
    v_cvt_pk_bf16_f32 v56, v56, v57
    v_mfma_f32_16x16x32_bf16 a[44:47], a[76:79], v[72:75], a[44:47]
    v_exp_f32 v59, v59
    v_mfma_f32_16x16x32_bf16 a[48:51], a[80:83], v[72:75], a[48:51]
    ds_read_b128 a[112:115], v8 offset:45056
    v_exp_f32 v60, v60
    v_mfma_f32_16x16x32_bf16 a[52:55], a[84:87], v[72:75], a[52:55]
    v_cvt_pk_bf16_f32 v57, v58, v59
    v_exp_f32 v61, v61
    v_mfma_f32_16x16x32_bf16 a[56:59], a[88:91], v[72:75], a[56:59]
    buffer_load_dwordx4 v28, s[68:71], s52 offen offset:0 lds
    v_mfma_f32_16x16x32_bf16 a[60:63], a[92:95], v[72:75], a[60:63]
    v_exp_f32 v62, v62
    v_mfma_f32_16x16x32_bf16 v[116:119], v[120:123], v[80:83], v[116:119]
    v_cvt_pk_bf16_f32 v58, v60, v61
    v_mfma_f32_16x16x32_bf16 v[192:195], a[64:67], v[80:83], v[192:195]
    ds_read_b128 a[116:119], v9 offset:45056
    v_exp_f32 v63, v63
    v_mfma_f32_16x16x32_bf16 v[196:199], a[68:71], v[80:83], v[196:199]
    s_add_u32 s53, s52, 14336
    s_nop 0
    v_cvt_pk_bf16_f32 v59, v62, v63
    v_mfma_f32_16x16x32_bf16 v[200:203], a[72:75], v[80:83], v[200:203]
    v_exp_f32 v32, v32
    v_mfma_f32_16x16x32_bf16 v[204:207], a[76:79], v[80:83], v[204:207]
    ds_read_b128 a[120:123], v10 offset:45056
    v_exp_f32 v33, v33
    v_mfma_f32_16x16x32_bf16 v[208:211], a[80:83], v[80:83], v[208:211]
    v_exp_f32 v34, v34
    v_cvt_pk_bf16_f32 v32, v32, v33
    v_mfma_f32_16x16x32_bf16 v[212:215], a[84:87], v[80:83], v[212:215]
    buffer_load_dwordx4 v29, s[68:71], s52 offen offset:1024 lds
    v_mfma_f32_16x16x32_bf16 v[216:219], a[88:91], v[80:83], v[216:219]
    v_exp_f32 v35, v35
    v_mfma_f32_16x16x32_bf16 v[220:223], a[92:95], v[80:83], v[220:223]
    v_exp_f32 v36, v36
    v_mfma_f32_16x16x32_bf16 v[116:119], v[124:127], v[88:91], v[116:119]
    ds_read_b128 a[124:127], v11 offset:45056
    v_cvt_pk_bf16_f32 v33, v34, v35
    v_mfma_f32_16x16x32_bf16 v[224:227], a[64:67], v[88:91], v[224:227]
    buffer_load_dwordx4 v28, s[68:71], s53 offen offset:2048 lds
    v_mfma_f32_16x16x32_bf16 v[228:231], a[68:71], v[88:91], v[228:231]
    v_exp_f32 v37, v37
    v_mfma_f32_16x16x32_bf16 v[232:235], a[72:75], v[88:91], v[232:235]
    v_exp_f32 v38, v38
    v_cvt_pk_bf16_f32 v34, v36, v37
    v_mfma_f32_16x16x32_bf16 v[236:239], a[76:79], v[88:91], v[236:239]
    v_exp_f32 v39, v39
    v_mfma_f32_16x16x32_bf16 v[240:243], a[80:83], v[88:91], v[240:243]
    buffer_load_dwordx4 v29, s[68:71], s53 offen offset:3072 lds
    v_mfma_f32_16x16x32_bf16 v[244:247], a[84:87], v[88:91], v[244:247]
    v_exp_f32 v40, v40
    v_cvt_pk_bf16_f32 v35, v38, v39
    v_mfma_f32_16x16x32_bf16 v[248:251], a[88:91], v[88:91], v[248:251]
    v_exp_f32 v41, v41
    v_mfma_f32_16x16x32_bf16 v[252:255], a[92:95], v[88:91], v[252:255]
    s_waitcnt lgkmcnt(0)
    v_exp_f32 v42, v42
    v_mfma_f32_16x16x32_bf16 v[80:83], a[96:99], v[160:163], v[104:107]
    ds_read_b64_tr_b16 a[64:65], v12 offset:32768
    ds_read_b64_tr_b16 a[66:67], v12 offset:36864
    v_mfma_f32_16x16x32_bf16 v[80:83], a[100:103], v[164:167], v[80:83]
    ds_read_b64_tr_b16 a[68:69], v13 offset:32768
    v_cvt_pk_bf16_f32 v40, v40, v41
    v_mfma_f32_16x16x32_bf16 v[80:83], a[104:107], v[168:171], v[80:83]
    ds_read_b64_tr_b16 a[70:71], v13 offset:36864
    v_exp_f32 v43, v43
    v_mfma_f32_16x16x32_bf16 v[80:83], a[108:111], v[172:175], v[80:83]
    ds_read_b64_tr_b16 a[72:73], v14 offset:32768
    v_exp_f32 v44, v44
    v_mfma_f32_16x16x32_bf16 v[84:87], a[112:115], v[160:163], v[104:107]
    ds_read_b64_tr_b16 a[74:75], v14 offset:36864
    ds_read_b64_tr_b16 a[76:77], v15 offset:32768
    v_mfma_f32_16x16x32_bf16 v[84:87], a[116:119], v[164:167], v[84:87]
    ds_read_b64_tr_b16 a[78:79], v15 offset:36864
    v_cvt_pk_bf16_f32 v41, v42, v43
    v_mfma_f32_16x16x32_bf16 v[84:87], a[120:123], v[168:171], v[84:87]
    ds_read_b64_tr_b16 a[80:81], v16 offset:32768
    v_exp_f32 v45, v45
    v_mfma_f32_16x16x32_bf16 v[84:87], a[124:127], v[172:175], v[84:87]
    ds_read_b64_tr_b16 a[82:83], v16 offset:36864
    v_exp_f32 v46, v46
    v_mfma_f32_16x16x32_bf16 v[88:91], a[96:99], v[176:179], v[108:111]
    ds_read_b64_tr_b16 a[84:85], v17 offset:32768
    ds_read_b64_tr_b16 a[86:87], v17 offset:36864
    v_mfma_f32_16x16x32_bf16 v[88:91], a[100:103], v[180:183], v[88:91]
    ds_read_b64_tr_b16 a[88:89], v18 offset:32768
    v_cvt_pk_bf16_f32 v42, v44, v45
    v_mfma_f32_16x16x32_bf16 v[88:91], a[104:107], v[184:187], v[88:91]
    ds_read_b64_tr_b16 a[90:91], v18 offset:36864
    v_exp_f32 v47, v47
    v_mfma_f32_16x16x32_bf16 v[88:91], a[108:111], v[188:191], v[88:91]
    ds_read_b64_tr_b16 a[92:93], v19 offset:32768
    s_nop 0
    v_mfma_f32_16x16x32_bf16 v[92:95], a[112:115], v[176:179], v[108:111]
    ds_read_b64_tr_b16 a[94:95], v19 offset:36864
    v_cvt_pk_bf16_f32 v43, v46, v47
    v_mfma_f32_16x16x32_bf16 v[92:95], a[116:119], v[180:183], v[92:95]
    v_lshlrev_b32 v7, 4, v0
    s_and_b32 s60, s41, 0
    v_mfma_f32_16x16x32_bf16 v[92:95], a[120:123], v[184:187], v[92:95]
    s_lshl_b32 s60, s60, 11
    s_add_u32 s60, s60, 0x100000
    s_xor_b32 s61, s60, 2048
    v_mfma_f32_16x16x32_bf16 v[92:95], a[124:127], v[188:191], v[92:95]
    s_xor_b32 s62, s60, 4096
    s_xor_b32 s63, s60, 6144
    s_waitcnt vmcnt(16) lgkmcnt(0)
    s_barrier
    v_mfma_f32_16x16x32_bf16 v[116:119], v[120:123], v[48:51], v[116:119]
    s_add_u32 s49, s8, 10
    ds_read_b128 a[96:99], v8 offset:49152
    ds_read_b128 a[100:103], v9 offset:49152
    v_mfma_f32_16x16x32_bf16 v[192:195], a[64:67], v[48:51], v[192:195]
    ds_read_b128 a[104:107], v10 offset:49152
    v_exp_f32 v80, v80
    v_mfma_f32_16x16x32_bf16 v[196:199], a[68:71], v[48:51], v[196:199]
    s_and_b32 s49, s49, 31
    ds_read_b128 a[108:111], v11 offset:49152
    v_exp_f32 v81, v81
    v_mfma_f32_16x16x32_bf16 v[200:203], a[72:75], v[48:51], v[200:203]
    ds_read_b128 a[112:115], v8 offset:53248
    ds_read_b128 a[116:119], v9 offset:53248
    v_mfma_f32_16x16x32_bf16 v[204:207], a[76:79], v[48:51], v[204:207]
    s_add_u32 m0, s56, 81920
    ds_read_b128 a[120:123], v10 offset:53248
    v_exp_f32 v82, v82
    v_mfma_f32_16x16x32_bf16 v[208:211], a[80:83], v[48:51], v[208:211]
    ds_read_b128 a[124:127], v11 offset:53248
    v_cvt_pk_bf16_f32 v80, v80, v81
    v_mfma_f32_16x16x32_bf16 v[212:215], a[84:87], v[48:51], v[212:215]
    s_lshl_b32 s52, s49, 15
    s_waitcnt vmcnt(12)
    ds_read_b64_tr_b16 a[208:209], v24 offset:16384
    ds_read_b64_tr_b16 a[210:211], v24 offset:18432
    v_mfma_f32_16x16x32_bf16 v[216:219], a[88:91], v[48:51], v[216:219]
    ds_read_b64_tr_b16 a[212:213], v25 offset:16384
    v_exp_f32 v83, v83
    v_mfma_f32_16x16x32_bf16 v[220:223], a[92:95], v[48:51], v[220:223]
    buffer_load_dwordx4 v28, s[68:71], s52 offen offset:0 lds
    v_mfma_f32_16x16x32_bf16 v[116:119], v[124:127], v[56:59], v[116:119]
    ds_read_b64_tr_b16 a[214:215], v25 offset:18432
    v_exp_f32 v84, v84
    v_mfma_f32_16x16x32_bf16 v[224:227], a[64:67], v[56:59], v[224:227]
    s_add_u32 s53, s52, 14336
    ds_read_b64_tr_b16 a[216:217], v26 offset:16384
    ds_read_b64_tr_b16 a[218:219], v26 offset:18432
    v_mfma_f32_16x16x32_bf16 v[228:231], a[68:71], v[56:59], v[228:231]
    ds_read_b64_tr_b16 a[220:221], v27 offset:16384
    v_cvt_pk_bf16_f32 v81, v82, v83
    v_mfma_f32_16x16x32_bf16 v[232:235], a[72:75], v[56:59], v[232:235]
    buffer_load_dwordx4 v29, s[68:71], s52 offen offset:1024 lds
    v_mfma_f32_16x16x32_bf16 v[236:239], a[76:79], v[56:59], v[236:239]
    ds_read_b64_tr_b16 a[222:223], v27 offset:18432
    v_exp_f32 v85, v85
    v_mfma_f32_16x16x32_bf16 v[240:243], a[80:83], v[56:59], v[240:243]
    buffer_load_dwordx4 v28, s[68:71], s53 offen offset:2048 lds
    v_mfma_f32_16x16x32_bf16 v[244:247], a[84:87], v[56:59], v[244:247]
    v_exp_f32 v86, v86
    v_mfma_f32_16x16x32_bf16 v[248:251], a[88:91], v[56:59], v[248:251]
    buffer_load_dwordx4 v29, s[68:71], s53 offen offset:3072 lds
    v_mfma_f32_16x16x32_bf16 v[252:255], a[92:95], v[56:59], v[252:255]
    s_waitcnt lgkmcnt(0)
    v_cvt_pk_bf16_f32 v82, v84, v85
    v_exp_f32 v87, v87
    v_mfma_f32_16x16x32_bf16 v[48:51], a[96:99], v[160:163], v[104:107]
    ds_read_b64_tr_b16 a[64:65], v12 offset:40960
    ds_read_b64_tr_b16 a[66:67], v12 offset:45056
    v_mfma_f32_16x16x32_bf16 v[48:51], a[100:103], v[164:167], v[48:51]
    ds_read_b64_tr_b16 a[68:69], v13 offset:40960
    v_mfma_f32_16x16x32_bf16 v[48:51], a[104:107], v[168:171], v[48:51]
    ds_read_b64_tr_b16 a[70:71], v13 offset:45056
    v_exp_f32 v88, v88
    v_cvt_pk_bf16_f32 v83, v86, v87
    v_mfma_f32_16x16x32_bf16 v[48:51], a[108:111], v[172:175], v[48:51]
    ds_read_b64_tr_b16 a[72:73], v14 offset:40960
    v_exp_f32 v89, v89
    v_mfma_f32_16x16x32_bf16 v[52:55], a[112:115], v[160:163], v[104:107]
    ds_read_b64_tr_b16 a[74:75], v14 offset:45056
    ds_read_b64_tr_b16 a[76:77], v15 offset:40960
    v_mfma_f32_16x16x32_bf16 v[52:55], a[116:119], v[164:167], v[52:55]
    ds_read_b64_tr_b16 a[78:79], v15 offset:45056
    v_mfma_f32_16x16x32_bf16 v[52:55], a[120:123], v[168:171], v[52:55]
    ds_read_b64_tr_b16 a[80:81], v16 offset:40960
    v_exp_f32 v90, v90
    v_cvt_pk_bf16_f32 v88, v88, v89
    v_mfma_f32_16x16x32_bf16 v[52:55], a[124:127], v[172:175], v[52:55]
    ds_read_b64_tr_b16 a[82:83], v16 offset:45056
    v_exp_f32 v91, v91
    v_mfma_f32_16x16x32_bf16 v[56:59], a[96:99], v[176:179], v[108:111]
    ds_read_b64_tr_b16 a[84:85], v17 offset:40960
    ds_read_b64_tr_b16 a[86:87], v17 offset:45056
    v_mfma_f32_16x16x32_bf16 v[56:59], a[100:103], v[180:183], v[56:59]
    ds_read_b64_tr_b16 a[88:89], v18 offset:40960
    v_mfma_f32_16x16x32_bf16 v[56:59], a[104:107], v[184:187], v[56:59]
    ds_read_b64_tr_b16 a[90:91], v18 offset:45056
    v_exp_f32 v92, v92
    v_cvt_pk_bf16_f32 v89, v90, v91
    v_mfma_f32_16x16x32_bf16 v[56:59], a[108:111], v[188:191], v[56:59]
    ds_read_b64_tr_b16 a[92:93], v19 offset:40960
    v_exp_f32 v93, v93
    v_mfma_f32_16x16x32_bf16 v[60:63], a[112:115], v[176:179], v[108:111]
    ds_read_b64_tr_b16 a[94:95], v19 offset:45056
    v_mfma_f32_16x16x32_bf16 v[60:63], a[116:119], v[180:183], v[60:63]
    v_exp_f32 v94, v94
    v_cvt_pk_bf16_f32 v90, v92, v93
    v_mfma_f32_16x16x32_bf16 v[60:63], a[120:123], v[184:187], v[60:63]
    v_exp_f32 v95, v95
    v_mfma_f32_16x16x32_bf16 v[60:63], a[124:127], v[188:191], v[60:63]
    s_nop 0
    v_cvt_pk_bf16_f32 v91, v94, v95
    s_waitcnt lgkmcnt(0)
    v_mfma_f32_16x16x32_bf16 v[116:119], v[120:123], v[80:83], v[116:119]
    s_add_u32 s49, s8, 11
    ds_read_b128 a[96:99], v8 offset:57344
    ds_read_b128 a[100:103], v9 offset:57344
    v_mfma_f32_16x16x32_bf16 v[192:195], a[64:67], v[80:83], v[192:195]
    ds_read_b128 a[104:107], v10 offset:57344
    v_exp_f32 v48, v48
    v_mfma_f32_16x16x32_bf16 v[196:199], a[68:71], v[80:83], v[196:199]
    s_and_b32 s49, s49, 31
    ds_read_b128 a[108:111], v11 offset:57344
    v_exp_f32 v49, v49
    v_mfma_f32_16x16x32_bf16 v[200:203], a[72:75], v[80:83], v[200:203]
    ds_read_b128 a[112:115], v8 offset:61440
    ds_read_b128 a[116:119], v9 offset:61440
    v_mfma_f32_16x16x32_bf16 v[204:207], a[76:79], v[80:83], v[204:207]
    s_add_u32 m0, s56, 147456
    ds_read_b128 a[120:123], v10 offset:61440
    v_exp_f32 v50, v50
    v_mfma_f32_16x16x32_bf16 v[208:211], a[80:83], v[80:83], v[208:211]
    ds_read_b128 a[124:127], v11 offset:61440
    v_cvt_pk_bf16_f32 v48, v48, v49
    v_mfma_f32_16x16x32_bf16 v[212:215], a[84:87], v[80:83], v[212:215]
    s_lshl_b32 s52, s49, 15
    s_waitcnt vmcnt(8)
    ds_read_b64_tr_b16 a[224:225], v24 offset:0
    ds_read_b64_tr_b16 a[226:227], v24 offset:2048
    v_mfma_f32_16x16x32_bf16 v[216:219], a[88:91], v[80:83], v[216:219]
    ds_read_b64_tr_b16 a[228:229], v25 offset:0
    v_exp_f32 v51, v51
    v_mfma_f32_16x16x32_bf16 v[220:223], a[92:95], v[80:83], v[220:223]
    buffer_load_dwordx4 v28, s[68:71], s52 offen offset:0 lds
    v_mfma_f32_16x16x32_bf16 v[116:119], v[124:127], v[88:91], v[116:119]
    ds_read_b64_tr_b16 a[230:231], v25 offset:2048
    v_exp_f32 v52, v52
    v_mfma_f32_16x16x32_bf16 v[224:227], a[64:67], v[88:91], v[224:227]
    s_add_u32 s53, s52, 14336
    ds_read_b64_tr_b16 a[232:233], v26 offset:0
    ds_read_b64_tr_b16 a[234:235], v26 offset:2048
    v_mfma_f32_16x16x32_bf16 v[228:231], a[68:71], v[88:91], v[228:231]
    ds_read_b64_tr_b16 a[236:237], v27 offset:0
    v_cvt_pk_bf16_f32 v49, v50, v51
    v_mfma_f32_16x16x32_bf16 v[232:235], a[72:75], v[88:91], v[232:235]
    buffer_load_dwordx4 v29, s[68:71], s52 offen offset:1024 lds
    v_mfma_f32_16x16x32_bf16 v[236:239], a[76:79], v[88:91], v[236:239]
    ds_read_b64_tr_b16 a[238:239], v27 offset:2048
    v_exp_f32 v53, v53
    v_mfma_f32_16x16x32_bf16 v[240:243], a[80:83], v[88:91], v[240:243]
    buffer_load_dwordx4 v28, s[68:71], s53 offen offset:2048 lds
    v_mfma_f32_16x16x32_bf16 v[244:247], a[84:87], v[88:91], v[244:247]
    v_exp_f32 v54, v54
    v_mfma_f32_16x16x32_bf16 v[248:251], a[88:91], v[88:91], v[248:251]
    buffer_load_dwordx4 v29, s[68:71], s53 offen offset:3072 lds
    v_mfma_f32_16x16x32_bf16 v[252:255], a[92:95], v[88:91], v[252:255]
    s_waitcnt lgkmcnt(0)
    v_cvt_pk_bf16_f32 v50, v52, v53
    v_exp_f32 v55, v55
    v_mfma_f32_16x16x32_bf16 v[80:83], a[96:99], v[160:163], v[104:107]
    ds_read_b64_tr_b16 a[64:65], v12 offset:49152
    ds_read_b64_tr_b16 a[66:67], v12 offset:53248
    v_mfma_f32_16x16x32_bf16 v[80:83], a[100:103], v[164:167], v[80:83]
    ds_read_b64_tr_b16 a[68:69], v13 offset:49152
    v_mfma_f32_16x16x32_bf16 v[80:83], a[104:107], v[168:171], v[80:83]
    ds_read_b64_tr_b16 a[70:71], v13 offset:53248
    v_exp_f32 v56, v56
    v_cvt_pk_bf16_f32 v51, v54, v55
    v_mfma_f32_16x16x32_bf16 v[80:83], a[108:111], v[172:175], v[80:83]
    ds_read_b64_tr_b16 a[72:73], v14 offset:49152
    v_exp_f32 v57, v57
    v_mfma_f32_16x16x32_bf16 v[84:87], a[112:115], v[160:163], v[104:107]
    ds_read_b64_tr_b16 a[74:75], v14 offset:53248
    ds_read_b64_tr_b16 a[76:77], v15 offset:49152
    v_mfma_f32_16x16x32_bf16 v[84:87], a[116:119], v[164:167], v[84:87]
    ds_read_b64_tr_b16 a[78:79], v15 offset:53248
    v_mfma_f32_16x16x32_bf16 v[84:87], a[120:123], v[168:171], v[84:87]
    ds_read_b64_tr_b16 a[80:81], v16 offset:49152
    v_exp_f32 v58, v58
    v_cvt_pk_bf16_f32 v56, v56, v57
    v_mfma_f32_16x16x32_bf16 v[84:87], a[124:127], v[172:175], v[84:87]
    ds_read_b64_tr_b16 a[82:83], v16 offset:53248
    v_exp_f32 v59, v59
    v_mfma_f32_16x16x32_bf16 v[88:91], a[96:99], v[176:179], v[108:111]
    ds_read_b64_tr_b16 a[84:85], v17 offset:49152
    ds_read_b64_tr_b16 a[86:87], v17 offset:53248
    v_mfma_f32_16x16x32_bf16 v[88:91], a[100:103], v[180:183], v[88:91]
    ds_read_b64_tr_b16 a[88:89], v18 offset:49152
    v_mfma_f32_16x16x32_bf16 v[88:91], a[104:107], v[184:187], v[88:91]
    ds_read_b64_tr_b16 a[90:91], v18 offset:53248
    v_exp_f32 v60, v60
    v_cvt_pk_bf16_f32 v57, v58, v59
    v_mfma_f32_16x16x32_bf16 v[88:91], a[108:111], v[188:191], v[88:91]
    ds_read_b64_tr_b16 a[92:93], v19 offset:49152
    v_exp_f32 v61, v61
    v_mfma_f32_16x16x32_bf16 v[92:95], a[112:115], v[176:179], v[108:111]
    ds_read_b64_tr_b16 a[94:95], v19 offset:53248
    v_mfma_f32_16x16x32_bf16 v[92:95], a[116:119], v[180:183], v[92:95]
    v_exp_f32 v62, v62
    v_cvt_pk_bf16_f32 v58, v60, v61
    v_mfma_f32_16x16x32_bf16 v[92:95], a[120:123], v[184:187], v[92:95]
    v_exp_f32 v63, v63
    v_mfma_f32_16x16x32_bf16 v[92:95], a[124:127], v[188:191], v[92:95]
    s_nop 0
    v_cvt_pk_bf16_f32 v59, v62, v63
    s_waitcnt lgkmcnt(0)
    v_mfma_f32_16x16x32_bf16 v[116:119], v[120:123], v[48:51], v[116:119]
    s_add_u32 s49, s8, 12
    ds_read_b128 a[96:99], v8 offset:40960
    ds_read_b128 a[100:103], v9 offset:40960
    v_mfma_f32_16x16x32_bf16 v[192:195], a[64:67], v[48:51], v[192:195]
    ds_read_b128 a[104:107], v10 offset:40960
    v_exp_f32 v80, v80
    v_mfma_f32_16x16x32_bf16 v[196:199], a[68:71], v[48:51], v[196:199]
    s_and_b32 s49, s49, 31
    ds_read_b128 a[108:111], v11 offset:40960
    v_exp_f32 v81, v81
    v_mfma_f32_16x16x32_bf16 v[200:203], a[72:75], v[48:51], v[200:203]
    ds_read_b128 a[112:115], v8 offset:45056
    ds_read_b128 a[116:119], v9 offset:45056
    v_mfma_f32_16x16x32_bf16 v[204:207], a[76:79], v[48:51], v[204:207]
    s_add_u32 m0, s56, 131072
    ds_read_b128 a[120:123], v10 offset:45056
    v_exp_f32 v82, v82
    v_mfma_f32_16x16x32_bf16 v[208:211], a[80:83], v[48:51], v[208:211]
    ds_read_b128 a[124:127], v11 offset:45056
    v_cvt_pk_bf16_f32 v80, v80, v81
    v_mfma_f32_16x16x32_bf16 v[212:215], a[84:87], v[48:51], v[212:215]
    s_lshl_b32 s52, s49, 15
    s_waitcnt vmcnt(0)
    ds_read_b64_tr_b16 a[240:241], v24 offset:16384
    ds_read_b64_tr_b16 a[242:243], v24 offset:18432
    v_mfma_f32_16x16x32_bf16 v[216:219], a[88:91], v[48:51], v[216:219]
    ds_read_b64_tr_b16 a[244:245], v25 offset:16384
    v_exp_f32 v83, v83
    v_mfma_f32_16x16x32_bf16 v[220:223], a[92:95], v[48:51], v[220:223]
    buffer_load_dwordx4 v28, s[68:71], s52 offen offset:0 lds
    v_mfma_f32_16x16x32_bf16 v[116:119], v[124:127], v[56:59], v[116:119]
    ds_read_b64_tr_b16 a[246:247], v25 offset:18432
    v_exp_f32 v84, v84
    v_mfma_f32_16x16x32_bf16 v[224:227], a[64:67], v[56:59], v[224:227]
    s_add_u32 s53, s52, 14336
    ds_read_b64_tr_b16 a[248:249], v26 offset:16384
    ds_read_b64_tr_b16 a[250:251], v26 offset:18432
    v_mfma_f32_16x16x32_bf16 v[228:231], a[68:71], v[56:59], v[228:231]
    ds_read_b64_tr_b16 a[252:253], v27 offset:16384
    v_cvt_pk_bf16_f32 v81, v82, v83
    v_mfma_f32_16x16x32_bf16 v[232:235], a[72:75], v[56:59], v[232:235]
    buffer_load_dwordx4 v29, s[68:71], s52 offen offset:1024 lds
    v_mfma_f32_16x16x32_bf16 v[236:239], a[76:79], v[56:59], v[236:239]
    ds_read_b64_tr_b16 a[254:255], v27 offset:18432
    v_exp_f32 v85, v85
    v_mfma_f32_16x16x32_bf16 v[240:243], a[80:83], v[56:59], v[240:243]
    buffer_load_dwordx4 v28, s[68:71], s53 offen offset:2048 lds
    v_mfma_f32_16x16x32_bf16 v[244:247], a[84:87], v[56:59], v[244:247]
    v_exp_f32 v86, v86
    v_mfma_f32_16x16x32_bf16 v[248:251], a[88:91], v[56:59], v[248:251]
    buffer_load_dwordx4 v29, s[68:71], s53 offen offset:3072 lds
    v_mfma_f32_16x16x32_bf16 v[252:255], a[92:95], v[56:59], v[252:255]
    s_waitcnt lgkmcnt(0)
    v_cvt_pk_bf16_f32 v82, v84, v85
    v_exp_f32 v87, v87
    v_mfma_f32_16x16x32_bf16 v[64:67], a[96:99], v[128:131], v[96:99]
    ds_read_b64_tr_b16 a[64:65], v12 offset:57344
    ds_read_b64_tr_b16 a[66:67], v12 offset:61440
    v_mfma_f32_16x16x32_bf16 v[64:67], a[100:103], v[132:135], v[64:67]
    ds_read_b64_tr_b16 a[68:69], v13 offset:57344
    v_mfma_f32_16x16x32_bf16 v[64:67], a[104:107], v[136:139], v[64:67]
    ds_read_b64_tr_b16 a[70:71], v13 offset:61440
    v_exp_f32 v88, v88
    v_cvt_pk_bf16_f32 v83, v86, v87
    v_mfma_f32_16x16x32_bf16 v[64:67], a[108:111], v[140:143], v[64:67]
    ds_read_b64_tr_b16 a[72:73], v14 offset:57344
    v_exp_f32 v89, v89
    v_mfma_f32_16x16x32_bf16 v[68:71], a[112:115], v[128:131], v[96:99]
    ds_read_b64_tr_b16 a[74:75], v14 offset:61440
    ds_read_b64_tr_b16 a[76:77], v15 offset:57344
    v_mfma_f32_16x16x32_bf16 v[68:71], a[116:119], v[132:135], v[68:71]
    ds_read_b64_tr_b16 a[78:79], v15 offset:61440
    v_mfma_f32_16x16x32_bf16 v[68:71], a[120:123], v[136:139], v[68:71]
    ds_read_b64_tr_b16 a[80:81], v16 offset:57344
    v_exp_f32 v90, v90
    v_cvt_pk_bf16_f32 v88, v88, v89
    v_mfma_f32_16x16x32_bf16 v[68:71], a[124:127], v[140:143], v[68:71]
    ds_read_b64_tr_b16 a[82:83], v16 offset:61440
    v_exp_f32 v91, v91
    v_mfma_f32_16x16x32_bf16 v[72:75], a[96:99], v[144:147], v[100:103]
L_pad6:
    s_cbranch_execz L_ret1
    ds_read_b64_tr_b16 a[84:85], v17 offset:57344
    ds_read_b64_tr_b16 a[86:87], v17 offset:61440
    v_mfma_f32_16x16x32_bf16 v[72:75], a[100:103], v[148:151], v[72:75]
    ds_read_b64_tr_b16 a[88:89], v18 offset:57344
    v_mfma_f32_16x16x32_bf16 v[72:75], a[104:107], v[152:155], v[72:75]
    ds_read_b64_tr_b16 a[90:91], v18 offset:61440
    v_exp_f32 v92, v92
    v_cvt_pk_bf16_f32 v89, v90, v91
    v_mfma_f32_16x16x32_bf16 v[72:75], a[108:111], v[156:159], v[72:75]
    ds_read_b64_tr_b16 a[92:93], v19 offset:57344
    v_exp_f32 v93, v93
    v_mfma_f32_16x16x32_bf16 v[76:79], a[112:115], v[144:147], v[100:103]
    ds_read_b64_tr_b16 a[94:95], v19 offset:61440
    v_mfma_f32_16x16x32_bf16 v[76:79], a[116:119], v[148:151], v[76:79]
    v_exp_f32 v94, v94
    v_cvt_pk_bf16_f32 v90, v92, v93
    v_mfma_f32_16x16x32_bf16 v[76:79], a[120:123], v[152:155], v[76:79]
    v_exp_f32 v95, v95
    v_mfma_f32_16x16x32_bf16 v[76:79], a[124:127], v[156:159], v[76:79]
    s_nop 0
    v_cvt_pk_bf16_f32 v91, v94, v95
    s_waitcnt lgkmcnt(0)
    s_nop 0
    v_mfma_f32_16x16x32_bf16 v[116:119], v[120:123], v[80:83], v[116:119]
    s_add_u32 s49, s8, 13
    ds_read_b64_tr_b16 a[96:97], v12 offset:32768
    ds_read_b64_tr_b16 a[98:99], v12 offset:36864
    v_mfma_f32_16x16x32_bf16 v[116:119], v[124:127], v[88:91], v[116:119]
    ds_read_b64_tr_b16 a[100:101], v13 offset:32768
    v_exp_f32 v64, v64
    v_exp_f32 v65, v65
    v_mfma_f32_16x16x32_bf16 v[192:195], a[64:67], v[80:83], v[192:195]
    s_and_b32 s49, s49, 31
    ds_read_b64_tr_b16 a[102:103], v13 offset:36864
    v_exp_f32 v66, v66
    v_mfma_f32_16x16x32_bf16 v[196:199], a[68:71], v[80:83], v[196:199]
    ds_read_b64_tr_b16 a[104:105], v14 offset:32768
    ds_read_b64_tr_b16 a[106:107], v14 offset:36864
    v_mfma_f32_16x16x32_bf16 v[200:203], a[72:75], v[80:83], v[200:203]
    s_add_u32 m0, s56, 147456
    ds_read_b64_tr_b16 a[108:109], v15 offset:32768
    v_cvt_pk_bf16_f32 v64, v64, v65
    v_exp_f32 v67, v67
    v_mfma_f32_16x16x32_bf16 v[204:207], a[76:79], v[80:83], v[204:207]
    ds_read_b64_tr_b16 a[110:111], v15 offset:36864
    v_exp_f32 v68, v68
    v_cvt_pk_bf16_f32 v65, v66, v67
    v_mfma_f32_16x16x32_bf16 v[208:211], a[80:83], v[80:83], v[208:211]
    s_lshl_b32 s52, s49, 15
    ds_read_b64_tr_b16 a[112:113], v16 offset:32768
    ds_read_b64_tr_b16 a[114:115], v16 offset:36864
    v_mfma_f32_16x16x32_bf16 v[212:215], a[84:87], v[80:83], v[212:215]
    ds_read_b64_tr_b16 a[116:117], v17 offset:32768
    v_exp_f32 v69, v69
    v_exp_f32 v70, v70
    v_mfma_f32_16x16x32_bf16 v[216:219], a[88:91], v[80:83], v[216:219]
    buffer_load_dwordx4 v28, s[68:71], s52 offen offset:0 lds
    v_mfma_f32_16x16x32_bf16 v[220:223], a[92:95], v[80:83], v[220:223]
    ds_read_b64_tr_b16 a[118:119], v17 offset:36864
    v_cvt_pk_bf16_f32 v66, v68, v69
    v_exp_f32 v71, v71
    v_mfma_f32_16x16x32_bf16 v[224:227], a[64:67], v[88:91], v[224:227]
    s_add_u32 s53, s52, 14336
    ds_read_b64_tr_b16 a[120:121], v18 offset:32768
    ds_read_b64_tr_b16 a[122:123], v18 offset:36864
    v_mfma_f32_16x16x32_bf16 v[228:231], a[68:71], v[88:91], v[228:231]
    ds_read_b64_tr_b16 a[124:125], v19 offset:32768
    v_exp_f32 v72, v72
    s_mov_b32 s51, 0x4e800000
    v_mfma_f32_16x16x32_bf16 v[232:235], a[72:75], v[88:91], v[232:235]
    buffer_load_dwordx4 v29, s[68:71], s52 offen offset:1024 lds
    v_mfma_f32_16x16x32_bf16 v[236:239], a[76:79], v[88:91], v[236:239]
    ds_read_b64_tr_b16 a[126:127], v19 offset:36864
    v_add_f32 v1, v116, v117
    v_max_f32 v2, 0x0da24260, v116
    v_max_f32 v4, 0x0da24260, v117
    v_mfma_f32_16x16x32_bf16 v[240:243], a[80:83], v[88:91], v[240:243]
    buffer_load_dwordx4 v28, s[68:71], s53 offen offset:2048 lds
    v_mfma_f32_16x16x32_bf16 v[244:247], a[84:87], v[88:91], v[244:247]
    v_cmp_nge_f32 vcc, s51, v1
    v_rcp_f32 v2, v2
    v_rcp_f32 v4, v4
    v_mfma_f32_16x16x32_bf16 v[248:251], a[88:91], v[88:91], v[248:251]
    buffer_load_dwordx4 v29, s[68:71], s53 offen offset:3072 lds
    v_mfma_f32_16x16x32_bf16 v[252:255], a[92:95], v[88:91], v[252:255]
    s_nop 0
    v_mov_b32 v3, v2
    v_mov_b32 v5, v4
    s_nop 1
    s_cbranch_vccnz L_slow1
L_back1:
    s_waitcnt lgkmcnt(0)
    v_mfma_f32_16x16x32_bf16 v[112:115], v[120:123], v[32:35], v[112:115]
    ds_read_b128 a[64:67], v8 offset:49152
    v_mul_f32 v192, v192, v2
    v_mul_f32 v193, v193, v2
    v_mfma_f32_16x16x32_bf16 a[0:3], a[96:99], v[32:35], a[0:3]
    ds_read_b128 a[68:71], v9 offset:49152
    v_mul_f32 v194, v194, v2
    v_mul_f32 v195, v195, v2
    v_mfma_f32_16x16x32_bf16 a[4:7], a[100:103], v[32:35], a[4:7]
    v_mul_f32 v196, v196, v2
    v_mul_f32 v197, v197, v2
    v_mul_f32 v198, v198, v2
    v_mul_f32 v199, v199, v2
    v_mfma_f32_16x16x32_bf16 a[8:11], a[104:107], v[32:35], a[8:11]
    ds_read_b128 a[72:75], v10 offset:49152
    v_cvt_pk_bf16_f32 v192, v192, v193
    v_cvt_pk_bf16_f32 v193, v194, v195
    v_mfma_f32_16x16x32_bf16 a[12:15], a[108:111], v[32:35], a[12:15]
    v_cvt_pk_bf16_f32 v194, v196, v197
    v_cvt_pk_bf16_f32 v195, v198, v199
    buffer_store_dwordx4 v[192:195], v7, s[36:39], s60 offen offset:0 sc1
    v_mfma_f32_16x16x32_bf16 a[16:19], a[112:115], v[32:35], a[16:19]
    ds_read_b128 a[76:79], v11 offset:49152
    v_mul_f32 v224, v224, v4
    v_mul_f32 v225, v225, v4
    v_mfma_f32_16x16x32_bf16 a[20:23], a[116:119], v[32:35], a[20:23]
    v_mul_f32 v226, v226, v4
    v_mul_f32 v227, v227, v4
    v_mul_f32 v228, v228, v4
    v_mul_f32 v229, v229, v4
    v_mfma_f32_16x16x32_bf16 a[24:27], a[120:123], v[32:35], a[24:27]
    ds_read_b128 a[80:83], v8 offset:53248
    v_mul_f32 v230, v230, v4
    v_mul_f32 v231, v231, v4
    v_cvt_pk_bf16_f32 v224, v224, v225
    v_mfma_f32_16x16x32_bf16 a[28:31], a[124:127], v[32:35], a[28:31]
    v_cvt_pk_bf16_f32 v225, v226, v227
    v_cvt_pk_bf16_f32 v226, v228, v229
    v_cvt_pk_bf16_f32 v227, v230, v231
    v_mfma_f32_16x16x32_bf16 v[112:115], v[124:127], v[40:43], v[112:115]
    ds_read_b128 a[84:87], v9 offset:53248
    buffer_store_dwordx4 v[224:227], v7, s[36:39], s60 offen offset:1024 sc1
    v_mul_f32 v200, v200, v2
    v_mfma_f32_16x16x32_bf16 a[32:35], a[96:99], v[40:43], a[32:35]
    v_mul_f32 v201, v201, v2
    v_mul_f32 v202, v202, v2
    v_mul_f32 v203, v203, v2
    v_mul_f32 v204, v204, v2
    v_mfma_f32_16x16x32_bf16 a[36:39], a[100:103], v[40:43], a[36:39]
    ds_read_b128 a[88:91], v10 offset:53248
    v_mul_f32 v205, v205, v2
    v_mul_f32 v206, v206, v2
    v_mfma_f32_16x16x32_bf16 a[40:43], a[104:107], v[40:43], a[40:43]
    v_mul_f32 v207, v207, v2
    v_cvt_pk_bf16_f32 v200, v200, v201
    v_cvt_pk_bf16_f32 v201, v202, v203
    v_cvt_pk_bf16_f32 v202, v204, v205
    v_mfma_f32_16x16x32_bf16 a[44:47], a[108:111], v[40:43], a[44:47]
    ds_read_b128 a[92:95], v11 offset:53248
    v_cvt_pk_bf16_f32 v203, v206, v207
    v_mfma_f32_16x16x32_bf16 a[48:51], a[112:115], v[40:43], a[48:51]
    buffer_store_dwordx4 v[200:203], v7, s[36:39], s61 offen offset:0 sc1
    v_mul_f32 v232, v232, v4
    v_mul_f32 v233, v233, v4
    v_mul_f32 v234, v234, v4
    v_mfma_f32_16x16x32_bf16 a[52:55], a[116:119], v[40:43], a[52:55]
    v_mul_f32 v235, v235, v4
    v_mul_f32 v236, v236, v4
    v_mul_f32 v237, v237, v4
    v_mul_f32 v238, v238, v4
    v_mfma_f32_16x16x32_bf16 a[56:59], a[120:123], v[40:43], a[56:59]
    v_mul_f32 v239, v239, v4
    v_cvt_pk_bf16_f32 v232, v232, v233
    v_cvt_pk_bf16_f32 v233, v234, v235
    v_cvt_pk_bf16_f32 v234, v236, v237
    v_mfma_f32_16x16x32_bf16 a[60:63], a[124:127], v[40:43], a[60:63]
    s_waitcnt lgkmcnt(0)
    v_cvt_pk_bf16_f32 v235, v238, v239
    buffer_store_dwordx4 v[232:235], v7, s[36:39], s61 offen offset:1024 sc1
    v_mul_f32 v208, v208, v2
    v_mfma_f32_16x16x32_bf16 v[32:35], a[64:67], v[128:131], v[96:99]
    ds_read_b64_tr_b16 a[96:97], v12 offset:40960
    ds_read_b64_tr_b16 a[98:99], v12 offset:45056
    v_mfma_f32_16x16x32_bf16 v[32:35], a[68:71], v[132:135], v[32:35]
    ds_read_b64_tr_b16 a[100:101], v13 offset:40960
    v_mul_f32 v209, v209, v2
    v_mul_f32 v210, v210, v2
    v_mfma_f32_16x16x32_bf16 v[32:35], a[72:75], v[136:139], v[32:35]
    ds_read_b64_tr_b16 a[102:103], v13 offset:45056
    v_mul_f32 v211, v211, v2
    v_mul_f32 v212, v212, v2
    v_mfma_f32_16x16x32_bf16 v[32:35], a[76:79], v[140:143], v[32:35]
    ds_read_b64_tr_b16 a[104:105], v14 offset:40960
    v_mul_f32 v213, v213, v2
    v_mul_f32 v214, v214, v2
    v_mfma_f32_16x16x32_bf16 v[36:39], a[80:83], v[128:131], v[96:99]
    ds_read_b64_tr_b16 a[106:107], v14 offset:45056
    ds_read_b64_tr_b16 a[108:109], v15 offset:40960
    v_mfma_f32_16x16x32_bf16 v[36:39], a[84:87], v[132:135], v[36:39]
    ds_read_b64_tr_b16 a[110:111], v15 offset:45056
    v_mul_f32 v215, v215, v2
    v_cvt_pk_bf16_f32 v208, v208, v209
    v_mfma_f32_16x16x32_bf16 v[36:39], a[88:91], v[136:139], v[36:39]
    ds_read_b64_tr_b16 a[112:113], v16 offset:40960
    v_cvt_pk_bf16_f32 v209, v210, v211
    v_cvt_pk_bf16_f32 v210, v212, v213
    v_cvt_pk_bf16_f32 v211, v214, v215
    v_mfma_f32_16x16x32_bf16 v[36:39], a[92:95], v[140:143], v[36:39]
    ds_read_b64_tr_b16 a[114:115], v16 offset:45056
    buffer_store_dwordx4 v[208:211], v7, s[36:39], s62 offen offset:0 sc1
    v_mfma_f32_16x16x32_bf16 v[40:43], a[64:67], v[144:147], v[100:103]
    ds_read_b64_tr_b16 a[116:117], v17 offset:40960
    ds_read_b64_tr_b16 a[118:119], v17 offset:45056
    v_mfma_f32_16x16x32_bf16 v[40:43], a[68:71], v[148:151], v[40:43]
    ds_read_b64_tr_b16 a[120:121], v18 offset:40960
    v_cvt_pk_bf16_f32 v67, v70, v71
    v_mfma_f32_16x16x32_bf16 v[40:43], a[72:75], v[152:155], v[40:43]
    ds_read_b64_tr_b16 a[122:123], v18 offset:45056
    v_exp_f32 v73, v73
    v_mfma_f32_16x16x32_bf16 v[40:43], a[76:79], v[156:159], v[40:43]
    ds_read_b64_tr_b16 a[124:125], v19 offset:40960
    v_exp_f32 v74, v74
    v_cvt_pk_bf16_f32 v72, v72, v73
    v_mfma_f32_16x16x32_bf16 v[44:47], a[80:83], v[144:147], v[100:103]
    ds_read_b64_tr_b16 a[126:127], v19 offset:45056
    v_exp_f32 v75, v75
    v_mfma_f32_16x16x32_bf16 v[44:47], a[84:87], v[148:151], v[44:47]
    v_exp_f32 v76, v76
    v_cvt_pk_bf16_f32 v73, v74, v75
    v_mfma_f32_16x16x32_bf16 v[44:47], a[88:91], v[152:155], v[44:47]
    v_exp_f32 v77, v77
    v_exp_f32 v78, v78
    v_cvt_pk_bf16_f32 v74, v76, v77
    v_mfma_f32_16x16x32_bf16 v[44:47], a[92:95], v[156:159], v[44:47]
    v_exp_f32 v79, v79
    s_nop 0
    v_cvt_pk_bf16_f32 v75, v78, v79
    s_waitcnt lgkmcnt(0)
    v_mfma_f32_16x16x32_bf16 v[112:115], v[120:123], v[64:67], v[112:115]
    ds_read_b128 a[64:67], v8 offset:57344
    v_mul_f32 v240, v240, v4
    v_mul_f32 v241, v241, v4
    v_mul_f32 v242, v242, v4
    v_mul_f32 v243, v243, v4
    v_mfma_f32_16x16x32_bf16 a[0:3], a[96:99], v[64:67], a[0:3]
    ds_read_b128 a[68:71], v9 offset:57344
    v_mul_f32 v244, v244, v4
    v_mfma_f32_16x16x32_bf16 a[4:7], a[100:103], v[64:67], a[4:7]
    v_mul_f32 v245, v245, v4
    v_mul_f32 v246, v246, v4
    v_mul_f32 v247, v247, v4
    v_cvt_pk_bf16_f32 v240, v240, v241
    v_mfma_f32_16x16x32_bf16 a[8:11], a[104:107], v[64:67], a[8:11]
    ds_read_b128 a[72:75], v10 offset:57344
    v_cvt_pk_bf16_f32 v241, v242, v243
    v_cvt_pk_bf16_f32 v242, v244, v245
    v_mfma_f32_16x16x32_bf16 a[12:15], a[108:111], v[64:67], a[12:15]
    v_cvt_pk_bf16_f32 v243, v246, v247
    buffer_store_dwordx4 v[240:243], v7, s[36:39], s62 offen offset:1024 sc1
    v_mul_f32 v216, v216, v2
    v_mfma_f32_16x16x32_bf16 a[16:19], a[112:115], v[64:67], a[16:19]
    ds_read_b128 a[76:79], v11 offset:57344
    v_mul_f32 v217, v217, v2
    v_mfma_f32_16x16x32_bf16 a[20:23], a[116:119], v[64:67], a[20:23]
    v_mul_f32 v218, v218, v2
    v_mul_f32 v219, v219, v2
    v_mul_f32 v220, v220, v2
    v_mul_f32 v221, v221, v2
    v_mfma_f32_16x16x32_bf16 a[24:27], a[120:123], v[64:67], a[24:27]
    ds_read_b128 a[80:83], v8 offset:61440
    v_mul_f32 v222, v222, v2
    v_mul_f32 v223, v223, v2
    v_cvt_pk_bf16_f32 v216, v216, v217
    v_cvt_pk_bf16_f32 v217, v218, v219
    v_mfma_f32_16x16x32_bf16 a[28:31], a[124:127], v[64:67], a[28:31]
    v_cvt_pk_bf16_f32 v218, v220, v221
    v_cvt_pk_bf16_f32 v219, v222, v223
    buffer_store_dwordx4 v[216:219], v7, s[36:39], s63 offen offset:0 sc1
    v_mfma_f32_16x16x32_bf16 v[112:115], v[124:127], v[72:75], v[112:115]
    ds_read_b128 a[84:87], v9 offset:61440
    v_mul_f32 v248, v248, v4
    v_mfma_f32_16x16x32_bf16 a[32:35], a[96:99], v[72:75], a[32:35]
    v_mul_f32 v249, v249, v4
    v_mul_f32 v250, v250, v4
    v_mul_f32 v251, v251, v4
    v_mul_f32 v252, v252, v4
    v_mfma_f32_16x16x32_bf16 a[36:39], a[100:103], v[72:75], a[36:39]
    ds_read_b128 a[88:91], v10 offset:61440
    v_mul_f32 v253, v253, v4
    v_mfma_f32_16x16x32_bf16 a[40:43], a[104:107], v[72:75], a[40:43]
    v_mul_f32 v254, v254, v4
    v_mul_f32 v255, v255, v4
    v_cvt_pk_bf16_f32 v248, v248, v249
    v_cvt_pk_bf16_f32 v249, v250, v251
    v_mfma_f32_16x16x32_bf16 a[44:47], a[108:111], v[72:75], a[44:47]
    ds_read_b128 a[92:95], v11 offset:61440
    v_cvt_pk_bf16_f32 v250, v252, v253
    v_cvt_pk_bf16_f32 v251, v254, v255
    v_mfma_f32_16x16x32_bf16 a[48:51], a[112:115], v[72:75], a[48:51]
    buffer_store_dwordx4 v[248:251], v7, s[36:39], s63 offen offset:1024 sc1
    v_exp_f32 v32, v32
    v_mfma_f32_16x16x32_bf16 a[52:55], a[116:119], v[72:75], a[52:55]
    v_exp_f32 v33, v33
    v_exp_f32 v34, v34
    v_mfma_f32_16x16x32_bf16 a[56:59], a[120:123], v[72:75], a[56:59]
    v_cvt_pk_bf16_f32 v32, v32, v33
    v_exp_f32 v35, v35
    v_mfma_f32_16x16x32_bf16 a[60:63], a[124:127], v[72:75], a[60:63]
    s_waitcnt lgkmcnt(0)
    v_exp_f32 v36, v36
    v_cvt_pk_bf16_f32 v33, v34, v35
    v_mfma_f32_16x16x32_bf16 v[64:67], a[64:67], v[128:131], v[96:99]
    ds_read_b64_tr_b16 a[96:97], v12 offset:49152
    ds_read_b64_tr_b16 a[98:99], v12 offset:53248
    v_mfma_f32_16x16x32_bf16 v[64:67], a[68:71], v[132:135], v[64:67]
    ds_read_b64_tr_b16 a[100:101], v13 offset:49152
    v_exp_f32 v37, v37
    v_mfma_f32_16x16x32_bf16 v[64:67], a[72:75], v[136:139], v[64:67]
    ds_read_b64_tr_b16 a[102:103], v13 offset:53248
    v_exp_f32 v38, v38
    v_cvt_pk_bf16_f32 v34, v36, v37
    v_mfma_f32_16x16x32_bf16 v[64:67], a[76:79], v[140:143], v[64:67]
    ds_read_b64_tr_b16 a[104:105], v14 offset:49152
    v_exp_f32 v39, v39
    v_mfma_f32_16x16x32_bf16 v[68:71], a[80:83], v[128:131], v[96:99]
    ds_read_b64_tr_b16 a[106:107], v14 offset:53248
    ds_read_b64_tr_b16 a[108:109], v15 offset:49152
    v_mfma_f32_16x16x32_bf16 v[68:71], a[84:87], v[132:135], v[68:71]
    ds_read_b64_tr_b16 a[110:111], v15 offset:53248
    v_exp_f32 v40, v40
    v_mfma_f32_16x16x32_bf16 v[68:71], a[88:91], v[136:139], v[68:71]
    ds_read_b64_tr_b16 a[112:113], v16 offset:49152
    v_cvt_pk_bf16_f32 v35, v38, v39
    v_exp_f32 v41, v41
    v_mfma_f32_16x16x32_bf16 v[68:71], a[92:95], v[140:143], v[68:71]
    ds_read_b64_tr_b16 a[114:115], v16 offset:53248
    v_exp_f32 v42, v42
    v_cvt_pk_bf16_f32 v40, v40, v41
    v_mfma_f32_16x16x32_bf16 v[72:75], a[64:67], v[144:147], v[100:103]
    ds_read_b64_tr_b16 a[116:117], v17 offset:49152
    ds_read_b64_tr_b16 a[118:119], v17 offset:53248
    v_mfma_f32_16x16x32_bf16 v[72:75], a[68:71], v[148:151], v[72:75]
    ds_read_b64_tr_b16 a[120:121], v18 offset:49152
    v_exp_f32 v43, v43
    v_mfma_f32_16x16x32_bf16 v[72:75], a[72:75], v[152:155], v[72:75]
    ds_read_b64_tr_b16 a[122:123], v18 offset:53248
    v_exp_f32 v44, v44
    v_mfma_f32_16x16x32_bf16 v[72:75], a[76:79], v[156:159], v[72:75]
    ds_read_b64_tr_b16 a[124:125], v19 offset:49152
    v_cvt_pk_bf16_f32 v41, v42, v43
    v_mfma_f32_16x16x32_bf16 v[76:79], a[80:83], v[144:147], v[100:103]
    ds_read_b64_tr_b16 a[126:127], v19 offset:53248
    v_exp_f32 v45, v45
    v_mfma_f32_16x16x32_bf16 v[76:79], a[84:87], v[148:151], v[76:79]
    v_exp_f32 v46, v46
    v_cvt_pk_bf16_f32 v42, v44, v45
    v_mfma_f32_16x16x32_bf16 v[76:79], a[88:91], v[152:155], v[76:79]
    v_exp_f32 v47, v47
    s_nop 0
    v_cvt_pk_bf16_f32 v43, v46, v47
    v_mfma_f32_16x16x32_bf16 v[76:79], a[92:95], v[156:159], v[76:79]
    v_subrev_u32 v8, 131072, v24
    v_subrev_u32 v9, 131072, v25
    v_subrev_u32 v10, 131072, v26
    v_subrev_u32 v11, 131072, v27
    s_waitcnt lgkmcnt(0)
    v_mfma_f32_16x16x32_bf16 v[112:115], v[120:123], v[32:35], v[112:115]
    ds_read_b64_tr_b16 a[64:65], v12 offset:57344
    ds_read_b64_tr_b16 a[66:67], v12 offset:61440
    v_mfma_f32_16x16x32_bf16 a[0:3], a[96:99], v[32:35], a[0:3]
    ds_read_b64_tr_b16 a[68:69], v13 offset:57344
    v_exp_f32 v64, v64
    v_mfma_f32_16x16x32_bf16 a[4:7], a[100:103], v[32:35], a[4:7]
    ds_read_b64_tr_b16 a[70:71], v13 offset:61440
    v_exp_f32 v65, v65
    v_mfma_f32_16x16x32_bf16 a[8:11], a[104:107], v[32:35], a[8:11]
    ds_read_b64_tr_b16 a[72:73], v14 offset:57344
    v_exp_f32 v66, v66
    v_cvt_pk_bf16_f32 v64, v64, v65
    v_mfma_f32_16x16x32_bf16 a[12:15], a[108:111], v[32:35], a[12:15]
    ds_read_b64_tr_b16 a[74:75], v14 offset:61440
    v_exp_f32 v67, v67
    v_mfma_f32_16x16x32_bf16 a[16:19], a[112:115], v[32:35], a[16:19]
    ds_read_b64_tr_b16 a[76:77], v15 offset:57344
    v_exp_f32 v68, v68
    v_cvt_pk_bf16_f32 v65, v66, v67
    v_mfma_f32_16x16x32_bf16 a[20:23], a[116:119], v[32:35], a[20:23]
    ds_read_b64_tr_b16 a[78:79], v15 offset:61440
    v_exp_f32 v69, v69
    v_mfma_f32_16x16x32_bf16 a[24:27], a[120:123], v[32:35], a[24:27]
    ds_read_b64_tr_b16 a[80:81], v16 offset:57344
    v_exp_f32 v70, v70
    v_cvt_pk_bf16_f32 v66, v68, v69
    v_mfma_f32_16x16x32_bf16 a[28:31], a[124:127], v[32:35], a[28:31]
    ds_read_b64_tr_b16 a[82:83], v16 offset:61440
    v_exp_f32 v71, v71
    v_mfma_f32_16x16x32_bf16 v[112:115], v[124:127], v[40:43], v[112:115]
    ds_read_b64_tr_b16 a[84:85], v17 offset:57344
    v_exp_f32 v72, v72
    v_cvt_pk_bf16_f32 v67, v70, v71
    v_mfma_f32_16x16x32_bf16 a[32:35], a[96:99], v[40:43], a[32:35]
    ds_read_b64_tr_b16 a[86:87], v17 offset:61440
    v_exp_f32 v73, v73
    v_mfma_f32_16x16x32_bf16 a[36:39], a[100:103], v[40:43], a[36:39]
    ds_read_b64_tr_b16 a[88:89], v18 offset:57344
    v_exp_f32 v74, v74
    v_cvt_pk_bf16_f32 v72, v72, v73
    v_mfma_f32_16x16x32_bf16 a[40:43], a[104:107], v[40:43], a[40:43]
    ds_read_b64_tr_b16 a[90:91], v18 offset:61440
    v_exp_f32 v75, v75
    v_mfma_f32_16x16x32_bf16 a[44:47], a[108:111], v[40:43], a[44:47]
    ds_read_b64_tr_b16 a[92:93], v19 offset:57344
    v_exp_f32 v76, v76
    v_mfma_f32_16x16x32_bf16 a[48:51], a[112:115], v[40:43], a[48:51]
    ds_read_b64_tr_b16 a[94:95], v19 offset:61440
    v_cvt_pk_bf16_f32 v73, v74, v75
    v_exp_f32 v77, v77
    v_mfma_f32_16x16x32_bf16 a[52:55], a[116:119], v[40:43], a[52:55]
    v_exp_f32 v78, v78
    v_mfma_f32_16x16x32_bf16 a[56:59], a[120:123], v[40:43], a[56:59]
    v_cvt_pk_bf16_f32 v74, v76, v77
    v_exp_f32 v79, v79
    v_mfma_f32_16x16x32_bf16 a[60:63], a[124:127], v[40:43], a[60:63]
    s_nop 0
    v_cvt_pk_bf16_f32 v75, v78, v79
    s_waitcnt lgkmcnt(0)
    s_barrier
    v_mfma_f32_16x16x32_bf16 v[112:115], v[120:123], v[64:67], v[112:115]
    s_add_u32 s49, s8, 14
    ds_read_b64_tr_b16 v[192:193], v8 offset:0
    ds_read_b64_tr_b16 v[194:195], v8 offset:2048
    v_mfma_f32_16x16x32_bf16 v[112:115], v[124:127], v[72:75], v[112:115]
    s_and_b32 s49, s49, 31
    ds_read_b64_tr_b16 v[196:197], v9 offset:0
    ds_read_b64_tr_b16 v[198:199], v9 offset:2048
    v_mfma_f32_16x16x32_bf16 a[0:3], a[64:67], v[64:67], a[0:3]
    s_add_u32 m0, s56, 32768
    ds_read_b64_tr_b16 v[200:201], v10 offset:0
    s_lshl_b32 s50, s40, 2
    s_add_u32 s50, s50, s42
    s_lshl_b32 s50, s50, 5
    s_add_u32 s50, s50, s41
    s_lshl_b32 s50, s50, 7
    s_add_u32 s50, s50, 131072
    v_mfma_f32_16x16x32_bf16 a[4:7], a[68:71], v[64:67], a[4:7]
    s_lshl_b32 s52, s49, 15
    ds_read_b64_tr_b16 v[202:203], v10 offset:2048
    ds_read_b64_tr_b16 v[204:205], v11 offset:0
    v_mfma_f32_16x16x32_bf16 a[8:11], a[72:75], v[64:67], a[8:11]
    buffer_load_dwordx4 v28, s[68:71], s52 offen offset:0 lds
    v_mfma_f32_16x16x32_bf16 a[12:15], a[76:79], v[64:67], a[12:15]
    s_add_u32 s53, s52, 14336
    ds_read_b64_tr_b16 v[206:207], v11 offset:2048
    v_and_b32 v31, 15, v0
    v_lshlrev_b32 v31, 3, v31
    v_mov_b32 v20, s90
    v_mov_b32 v21, s91
    s_waitcnt vmcnt(1)
    v_mfma_f32_16x16x32_bf16 a[16:19], a[80:83], v[64:67], a[16:19]
    buffer_load_dwordx4 v29, s[68:71], s52 offen offset:1024 lds
    v_mfma_f32_16x16x32_bf16 a[20:23], a[84:87], v[64:67], a[20:23]
    buffer_load_dwordx4 v28, s[68:71], s53 offen offset:2048 lds
    v_mfma_f32_16x16x32_bf16 a[24:27], a[88:91], v[64:67], a[24:27]
    buffer_load_dwordx4 v29, s[68:71], s53 offen offset:3072 lds
    v_mfma_f32_16x16x32_bf16 a[28:31], a[92:95], v[64:67], a[28:31]
    s_add_u32 s49, s8, 15
    ds_read_b64_tr_b16 v[208:209], v8 offset:16384
    ds_read_b64_tr_b16 v[210:211], v8 offset:18432
    v_mfma_f32_16x16x32_bf16 a[32:35], a[64:67], v[72:75], a[32:35]
    s_and_b32 s49, s49, 31
    ds_read_b64_tr_b16 v[212:213], v9 offset:16384
    ds_read_b64_tr_b16 v[214:215], v9 offset:18432
    v_mfma_f32_16x16x32_bf16 a[36:39], a[68:71], v[72:75], a[36:39]
    s_add_u32 m0, s56, 49152
    ds_read_b64_tr_b16 v[216:217], v10 offset:16384
    buffer_store_dwordx2 v[20:21], v31, s[4:7], s50 offen sc1
    s_mov_b32 s51, 0x4e800000
    v_add_f32 v1, v112, v113
    v_max_f32 v2, 0x0da24260, v112
    v_max_f32 v4, 0x0da24260, v113
    v_mfma_f32_16x16x32_bf16 a[40:43], a[72:75], v[72:75], a[40:43]
    s_lshl_b32 s52, s49, 15
    ds_read_b64_tr_b16 v[218:219], v10 offset:18432
    ds_read_b64_tr_b16 v[220:221], v11 offset:16384
    v_mfma_f32_16x16x32_bf16 a[44:47], a[76:79], v[72:75], a[44:47]
    buffer_load_dwordx4 v28, s[68:71], s52 offen offset:0 lds
    v_mfma_f32_16x16x32_bf16 a[48:51], a[80:83], v[72:75], a[48:51]
    s_add_u32 s53, s52, 14336
    ds_read_b64_tr_b16 v[222:223], v11 offset:18432
    v_cmp_nge_f32 vcc, s51, v1
    v_rcp_f32 v2, v2
    v_rcp_f32 v4, v4
    s_nop 0
    v_mov_b32 v3, v2
    v_mov_b32 v5, v4
    v_mfma_f32_16x16x32_bf16 a[52:55], a[84:87], v[72:75], a[52:55]
    buffer_load_dwordx4 v29, s[68:71], s52 offen offset:1024 lds
    v_mfma_f32_16x16x32_bf16 a[56:59], a[88:91], v[72:75], a[56:59]
    buffer_load_dwordx4 v28, s[68:71], s53 offen offset:2048 lds
    v_mfma_f32_16x16x32_bf16 a[60:63], a[92:95], v[72:75], a[60:63]
    buffer_load_dwordx4 v29, s[68:71], s53 offen offset:3072 lds
    s_nop 1
    s_cbranch_vccnz L_slow0
L_back0:
    v_subrev_u32 v12, 65536, v24
    v_subrev_u32 v13, 65536, v25
    v_subrev_u32 v14, 65536, v26
    v_subrev_u32 v15, 65536, v27
    v_add_u32 v16, 0x100000, v7
    s_and_b32 s60, s60, 0xffff
    s_and_b32 s61, s61, 0xffff
    s_and_b32 s62, s62, 0xffff
    s_and_b32 s63, s63, 0xffff
    s_lshl_b32 s49, s43, 2
    s_add_u32 s49, s49, s64
    s_lshl_b32 s49, s49, 2
    s_add_u32 s49, s49, s42
    s_lshl_b32 s49, s49, 10
    v_and_b32 v6, 7, v0
    v_lshlrev_b32 v6, 7, v6
    v_add_u32 v6, s49, v6
    s_mov_b32 s93, 131072
    s_mov_b32 s92, 0
    s_waitcnt lgkmcnt(0)
    v_accvgpr_read_b32 v128, a0
    v_accvgpr_read_b32 v129, a1
    v_accvgpr_read_b32 v130, a2
    v_accvgpr_read_b32 v131, a3
    v_accvgpr_read_b32 v132, a4
    v_accvgpr_read_b32 v133, a5
    v_accvgpr_read_b32 v134, a6
    v_accvgpr_read_b32 v135, a7
    v_pk_mul_f32 v[128:129], v[128:129], v[2:3]
    v_pk_mul_f32 v[130:131], v[130:131], v[2:3]
    v_pk_mul_f32 v[132:133], v[132:133], v[2:3]
    v_pk_mul_f32 v[134:135], v[134:135], v[2:3]
    v_cvt_pk_bf16_f32 v128, v128, v129
    v_cvt_pk_bf16_f32 v129, v130, v131
    v_cvt_pk_bf16_f32 v130, v132, v133
    v_cvt_pk_bf16_f32 v131, v134, v135
    buffer_store_dwordx4 v[128:131], v7, s[36:39], s60 offen offset:0 sc1
    v_accvgpr_read_b32 v160, a32
    v_accvgpr_read_b32 v161, a33
    v_accvgpr_read_b32 v162, a34
    v_accvgpr_read_b32 v163, a35
    v_accvgpr_read_b32 v164, a36
    v_accvgpr_read_b32 v165, a37
    v_accvgpr_read_b32 v166, a38
    v_accvgpr_read_b32 v167, a39
    v_pk_mul_f32 v[160:161], v[160:161], v[4:5]
    v_pk_mul_f32 v[162:163], v[162:163], v[4:5]
    v_pk_mul_f32 v[164:165], v[164:165], v[4:5]
    v_pk_mul_f32 v[166:167], v[166:167], v[4:5]
    v_cvt_pk_bf16_f32 v160, v160, v161
    v_cvt_pk_bf16_f32 v161, v162, v163
    v_cvt_pk_bf16_f32 v162, v164, v165
    v_cvt_pk_bf16_f32 v163, v166, v167
    buffer_store_dwordx4 v[160:163], v7, s[36:39], s60 offen offset:1024 sc1
    v_accvgpr_read_b32 v136, a8
    v_accvgpr_read_b32 v137, a9
    v_accvgpr_read_b32 v138, a10
    v_accvgpr_read_b32 v139, a11
    v_accvgpr_read_b32 v140, a12
    v_accvgpr_read_b32 v141, a13
    v_accvgpr_read_b32 v142, a14
    v_accvgpr_read_b32 v143, a15
    v_pk_mul_f32 v[136:137], v[136:137], v[2:3]
    v_pk_mul_f32 v[138:139], v[138:139], v[2:3]
    v_pk_mul_f32 v[140:141], v[140:141], v[2:3]
    v_pk_mul_f32 v[142:143], v[142:143], v[2:3]
    v_cvt_pk_bf16_f32 v136, v136, v137
    v_cvt_pk_bf16_f32 v137, v138, v139
    v_cvt_pk_bf16_f32 v138, v140, v141
    v_cvt_pk_bf16_f32 v139, v142, v143
    buffer_store_dwordx4 v[136:139], v7, s[36:39], s61 offen offset:0 sc1
    v_accvgpr_read_b32 v168, a40
    v_accvgpr_read_b32 v169, a41
    v_accvgpr_read_b32 v170, a42
    v_accvgpr_read_b32 v171, a43
    v_accvgpr_read_b32 v172, a44
    v_accvgpr_read_b32 v173, a45
    v_accvgpr_read_b32 v174, a46
    v_accvgpr_read_b32 v175, a47
    v_pk_mul_f32 v[168:169], v[168:169], v[4:5]
    v_pk_mul_f32 v[170:171], v[170:171], v[4:5]
    v_pk_mul_f32 v[172:173], v[172:173], v[4:5]
    v_pk_mul_f32 v[174:175], v[174:175], v[4:5]
    v_cvt_pk_bf16_f32 v168, v168, v169
    v_cvt_pk_bf16_f32 v169, v170, v171
    v_cvt_pk_bf16_f32 v170, v172, v173
    v_cvt_pk_bf16_f32 v171, v174, v175
    buffer_store_dwordx4 v[168:171], v7, s[36:39], s61 offen offset:1024 sc1
    v_accvgpr_read_b32 v144, a16
    v_accvgpr_read_b32 v145, a17
    v_accvgpr_read_b32 v146, a18
    v_accvgpr_read_b32 v147, a19
    v_accvgpr_read_b32 v148, a20
    v_accvgpr_read_b32 v149, a21
    v_accvgpr_read_b32 v150, a22
    v_accvgpr_read_b32 v151, a23
    v_pk_mul_f32 v[144:145], v[144:145], v[2:3]
    v_pk_mul_f32 v[146:147], v[146:147], v[2:3]
    v_pk_mul_f32 v[148:149], v[148:149], v[2:3]
    v_pk_mul_f32 v[150:151], v[150:151], v[2:3]
    v_cvt_pk_bf16_f32 v144, v144, v145
    v_cvt_pk_bf16_f32 v145, v146, v147
    v_cvt_pk_bf16_f32 v146, v148, v149
    v_cvt_pk_bf16_f32 v147, v150, v151
    buffer_store_dwordx4 v[144:147], v7, s[36:39], s62 offen offset:0 sc1
    v_accvgpr_read_b32 v176, a48
    v_accvgpr_read_b32 v177, a49
    v_accvgpr_read_b32 v178, a50
    v_accvgpr_read_b32 v179, a51
    v_accvgpr_read_b32 v180, a52
L_pad7:
    s_cbranch_execz L_ret1
    v_accvgpr_read_b32 v181, a53
    v_accvgpr_read_b32 v182, a54
    v_accvgpr_read_b32 v183, a55
    v_pk_mul_f32 v[176:177], v[176:177], v[4:5]
    v_pk_mul_f32 v[178:179], v[178:179], v[4:5]
    v_pk_mul_f32 v[180:181], v[180:181], v[4:5]
    v_pk_mul_f32 v[182:183], v[182:183], v[4:5]
    v_cvt_pk_bf16_f32 v176, v176, v177
    v_cvt_pk_bf16_f32 v177, v178, v179
    v_cvt_pk_bf16_f32 v178, v180, v181
    v_cvt_pk_bf16_f32 v179, v182, v183
    buffer_store_dwordx4 v[176:179], v7, s[36:39], s62 offen offset:1024 sc1
    v_accvgpr_read_b32 v152, a24
    v_accvgpr_read_b32 v153, a25
    v_accvgpr_read_b32 v154, a26
    v_accvgpr_read_b32 v155, a27
    v_accvgpr_read_b32 v156, a28
    v_accvgpr_read_b32 v157, a29
    v_accvgpr_read_b32 v158, a30
    v_accvgpr_read_b32 v159, a31
    v_pk_mul_f32 v[152:153], v[152:153], v[2:3]
    v_pk_mul_f32 v[154:155], v[154:155], v[2:3]
    v_pk_mul_f32 v[156:157], v[156:157], v[2:3]
    v_pk_mul_f32 v[158:159], v[158:159], v[2:3]
    v_cvt_pk_bf16_f32 v152, v152, v153
    v_cvt_pk_bf16_f32 v153, v154, v155
    v_cvt_pk_bf16_f32 v154, v156, v157
    v_cvt_pk_bf16_f32 v155, v158, v159
    buffer_store_dwordx4 v[152:155], v7, s[36:39], s63 offen offset:0 sc1
    v_accvgpr_read_b32 v184, a56
    v_accvgpr_read_b32 v185, a57
    v_accvgpr_read_b32 v186, a58
    v_accvgpr_read_b32 v187, a59
    v_accvgpr_read_b32 v188, a60
    v_accvgpr_read_b32 v189, a61
    v_accvgpr_read_b32 v190, a62
    v_accvgpr_read_b32 v191, a63
    v_pk_mul_f32 v[184:185], v[184:185], v[4:5]
    v_pk_mul_f32 v[186:187], v[186:187], v[4:5]
    v_pk_mul_f32 v[188:189], v[188:189], v[4:5]
    v_pk_mul_f32 v[190:191], v[190:191], v[4:5]
    v_cvt_pk_bf16_f32 v184, v184, v185
    v_cvt_pk_bf16_f32 v185, v186, v187
    v_cvt_pk_bf16_f32 v186, v188, v189
    v_cvt_pk_bf16_f32 v187, v190, v191
    buffer_store_dwordx4 v[184:187], v7, s[36:39], s63 offen offset:1024 sc1
    s_add_u32 s49, s8, 16
    s_and_b32 s49, s49, 31
    s_add_u32 m0, s56, 98304
    s_lshl_b32 s52, s49, 15
    buffer_load_dwordx4 v28, s[68:71], s52 offen offset:0 lds
    s_add_u32 s53, s52, 14336
    buffer_load_dwordx4 v29, s[68:71], s52 offen offset:1024 lds
    buffer_load_dwordx4 v28, s[68:71], s53 offen offset:2048 lds
    buffer_load_dwordx4 v29, s[68:71], s53 offen offset:3072 lds
    s_add_u32 s49, s8, 17
    s_and_b32 s49, s49, 31
    s_add_u32 m0, s56, 114688
    s_lshl_b32 s52, s49, 15
    buffer_load_dwordx4 v28, s[68:71], s52 offen offset:0 lds
    s_add_u32 s53, s52, 14336
    buffer_load_dwordx4 v29, s[68:71], s52 offen offset:1024 lds
    buffer_load_dwordx4 v28, s[68:71], s53 offen offset:2048 lds
    buffer_load_dwordx4 v29, s[68:71], s53 offen offset:3072 lds
    s_add_u32 s49, s8, 18
    s_and_b32 s49, s49, 31
    s_add_u32 m0, s56, 0
    s_lshl_b32 s52, s49, 15
    buffer_load_dwordx4 v28, s[68:71], s52 offen offset:0 lds
    s_add_u32 s53, s52, 14336
    buffer_load_dwordx4 v29, s[68:71], s52 offen offset:1024 lds
    buffer_load_dwordx4 v28, s[68:71], s53 offen offset:2048 lds
    buffer_load_dwordx4 v29, s[68:71], s53 offen offset:3072 lds
    s_add_u32 s49, s8, 19
    s_and_b32 s49, s49, 31
    s_add_u32 m0, s56, 16384
    s_lshl_b32 s52, s49, 15
    buffer_load_dwordx4 v28, s[68:71], s52 offen offset:0 lds
    s_add_u32 s53, s52, 14336
    buffer_load_dwordx4 v29, s[68:71], s52 offen offset:1024 lds
    buffer_load_dwordx4 v28, s[68:71], s53 offen offset:2048 lds
    buffer_load_dwordx4 v29, s[68:71], s53 offen offset:3072 lds
    ds_read_b64_tr_b16 v[224:225], v12 offset:0
    ds_read_b64_tr_b16 v[226:227], v12 offset:2048
    ds_read_b64_tr_b16 v[228:229], v13 offset:0
    ds_read_b64_tr_b16 v[230:231], v13 offset:2048
    ds_read_b64_tr_b16 v[232:233], v14 offset:0
    ds_read_b64_tr_b16 v[234:235], v14 offset:2048
    ds_read_b64_tr_b16 v[236:237], v15 offset:0
    ds_read_b64_tr_b16 v[238:239], v15 offset:2048
    s_waitcnt lgkmcnt(0)
    s_add_u32 s49, s8, 20
    s_and_b32 s49, s49, 31
    s_add_u32 m0, s56, 65536
    s_lshl_b32 s52, s49, 15
    buffer_load_dwordx4 v28, s[68:71], s52 offen offset:0 lds
    s_add_u32 s53, s52, 14336
    buffer_load_dwordx4 v29, s[68:71], s52 offen offset:1024 lds
    buffer_load_dwordx4 v28, s[68:71], s53 offen offset:2048 lds
    buffer_load_dwordx4 v29, s[68:71], s53 offen offset:3072 lds
    buffer_load_dwordx2 v[22:23], v6, s[4:7], s93 offen sc1
    ds_read_b64_tr_b16 v[240:241], v12 offset:16384
    ds_read_b64_tr_b16 v[242:243], v12 offset:18432
    ds_read_b64_tr_b16 v[244:245], v13 offset:16384
    ds_read_b64_tr_b16 v[246:247], v13 offset:18432
    ds_read_b64_tr_b16 v[248:249], v14 offset:16384
    ds_read_b64_tr_b16 v[250:251], v14 offset:18432
    ds_read_b64_tr_b16 v[252:253], v15 offset:16384
    ds_read_b64_tr_b16 v[254:255], v15 offset:18432
    s_waitcnt lgkmcnt(0)
    s_add_u32 s49, s8, 21
    s_and_b32 s49, s49, 31
    s_add_u32 m0, s56, 81920
    s_lshl_b32 s52, s49, 15
    buffer_load_dwordx4 v28, s[68:71], s52 offen offset:0 lds
    s_add_u32 s53, s52, 14336
    buffer_load_dwordx4 v29, s[68:71], s52 offen offset:1024 lds
    buffer_load_dwordx4 v28, s[68:71], s53 offen offset:2048 lds
    buffer_load_dwordx4 v29, s[68:71], s53 offen offset:3072 lds
    ds_read_b64_tr_b16 a[64:65], v24 offset:0
    ds_read_b64_tr_b16 a[66:67], v24 offset:2048
    ds_read_b64_tr_b16 a[68:69], v25 offset:0
    ds_read_b64_tr_b16 a[70:71], v25 offset:2048
    ds_read_b64_tr_b16 a[72:73], v26 offset:0
    ds_read_b64_tr_b16 a[74:75], v26 offset:2048
    ds_read_b64_tr_b16 a[76:77], v27 offset:0
    ds_read_b64_tr_b16 a[78:79], v27 offset:2048
    s_waitcnt lgkmcnt(0)
    s_add_u32 s49, s8, 22
    s_and_b32 s49, s49, 31
    s_add_u32 m0, s56, 131072
    s_lshl_b32 s52, s49, 15
    buffer_load_dwordx4 v28, s[68:71], s52 offen offset:0 lds
    s_add_u32 s53, s52, 14336
    buffer_load_dwordx4 v29, s[68:71], s52 offen offset:1024 lds
    buffer_load_dwordx4 v28, s[68:71], s53 offen offset:2048 lds
    buffer_load_dwordx4 v29, s[68:71], s53 offen offset:3072 lds
    ds_read_b64_tr_b16 a[80:81], v24 offset:16384
    ds_read_b64_tr_b16 a[82:83], v24 offset:18432
    ds_read_b64_tr_b16 a[84:85], v25 offset:16384
    ds_read_b64_tr_b16 a[86:87], v25 offset:18432
    ds_read_b64_tr_b16 a[88:89], v26 offset:16384
    ds_read_b64_tr_b16 a[90:91], v26 offset:18432
    ds_read_b64_tr_b16 a[92:93], v27 offset:16384
    ds_read_b64_tr_b16 a[94:95], v27 offset:18432
    s_waitcnt lgkmcnt(0)
    s_add_u32 s49, s8, 23
    s_and_b32 s49, s49, 31
    s_add_u32 m0, s56, 147456
    s_lshl_b32 s52, s49, 15
    buffer_load_dwordx4 v28, s[68:71], s52 offen offset:0 lds
    s_add_u32 s53, s52, 14336
    buffer_load_dwordx4 v29, s[68:71], s52 offen offset:1024 lds
    buffer_load_dwordx4 v28, s[68:71], s53 offen offset:2048 lds
    buffer_load_dwordx4 v29, s[68:71], s53 offen offset:3072 lds
    s_mov_b32 s48, 0x40000
    s_waitcnt vmcnt(12)
    s_branch L_chk1
L_poll1:
    s_sleep 2
    buffer_load_dwordx2 v[22:23], v6, s[4:7], s93 offen sc1
    s_waitcnt vmcnt(0)
L_chk1:
    v_cmp_ne_u64 vcc, s[90:91], v[22:23]
    s_sub_u32 s48, s48, 1
    s_cbranch_scc1 L_go1
    s_nop 2
    s_cbranch_vccnz L_poll1
L_go1:
    s_add_u32 s49, s8, 14
    s_and_b32 s49, s49, 31
    s_lshl_b32 s51, s49, 11
    buffer_load_dwordx4 v[96:99], v16, s[72:75], s51 offen offset:0 sc1
    buffer_load_dwordx4 v[100:103], v16, s[72:75], s51 offen offset:1024 sc1
    s_add_u32 s49, s8, 0
    s_and_b32 s49, s49, 31
    s_lshl_b32 s51, s49, 11
    buffer_load_dwordx4 v[104:107], v16, s[72:75], s51 offen offset:0 sc1
    buffer_load_dwordx4 v[108:111], v16, s[72:75], s51 offen offset:1024 sc1
    s_add_u32 s49, s8, 1
    s_and_b32 s49, s49, 31
    s_lshl_b32 s51, s49, 11
    buffer_load_dwordx4 v[112:115], v16, s[72:75], s51 offen offset:0 sc1
    buffer_load_dwordx4 v[116:119], v16, s[72:75], s51 offen offset:1024 sc1
    s_add_u32 s49, s8, 2
    s_and_b32 s49, s49, 31
    s_lshl_b32 s51, s49, 11
    buffer_load_dwordx4 v[120:123], v16, s[72:75], s51 offen offset:0 sc1
    buffer_load_dwordx4 v[124:127], v16, s[72:75], s51 offen offset:1024 sc1
    s_add_u32 s49, s8, 15
    s_and_b32 s49, s49, 31
    s_lshl_b32 s51, s49, 11
    buffer_load_dwordx4 v[128:131], v16, s[72:75], s51 offen offset:0 sc1
    buffer_load_dwordx4 v[132:135], v16, s[72:75], s51 offen offset:1024 sc1
    ds_read_b64_tr_b16 a[96:97], v8 offset:32768
    ds_read_b64_tr_b16 a[98:99], v8 offset:34816
    ds_read_b64_tr_b16 a[100:101], v9 offset:32768
    ds_read_b64_tr_b16 a[102:103], v9 offset:34816
    ds_read_b64_tr_b16 a[104:105], v10 offset:32768
    ds_read_b64_tr_b16 a[106:107], v10 offset:34816
    ds_read_b64_tr_b16 a[108:109], v11 offset:32768
    ds_read_b64_tr_b16 a[110:111], v11 offset:34816
    s_waitcnt vmcnt(8) lgkmcnt(4)
    v_mfma_f32_16x16x32_bf16 v[32:35], a[96:99], v[96:99], 0
    s_add_u32 s49, s8, 3
    s_and_b32 s49, s49, 31
    v_mfma_f32_16x16x32_bf16 v[36:39], a[96:99], v[100:103], 0
    s_lshl_b32 s51, s49, 11
    v_mfma_f32_16x16x32_bf16 v[40:43], a[100:103], v[96:99], 0
    buffer_load_dwordx4 v[136:139], v16, s[72:75], s51 offen offset:0 sc1
    v_mfma_f32_16x16x32_bf16 v[44:47], a[100:103], v[100:103], 0
    s_waitcnt lgkmcnt(0)
    v_mfma_f32_16x16x32_bf16 v[48:51], a[104:107], v[96:99], 0
    s_lshl_b32 s50, s40, 2
    s_add_u32 s50, s50, s42
    s_lshl_b32 s50, s50, 5
    s_add_u32 s50, s50, s41
    s_lshl_b32 s50, s50, 7
    s_add_u32 s50, s50, 0
    v_and_b32 v31, 15, v0
    v_lshlrev_b32 v31, 3, v31
    v_mov_b32 v20, s90
    v_mov_b32 v21, s91
    buffer_store_dwordx2 v[20:21], v31, s[4:7], s50 offen sc1
    v_mfma_f32_16x16x32_bf16 v[52:55], a[104:107], v[100:103], 0
    buffer_load_dwordx4 v[140:143], v16, s[72:75], s51 offen offset:1024 sc1
    v_mfma_f32_16x16x32_bf16 v[56:59], a[108:111], v[96:99], 0
    v_mfma_f32_16x16x32_bf16 v[60:63], a[108:111], v[100:103], 0
    s_add_u32 s49, s8, 24
    s_and_b32 s49, s49, 31
    s_add_u32 m0, s56, 32768
    s_lshl_b32 s52, s49, 15
    buffer_load_dwordx4 v28, s[68:71], s52 offen offset:0 lds
    s_add_u32 s53, s52, 14336
    buffer_load_dwordx4 v29, s[68:71], s52 offen offset:1024 lds
    buffer_load_dwordx4 v28, s[68:71], s53 offen offset:2048 lds
    buffer_load_dwordx4 v29, s[68:71], s53 offen offset:3072 lds
    s_waitcnt vmcnt(13)
    v_mfma_f32_16x16x32_bf16 v[32:35], a[128:131], v[104:107], v[32:35]
    s_add_u32 s49, s8, 4
    s_and_b32 s49, s49, 31
    v_mfma_f32_16x16x32_bf16 v[36:39], a[128:131], v[108:111], v[36:39]
    s_lshl_b32 s51, s49, 11
    v_mfma_f32_16x16x32_bf16 v[40:43], a[132:135], v[104:107], v[40:43]
    buffer_load_dwordx4 v[96:99], v16, s[72:75], s51 offen offset:0 sc1
    v_mfma_f32_16x16x32_bf16 v[44:47], a[132:135], v[108:111], v[44:47]
    v_mfma_f32_16x16x32_bf16 v[48:51], a[136:139], v[104:107], v[48:51]
    v_mfma_f32_16x16x32_bf16 v[52:55], a[136:139], v[108:111], v[52:55]
    buffer_load_dwordx4 v[100:103], v16, s[72:75], s51 offen offset:1024 sc1
    v_mfma_f32_16x16x32_bf16 v[56:59], a[140:143], v[104:107], v[56:59]
    v_mfma_f32_16x16x32_bf16 v[60:63], a[140:143], v[108:111], v[60:63]
    s_waitcnt vmcnt(13)
    v_mfma_f32_16x16x32_bf16 v[32:35], a[144:147], v[112:115], v[32:35]
    s_add_u32 s49, s8, 5
    s_and_b32 s49, s49, 31
    v_mfma_f32_16x16x32_bf16 v[36:39], a[144:147], v[116:119], v[36:39]
    s_lshl_b32 s51, s49, 11
    v_mfma_f32_16x16x32_bf16 v[40:43], a[148:151], v[112:115], v[40:43]
    buffer_load_dwordx4 v[104:107], v16, s[72:75], s51 offen offset:0 sc1
    v_mfma_f32_16x16x32_bf16 v[44:47], a[148:151], v[116:119], v[44:47]
    v_mfma_f32_16x16x32_bf16 v[48:51], a[152:155], v[112:115], v[48:51]
    v_mfma_f32_16x16x32_bf16 v[52:55], a[152:155], v[116:119], v[52:55]
    buffer_load_dwordx4 v[108:111], v16, s[72:75], s51 offen offset:1024 sc1
    v_mfma_f32_16x16x32_bf16 v[56:59], a[156:159], v[112:115], v[56:59]
    v_mfma_f32_16x16x32_bf16 v[60:63], a[156:159], v[116:119], v[60:63]
    s_waitcnt vmcnt(13)
    v_mfma_f32_16x16x32_bf16 v[32:35], a[160:163], v[120:123], v[32:35]
    s_add_u32 s49, s8, 6
    s_and_b32 s49, s49, 31
    ds_read_b64_tr_b16 a[112:113], v8 offset:49152
    v_mfma_f32_16x16x32_bf16 v[36:39], a[160:163], v[124:127], v[36:39]
    s_lshl_b32 s51, s49, 11
    ds_read_b64_tr_b16 a[114:115], v8 offset:51200
    ds_read_b64_tr_b16 a[116:117], v9 offset:49152
    v_mfma_f32_16x16x32_bf16 v[40:43], a[164:167], v[120:123], v[40:43]
    buffer_load_dwordx4 v[112:115], v16, s[72:75], s51 offen offset:0 sc1
    v_mfma_f32_16x16x32_bf16 v[44:47], a[164:167], v[124:127], v[44:47]
    ds_read_b64_tr_b16 a[118:119], v9 offset:51200
    v_mfma_f32_16x16x32_bf16 v[48:51], a[168:171], v[120:123], v[48:51]
    ds_read_b64_tr_b16 a[120:121], v10 offset:49152
    ds_read_b64_tr_b16 a[122:123], v10 offset:51200
    v_mfma_f32_16x16x32_bf16 v[52:55], a[168:171], v[124:127], v[52:55]
    buffer_load_dwordx4 v[116:119], v16, s[72:75], s51 offen offset:1024 sc1
    v_mfma_f32_16x16x32_bf16 v[56:59], a[172:175], v[120:123], v[56:59]
    ds_read_b64_tr_b16 a[124:125], v11 offset:49152
    v_mfma_f32_16x16x32_bf16 v[60:63], a[172:175], v[124:127], v[60:63]
    ds_read_b64_tr_b16 a[126:127], v11 offset:51200
    s_waitcnt vmcnt(13) lgkmcnt(4)
    v_mfma_f32_16x16x32_bf16 v[32:35], a[112:115], v[128:131], v[32:35]
    s_add_u32 s49, s8, 16
    s_and_b32 s49, s49, 31
    v_mfma_f32_16x16x32_bf16 v[36:39], a[112:115], v[132:135], v[36:39]
    s_lshl_b32 s51, s49, 11
    v_mfma_f32_16x16x32_bf16 v[40:43], a[116:119], v[128:131], v[40:43]
    buffer_load_dwordx4 v[120:123], v16, s[72:75], s51 offen offset:0 sc1
    v_mfma_f32_16x16x32_bf16 v[44:47], a[116:119], v[132:135], v[44:47]
    s_waitcnt lgkmcnt(0)
    v_mfma_f32_16x16x32_bf16 v[48:51], a[120:123], v[128:131], v[48:51]
    v_mfma_f32_16x16x32_bf16 v[52:55], a[120:123], v[132:135], v[52:55]
    buffer_load_dwordx4 v[124:127], v16, s[72:75], s51 offen offset:1024 sc1
    v_mfma_f32_16x16x32_bf16 v[56:59], a[124:127], v[128:131], v[56:59]
    v_mfma_f32_16x16x32_bf16 v[60:63], a[124:127], v[132:135], v[60:63]
    s_add_u32 s49, s8, 25
    s_and_b32 s49, s49, 31
    s_add_u32 m0, s56, 49152
    s_lshl_b32 s52, s49, 15
    buffer_load_dwordx4 v28, s[68:71], s52 offen offset:0 lds
    s_add_u32 s53, s52, 14336
    buffer_load_dwordx4 v29, s[68:71], s52 offen offset:1024 lds
    buffer_load_dwordx4 v28, s[68:71], s53 offen offset:2048 lds
    buffer_load_dwordx4 v29, s[68:71], s53 offen offset:3072 lds
    s_waitcnt vmcnt(16)
    v_mfma_f32_16x16x32_bf16 v[32:35], a[176:179], v[136:139], v[32:35]
    s_add_u32 s49, s8, 7
    s_and_b32 s49, s49, 31
    v_mfma_f32_16x16x32_bf16 v[36:39], a[176:179], v[140:143], v[36:39]
    s_lshl_b32 s51, s49, 11
    v_mfma_f32_16x16x32_bf16 v[40:43], a[180:183], v[136:139], v[40:43]
    buffer_load_dwordx4 v[128:131], v16, s[72:75], s51 offen offset:0 sc1
    v_mfma_f32_16x16x32_bf16 v[44:47], a[180:183], v[140:143], v[44:47]
    v_mfma_f32_16x16x32_bf16 v[48:51], a[184:187], v[136:139], v[48:51]
    v_mfma_f32_16x16x32_bf16 v[52:55], a[184:187], v[140:143], v[52:55]
    buffer_load_dwordx4 v[132:135], v16, s[72:75], s51 offen offset:1024 sc1
    v_mfma_f32_16x16x32_bf16 v[56:59], a[188:191], v[136:139], v[56:59]
    v_mfma_f32_16x16x32_bf16 v[60:63], a[188:191], v[140:143], v[60:63]
    s_waitcnt vmcnt(12)
    v_mfma_f32_16x16x32_bf16 v[32:35], v[192:195], v[96:99], v[32:35]
    s_add_u32 s49, s8, 8
    s_and_b32 s49, s49, 31
    v_mfma_f32_16x16x32_bf16 v[36:39], v[192:195], v[100:103], v[36:39]
    s_lshl_b32 s51, s49, 11
    v_mfma_f32_16x16x32_bf16 v[40:43], v[196:199], v[96:99], v[40:43]
    buffer_load_dwordx4 v[136:139], v16, s[72:75], s51 offen offset:0 sc1
    v_mfma_f32_16x16x32_bf16 v[44:47], v[196:199], v[100:103], v[44:47]
    v_mfma_f32_16x16x32_bf16 v[48:51], v[200:203], v[96:99], v[48:51]
    v_mfma_f32_16x16x32_bf16 v[52:55], v[200:203], v[100:103], v[52:55]
    buffer_load_dwordx4 v[140:143], v16, s[72:75], s51 offen offset:1024 sc1
    v_mfma_f32_16x16x32_bf16 v[56:59], v[204:207], v[96:99], v[56:59]
    v_mfma_f32_16x16x32_bf16 v[60:63], v[204:207], v[100:103], v[60:63]
    s_waitcnt vmcnt(12)
    v_mfma_f32_16x16x32_bf16 v[32:35], a[192:195], v[104:107], v[32:35]
    s_add_u32 s49, s8, 9
    s_and_b32 s49, s49, 31
    v_mfma_f32_16x16x32_bf16 v[36:39], a[192:195], v[108:111], v[36:39]
    s_lshl_b32 s51, s49, 11
    v_mfma_f32_16x16x32_bf16 v[40:43], a[196:199], v[104:107], v[40:43]
    buffer_load_dwordx4 v[96:99], v16, s[72:75], s51 offen offset:0 sc1
    v_mfma_f32_16x16x32_bf16 v[44:47], a[196:199], v[108:111], v[44:47]
    v_mfma_f32_16x16x32_bf16 v[48:51], a[200:203], v[104:107], v[48:51]
    v_mfma_f32_16x16x32_bf16 v[52:55], a[200:203], v[108:111], v[52:55]
    buffer_load_dwordx4 v[100:103], v16, s[72:75], s51 offen offset:1024 sc1
    v_mfma_f32_16x16x32_bf16 v[56:59], a[204:207], v[104:107], v[56:59]
    v_mfma_f32_16x16x32_bf16 v[60:63], a[204:207], v[108:111], v[60:63]
    s_waitcnt vmcnt(12)
    v_mfma_f32_16x16x32_bf16 v[32:35], a[208:211], v[112:115], v[32:35]
    s_add_u32 s49, s8, 17
    s_and_b32 s49, s49, 31
    ds_read_b64_tr_b16 a[0:1], v12 offset:32768
    v_mfma_f32_16x16x32_bf16 v[36:39], a[208:211], v[116:119], v[36:39]
    s_lshl_b32 s51, s49, 11
    ds_read_b64_tr_b16 a[2:3], v12 offset:34816
    ds_read_b64_tr_b16 a[4:5], v13 offset:32768
    v_mfma_f32_16x16x32_bf16 v[40:43], a[212:215], v[112:115], v[40:43]
    buffer_load_dwordx4 v[104:107], v16, s[72:75], s51 offen offset:0 sc1
    v_mfma_f32_16x16x32_bf16 v[44:47], a[212:215], v[116:119], v[44:47]
    ds_read_b64_tr_b16 a[6:7], v13 offset:34816
    v_mfma_f32_16x16x32_bf16 v[48:51], a[216:219], v[112:115], v[48:51]
    ds_read_b64_tr_b16 a[8:9], v14 offset:32768
    ds_read_b64_tr_b16 a[10:11], v14 offset:34816
    v_mfma_f32_16x16x32_bf16 v[52:55], a[216:219], v[116:119], v[52:55]
    buffer_load_dwordx4 v[108:111], v16, s[72:75], s51 offen offset:1024 sc1
    v_mfma_f32_16x16x32_bf16 v[56:59], a[220:223], v[112:115], v[56:59]
    ds_read_b64_tr_b16 a[12:13], v15 offset:32768
    v_mfma_f32_16x16x32_bf16 v[60:63], a[220:223], v[116:119], v[60:63]
    ds_read_b64_tr_b16 a[14:15], v15 offset:34816
    s_waitcnt vmcnt(12) lgkmcnt(4)
    v_mfma_f32_16x16x32_bf16 v[32:35], a[0:3], v[120:123], v[32:35]
    s_add_u32 s49, s8, 10
    s_and_b32 s49, s49, 31
    v_mfma_f32_16x16x32_bf16 v[36:39], a[0:3], v[124:127], v[36:39]
    s_lshl_b32 s51, s49, 11
    v_mfma_f32_16x16x32_bf16 v[40:43], a[4:7], v[120:123], v[40:43]
    buffer_load_dwordx4 v[112:115], v16, s[72:75], s51 offen offset:0 sc1
    v_mfma_f32_16x16x32_bf16 v[44:47], a[4:7], v[124:127], v[44:47]
    s_waitcnt lgkmcnt(0)
    v_mfma_f32_16x16x32_bf16 v[48:51], a[8:11], v[120:123], v[48:51]
    v_mfma_f32_16x16x32_bf16 v[52:55], a[8:11], v[124:127], v[52:55]
    buffer_load_dwordx4 v[116:119], v16, s[72:75], s51 offen offset:1024 sc1
    v_mfma_f32_16x16x32_bf16 v[56:59], a[12:15], v[120:123], v[56:59]
    v_mfma_f32_16x16x32_bf16 v[60:63], a[12:15], v[124:127], v[60:63]
    s_add_u32 s49, s8, 26
    s_and_b32 s49, s49, 31
    s_add_u32 m0, s56, 98304
    s_lshl_b32 s52, s49, 15
    buffer_load_dwordx4 v28, s[68:71], s52 offen offset:0 lds
    s_add_u32 s53, s52, 14336
    buffer_load_dwordx4 v29, s[68:71], s52 offen offset:1024 lds
    buffer_load_dwordx4 v28, s[68:71], s53 offen offset:2048 lds
    buffer_load_dwordx4 v29, s[68:71], s53 offen offset:3072 lds
    s_waitcnt vmcnt(12)
    v_mfma_f32_16x16x32_bf16 v[32:35], v[208:211], v[128:131], v[32:35]
    s_add_u32 s49, s8, 11
    s_and_b32 s49, s49, 31
    v_mfma_f32_16x16x32_bf16 v[36:39], v[208:211], v[132:135], v[36:39]
    s_lshl_b32 s51, s49, 11
    v_mfma_f32_16x16x32_bf16 v[40:43], v[212:215], v[128:131], v[40:43]
    buffer_load_dwordx4 v[120:123], v16, s[72:75], s51 offen offset:0 sc1
    v_mfma_f32_16x16x32_bf16 v[44:47], v[212:215], v[132:135], v[44:47]
    v_mfma_f32_16x16x32_bf16 v[48:51], v[216:219], v[128:131], v[48:51]
    v_mfma_f32_16x16x32_bf16 v[52:55], v[216:219], v[132:135], v[52:55]
    buffer_load_dwordx4 v[124:127], v16, s[72:75], s51 offen offset:1024 sc1
    v_mfma_f32_16x16x32_bf16 v[56:59], v[220:223], v[128:131], v[56:59]
    v_mfma_f32_16x16x32_bf16 v[60:63], v[220:223], v[132:135], v[60:63]
    s_waitcnt vmcnt(12)
    v_mfma_f32_16x16x32_bf16 v[32:35], a[224:227], v[136:139], v[32:35]
    s_add_u32 s49, s8, 12
    s_and_b32 s49, s49, 31
    v_mfma_f32_16x16x32_bf16 v[36:39], a[224:227], v[140:143], v[36:39]
    s_lshl_b32 s51, s49, 11
    v_mfma_f32_16x16x32_bf16 v[40:43], a[228:231], v[136:139], v[40:43]
    buffer_load_dwordx4 v[128:131], v16, s[72:75], s51 offen offset:0 sc1
    v_mfma_f32_16x16x32_bf16 v[44:47], a[228:231], v[140:143], v[44:47]
    v_mfma_f32_16x16x32_bf16 v[48:51], a[232:235], v[136:139], v[48:51]
    v_mfma_f32_16x16x32_bf16 v[52:55], a[232:235], v[140:143], v[52:55]
    buffer_load_dwordx4 v[132:135], v16, s[72:75], s51 offen offset:1024 sc1
    v_mfma_f32_16x16x32_bf16 v[56:59], a[236:239], v[136:139], v[56:59]
    v_mfma_f32_16x16x32_bf16 v[60:63], a[236:239], v[140:143], v[60:63]
    s_waitcnt vmcnt(12)
    v_mfma_f32_16x16x32_bf16 v[32:35], v[224:227], v[96:99], v[32:35]
    s_add_u32 s49, s8, 13
    s_and_b32 s49, s49, 31
    ds_read_b64_tr_b16 a[16:17], v12 offset:49152
    v_mfma_f32_16x16x32_bf16 v[36:39], v[224:227], v[100:103], v[36:39]
    s_lshl_b32 s51, s49, 11
    ds_read_b64_tr_b16 a[18:19], v12 offset:51200
    ds_read_b64_tr_b16 a[20:21], v13 offset:49152
    v_mfma_f32_16x16x32_bf16 v[40:43], v[228:231], v[96:99], v[40:43]
    buffer_load_dwordx4 v[136:139], v16, s[72:75], s51 offen offset:0 sc1
    v_mfma_f32_16x16x32_bf16 v[44:47], v[228:231], v[100:103], v[44:47]
    ds_read_b64_tr_b16 a[22:23], v13 offset:51200
    v_mfma_f32_16x16x32_bf16 v[48:51], v[232:235], v[96:99], v[48:51]
    ds_read_b64_tr_b16 a[24:25], v14 offset:49152
    ds_read_b64_tr_b16 a[26:27], v14 offset:51200
    v_mfma_f32_16x16x32_bf16 v[52:55], v[232:235], v[100:103], v[52:55]
    buffer_load_dwordx4 v[140:143], v16, s[72:75], s51 offen offset:1024 sc1
    v_mfma_f32_16x16x32_bf16 v[56:59], v[236:239], v[96:99], v[56:59]
    ds_read_b64_tr_b16 a[28:29], v15 offset:49152
    v_mfma_f32_16x16x32_bf16 v[60:63], v[236:239], v[100:103], v[60:63]
    ds_read_b64_tr_b16 a[30:31], v15 offset:51200
    s_waitcnt vmcnt(12) lgkmcnt(4)
    v_mfma_f32_16x16x32_bf16 v[32:35], a[16:19], v[104:107], v[32:35]
    s_add_u32 s49, s8, 18
    s_and_b32 s49, s49, 31
    v_mfma_f32_16x16x32_bf16 v[36:39], a[16:19], v[108:111], v[36:39]
    s_lshl_b32 s51, s49, 11
    v_mfma_f32_16x16x32_bf16 v[40:43], a[20:23], v[104:107], v[40:43]
    buffer_load_dwordx4 v[96:99], v16, s[72:75], s51 offen offset:0 sc1
    v_mfma_f32_16x16x32_bf16 v[44:47], a[20:23], v[108:111], v[44:47]
    s_waitcnt lgkmcnt(0)
    v_mfma_f32_16x16x32_bf16 v[48:51], a[24:27], v[104:107], v[48:51]
    v_mfma_f32_16x16x32_bf16 v[52:55], a[24:27], v[108:111], v[52:55]
    buffer_load_dwordx4 v[100:103], v16, s[72:75], s51 offen offset:1024 sc1
    v_mfma_f32_16x16x32_bf16 v[56:59], a[28:31], v[104:107], v[56:59]
    buffer_load_dwordx2 v[22:23], v6, s[4:7], s92 offen sc1
    v_mfma_f32_16x16x32_bf16 v[60:63], a[28:31], v[108:111], v[60:63]
    s_add_u32 s49, s8, 27
    s_and_b32 s49, s49, 31
    s_add_u32 m0, s56, 114688
    s_lshl_b32 s52, s49, 15
    buffer_load_dwordx4 v28, s[68:71], s52 offen offset:0 lds
    s_add_u32 s53, s52, 14336
    buffer_load_dwordx4 v29, s[68:71], s52 offen offset:1024 lds
    buffer_load_dwordx4 v28, s[68:71], s53 offen offset:2048 lds
    buffer_load_dwordx4 v29, s[68:71], s53 offen offset:3072 lds
    s_waitcnt vmcnt(17)
    v_mfma_f32_16x16x32_bf16 v[32:35], v[240:243], v[112:115], v[32:35]
    s_add_u32 s49, s8, 19
    s_and_b32 s49, s49, 31
    v_mfma_f32_16x16x32_bf16 v[36:39], v[240:243], v[116:119], v[36:39]
    s_lshl_b32 s51, s49, 11
    v_mfma_f32_16x16x32_bf16 v[40:43], v[244:247], v[112:115], v[40:43]
    buffer_load_dwordx4 v[104:107], v16, s[72:75], s51 offen offset:0 sc1
    v_mfma_f32_16x16x32_bf16 v[44:47], v[244:247], v[116:119], v[44:47]
    v_mfma_f32_16x16x32_bf16 v[48:51], v[248:251], v[112:115], v[48:51]
    v_mfma_f32_16x16x32_bf16 v[52:55], v[248:251], v[116:119], v[52:55]
    buffer_load_dwordx4 v[108:111], v16, s[72:75], s51 offen offset:1024 sc1
    v_mfma_f32_16x16x32_bf16 v[56:59], v[252:255], v[112:115], v[56:59]
    v_mfma_f32_16x16x32_bf16 v[60:63], v[252:255], v[116:119], v[60:63]
    s_waitcnt vmcnt(13)
    v_mfma_f32_16x16x32_bf16 v[32:35], a[240:243], v[120:123], v[32:35]
    s_add_u32 s49, s8, 20
    s_and_b32 s49, s49, 31
    v_mfma_f32_16x16x32_bf16 v[36:39], a[240:243], v[124:127], v[36:39]
    s_lshl_b32 s51, s49, 11
    v_mfma_f32_16x16x32_bf16 v[40:43], a[244:247], v[120:123], v[40:43]
    buffer_load_dwordx4 v[112:115], v16, s[72:75], s51 offen offset:0 sc1
    v_mfma_f32_16x16x32_bf16 v[44:47], a[244:247], v[124:127], v[44:47]
    v_mfma_f32_16x16x32_bf16 v[48:51], a[248:251], v[120:123], v[48:51]
    v_mfma_f32_16x16x32_bf16 v[52:55], a[248:251], v[124:127], v[52:55]
    buffer_load_dwordx4 v[116:119], v16, s[72:75], s51 offen offset:1024 sc1
    v_mfma_f32_16x16x32_bf16 v[56:59], a[252:255], v[120:123], v[56:59]
    v_mfma_f32_16x16x32_bf16 v[60:63], a[252:255], v[124:127], v[60:63]
    s_waitcnt vmcnt(13)
    v_mfma_f32_16x16x32_bf16 v[32:35], a[64:67], v[128:131], v[32:35]
    s_add_u32 s49, s8, 21
    s_and_b32 s49, s49, 31
    v_mfma_f32_16x16x32_bf16 v[36:39], a[64:67], v[132:135], v[36:39]
    s_lshl_b32 s51, s49, 11
    v_mfma_f32_16x16x32_bf16 v[40:43], a[68:71], v[128:131], v[40:43]
    buffer_load_dwordx4 v[120:123], v16, s[72:75], s51 offen offset:0 sc1
    v_mfma_f32_16x16x32_bf16 v[44:47], a[68:71], v[132:135], v[44:47]
    v_mfma_f32_16x16x32_bf16 v[48:51], a[72:75], v[128:131], v[48:51]
    v_mfma_f32_16x16x32_bf16 v[52:55], a[72:75], v[132:135], v[52:55]
    buffer_load_dwordx4 v[124:127], v16, s[72:75], s51 offen offset:1024 sc1
    v_mfma_f32_16x16x32_bf16 v[56:59], a[76:79], v[128:131], v[56:59]
    v_mfma_f32_16x16x32_bf16 v[60:63], a[76:79], v[132:135], v[60:63]
    s_waitcnt vmcnt(13)
    v_mfma_f32_16x16x32_bf16 v[32:35], a[80:83], v[136:139], v[32:35]
    s_add_u32 s49, s8, 22
    s_and_b32 s49, s49, 31
    ds_read_b64_tr_b16 v[144:145], v8 offset:0
    v_mfma_f32_16x16x32_bf16 v[36:39], a[80:83], v[140:143], v[36:39]
    s_lshl_b32 s51, s49, 11
    ds_read_b64_tr_b16 v[146:147], v8 offset:2048
    ds_read_b64_tr_b16 v[148:149], v9 offset:0
    v_mfma_f32_16x16x32_bf16 v[40:43], a[84:87], v[136:139], v[40:43]
    buffer_load_dwordx4 v[128:131], v16, s[72:75], s51 offen offset:0 sc1
    v_mfma_f32_16x16x32_bf16 v[44:47], a[84:87], v[140:143], v[44:47]
    ds_read_b64_tr_b16 v[150:151], v9 offset:2048
    v_mfma_f32_16x16x32_bf16 v[48:51], a[88:91], v[136:139], v[48:51]
    ds_read_b64_tr_b16 v[152:153], v10 offset:0
    ds_read_b64_tr_b16 v[154:155], v10 offset:2048
    v_mfma_f32_16x16x32_bf16 v[52:55], a[88:91], v[140:143], v[52:55]
    buffer_load_dwordx4 v[132:135], v16, s[72:75], s51 offen offset:1024 sc1
    v_mfma_f32_16x16x32_bf16 v[56:59], a[92:95], v[136:139], v[56:59]
    ds_read_b64_tr_b16 v[156:157], v11 offset:0
    v_mfma_f32_16x16x32_bf16 v[60:63], a[92:95], v[140:143], v[60:63]
    ds_read_b64_tr_b16 v[158:159], v11 offset:2048
    s_waitcnt vmcnt(13) lgkmcnt(4)
    v_mfma_f32_16x16x32_bf16 v[32:35], v[144:147], v[96:99], v[32:35]
    s_add_u32 s49, s8, 23
    s_and_b32 s49, s49, 31
    ds_read_b64_tr_b16 v[64:65], v8 offset:16384
    v_mfma_f32_16x16x32_bf16 v[36:39], v[144:147], v[100:103], v[36:39]
    s_lshl_b32 s51, s49, 11
    ds_read_b64_tr_b16 v[66:67], v8 offset:18432
    ds_read_b64_tr_b16 v[68:69], v9 offset:16384
    v_mfma_f32_16x16x32_bf16 v[40:43], v[148:151], v[96:99], v[40:43]
    buffer_load_dwordx4 v[136:139], v16, s[72:75], s51 offen offset:0 sc1
    v_mfma_f32_16x16x32_bf16 v[44:47], v[148:151], v[100:103], v[44:47]
    ds_read_b64_tr_b16 v[70:71], v9 offset:18432
    s_waitcnt lgkmcnt(4)
    v_mfma_f32_16x16x32_bf16 v[48:51], v[152:155], v[96:99], v[48:51]
    ds_read_b64_tr_b16 v[72:73], v10 offset:16384
    ds_read_b64_tr_b16 v[74:75], v10 offset:18432
    v_mfma_f32_16x16x32_bf16 v[52:55], v[152:155], v[100:103], v[52:55]
    buffer_load_dwordx4 v[140:143], v16, s[72:75], s51 offen offset:1024 sc1
    v_mfma_f32_16x16x32_bf16 v[56:59], v[156:159], v[96:99], v[56:59]
    ds_read_b64_tr_b16 v[76:77], v11 offset:16384
    v_mfma_f32_16x16x32_bf16 v[60:63], v[156:159], v[100:103], v[60:63]
    ds_read_b64_tr_b16 v[78:79], v11 offset:18432
    s_waitcnt vmcnt(8) lgkmcnt(4)
    v_mfma_f32_16x16x32_bf16 v[32:35], v[64:67], v[104:107], v[32:35]
    s_add_u32 s49, s8, 24
    s_and_b32 s49, s49, 31
    ds_read_b64_tr_b16 v[144:145], v12 offset:0
    v_mfma_f32_16x16x32_bf16 v[36:39], v[64:67], v[108:111], v[36:39]
    s_lshl_b32 s51, s49, 11
    ds_read_b64_tr_b16 v[146:147], v12 offset:2048
    ds_read_b64_tr_b16 v[148:149], v13 offset:0
    v_mfma_f32_16x16x32_bf16 v[40:43], v[68:71], v[104:107], v[40:43]
    buffer_load_dwordx4 v[96:99], v16, s[72:75], s51 offen offset:0 sc1
    v_mfma_f32_16x16x32_bf16 v[44:47], v[68:71], v[108:111], v[44:47]
    ds_read_b64_tr_b16 v[150:151], v13 offset:2048
    s_waitcnt lgkmcnt(4)
    v_mfma_f32_16x16x32_bf16 v[48:51], v[72:75], v[104:107], v[48:51]
    ds_read_b64_tr_b16 v[152:153], v14 offset:0
    ds_read_b64_tr_b16 v[154:155], v14 offset:2048
    v_mfma_f32_16x16x32_bf16 v[52:55], v[72:75], v[108:111], v[52:55]
    buffer_load_dwordx4 v[100:103], v16, s[72:75], s51 offen offset:1024 sc1
    v_mfma_f32_16x16x32_bf16 v[56:59], v[76:79], v[104:107], v[56:59]
    ds_read_b64_tr_b16 v[156:157], v15 offset:0
    v_mfma_f32_16x16x32_bf16 v[60:63], v[76:79], v[108:111], v[60:63]
    ds_read_b64_tr_b16 v[158:159], v15 offset:2048
    s_waitcnt vmcnt(8) lgkmcnt(4)
    v_mfma_f32_16x16x32_bf16 v[32:35], v[144:147], v[112:115], v[32:35]
    s_add_u32 s49, s8, 25
    s_and_b32 s49, s49, 31
    ds_read_b64_tr_b16 v[64:65], v12 offset:16384
    v_mfma_f32_16x16x32_bf16 v[36:39], v[144:147], v[116:119], v[36:39]
    s_lshl_b32 s51, s49, 11
    ds_read_b64_tr_b16 v[66:67], v12 offset:18432
    ds_read_b64_tr_b16 v[68:69], v13 offset:16384
    v_mfma_f32_16x16x32_bf16 v[40:43], v[148:151], v[112:115], v[40:43]
L_pad8:
    s_cbranch_execz L_ret2
    buffer_load_dwordx4 v[104:107], v16, s[72:75], s51 offen offset:0 sc1
    v_mfma_f32_16x16x32_bf16 v[44:47], v[148:151], v[116:119], v[44:47]
    ds_read_b64_tr_b16 v[70:71], v13 offset:18432
    s_waitcnt lgkmcnt(4)
    v_mfma_f32_16x16x32_bf16 v[48:51], v[152:155], v[112:115], v[48:51]
    ds_read_b64_tr_b16 v[72:73], v14 offset:16384
    ds_read_b64_tr_b16 v[74:75], v14 offset:18432
    v_mfma_f32_16x16x32_bf16 v[52:55], v[152:155], v[116:119], v[52:55]
    buffer_load_dwordx4 v[108:111], v16, s[72:75], s51 offen offset:1024 sc1
    v_mfma_f32_16x16x32_bf16 v[56:59], v[156:159], v[112:115], v[56:59]
    ds_read_b64_tr_b16 v[76:77], v15 offset:16384
    v_mfma_f32_16x16x32_bf16 v[60:63], v[156:159], v[116:119], v[60:63]
    ds_read_b64_tr_b16 v[78:79], v15 offset:18432
    s_waitcnt vmcnt(8) lgkmcnt(4)
    v_mfma_f32_16x16x32_bf16 v[32:35], v[64:67], v[120:123], v[32:35]
    s_add_u32 s49, s8, 26
    s_and_b32 s49, s49, 31
    ds_read_b64_tr_b16 v[144:145], v24 offset:0
    v_mfma_f32_16x16x32_bf16 v[36:39], v[64:67], v[124:127], v[36:39]
    s_lshl_b32 s51, s49, 11
    ds_read_b64_tr_b16 v[146:147], v24 offset:2048
    ds_read_b64_tr_b16 v[148:149], v25 offset:0
    v_mfma_f32_16x16x32_bf16 v[40:43], v[68:71], v[120:123], v[40:43]
    buffer_load_dwordx4 v[112:115], v16, s[72:75], s51 offen offset:0 sc1
    v_mfma_f32_16x16x32_bf16 v[44:47], v[68:71], v[124:127], v[44:47]
    ds_read_b64_tr_b16 v[150:151], v25 offset:2048
    s_waitcnt lgkmcnt(4)
    v_mfma_f32_16x16x32_bf16 v[48:51], v[72:75], v[120:123], v[48:51]
    ds_read_b64_tr_b16 v[152:153], v26 offset:0
    ds_read_b64_tr_b16 v[154:155], v26 offset:2048
    v_mfma_f32_16x16x32_bf16 v[52:55], v[72:75], v[124:127], v[52:55]
    buffer_load_dwordx4 v[116:119], v16, s[72:75], s51 offen offset:1024 sc1
    v_mfma_f32_16x16x32_bf16 v[56:59], v[76:79], v[120:123], v[56:59]
    ds_read_b64_tr_b16 v[156:157], v27 offset:0
    v_mfma_f32_16x16x32_bf16 v[60:63], v[76:79], v[124:127], v[60:63]
    ds_read_b64_tr_b16 v[158:159], v27 offset:2048
    s_waitcnt vmcnt(8) lgkmcnt(4)
    v_mfma_f32_16x16x32_bf16 v[32:35], v[144:147], v[128:131], v[32:35]
    s_add_u32 s49, s8, 27
    s_and_b32 s49, s49, 31
    ds_read_b64_tr_b16 v[64:65], v24 offset:16384
    v_mfma_f32_16x16x32_bf16 v[36:39], v[144:147], v[132:135], v[36:39]
    s_lshl_b32 s51, s49, 11
    ds_read_b64_tr_b16 v[66:67], v24 offset:18432
    ds_read_b64_tr_b16 v[68:69], v25 offset:16384
    v_mfma_f32_16x16x32_bf16 v[40:43], v[148:151], v[128:131], v[40:43]
    buffer_load_dwordx4 v[120:123], v16, s[72:75], s51 offen offset:0 sc1
    v_mfma_f32_16x16x32_bf16 v[44:47], v[148:151], v[132:135], v[44:47]
    ds_read_b64_tr_b16 v[70:71], v25 offset:18432
    s_waitcnt lgkmcnt(4)
    v_mfma_f32_16x16x32_bf16 v[48:51], v[152:155], v[128:131], v[48:51]
    ds_read_b64_tr_b16 v[72:73], v26 offset:16384
    ds_read_b64_tr_b16 v[74:75], v26 offset:18432
    v_mfma_f32_16x16x32_bf16 v[52:55], v[152:155], v[132:135], v[52:55]
    buffer_load_dwordx4 v[124:127], v16, s[72:75], s51 offen offset:1024 sc1
    v_mfma_f32_16x16x32_bf16 v[56:59], v[156:159], v[128:131], v[56:59]
    ds_read_b64_tr_b16 v[76:77], v27 offset:16384
    v_mfma_f32_16x16x32_bf16 v[60:63], v[156:159], v[132:135], v[60:63]
    ds_read_b64_tr_b16 v[78:79], v27 offset:18432
    s_mov_b32 s48, 0x40000
    s_branch L_chk0
L_poll0:
    s_sleep 2
    buffer_load_dwordx2 v[22:23], v6, s[4:7], s92 offen sc1
    s_waitcnt vmcnt(0)
L_chk0:
    v_cmp_ne_u64 vcc, s[90:91], v[22:23]
    s_sub_u32 s48, s48, 1
    s_cbranch_scc1 L_go0
    s_nop 2
    s_cbranch_vccnz L_poll0
L_go0:
    s_waitcnt vmcnt(8) lgkmcnt(4)
    v_mfma_f32_16x16x32_bf16 v[32:35], v[64:67], v[136:139], v[32:35]
    s_add_u32 s49, s8, 14
    s_and_b32 s49, s49, 31
    ds_read_b64_tr_b16 v[144:145], v8 offset:32768
    v_mfma_f32_16x16x32_bf16 v[36:39], v[64:67], v[140:143], v[36:39]
    s_lshl_b32 s51, s49, 11
    ds_read_b64_tr_b16 v[146:147], v8 offset:34816
    ds_read_b64_tr_b16 v[148:149], v9 offset:32768
    v_mfma_f32_16x16x32_bf16 v[40:43], v[68:71], v[136:139], v[40:43]
    buffer_load_dwordx4 v[128:131], v7, s[72:75], s51 offen offset:0 sc1
    v_mfma_f32_16x16x32_bf16 v[44:47], v[68:71], v[140:143], v[44:47]
    ds_read_b64_tr_b16 v[150:151], v9 offset:34816
    s_waitcnt lgkmcnt(4)
    v_mfma_f32_16x16x32_bf16 v[48:51], v[72:75], v[136:139], v[48:51]
    ds_read_b64_tr_b16 v[152:153], v10 offset:32768
    ds_read_b64_tr_b16 v[154:155], v10 offset:34816
    v_mfma_f32_16x16x32_bf16 v[52:55], v[72:75], v[140:143], v[52:55]
    buffer_load_dwordx4 v[132:135], v7, s[72:75], s51 offen offset:1024 sc1
    v_mfma_f32_16x16x32_bf16 v[56:59], v[76:79], v[136:139], v[56:59]
    ds_read_b64_tr_b16 v[156:157], v11 offset:32768
    v_mfma_f32_16x16x32_bf16 v[60:63], v[76:79], v[140:143], v[60:63]
    ds_read_b64_tr_b16 v[158:159], v11 offset:34816
    s_waitcnt vmcnt(8) lgkmcnt(4)
    v_mfma_f32_16x16x32_bf16 v[32:35], v[144:147], v[96:99], v[32:35]
    s_add_u32 s49, s8, 18
    s_and_b32 s49, s49, 31
    ds_read_b64_tr_b16 v[64:65], v8 offset:49152
    v_mfma_f32_16x16x32_bf16 v[36:39], v[144:147], v[100:103], v[36:39]
    s_lshl_b32 s51, s49, 11
    ds_read_b64_tr_b16 v[66:67], v8 offset:51200
    ds_read_b64_tr_b16 v[68:69], v9 offset:49152
    v_mfma_f32_16x16x32_bf16 v[40:43], v[148:151], v[96:99], v[40:43]
    buffer_load_dwordx4 v[136:139], v7, s[72:75], s51 offen offset:0 sc1
    v_mfma_f32_16x16x32_bf16 v[44:47], v[148:151], v[100:103], v[44:47]
    ds_read_b64_tr_b16 v[70:71], v9 offset:51200
    s_waitcnt lgkmcnt(4)
    v_mfma_f32_16x16x32_bf16 v[48:51], v[152:155], v[96:99], v[48:51]
    ds_read_b64_tr_b16 v[72:73], v10 offset:49152
    ds_read_b64_tr_b16 v[74:75], v10 offset:51200
    v_mfma_f32_16x16x32_bf16 v[52:55], v[152:155], v[100:103], v[52:55]
    buffer_load_dwordx4 v[140:143], v7, s[72:75], s51 offen offset:1024 sc1
    v_mfma_f32_16x16x32_bf16 v[56:59], v[156:159], v[96:99], v[56:59]
    ds_read_b64_tr_b16 v[76:77], v11 offset:49152
    v_mfma_f32_16x16x32_bf16 v[60:63], v[156:159], v[100:103], v[60:63]
    ds_read_b64_tr_b16 v[78:79], v11 offset:51200
    s_waitcnt vmcnt(8) lgkmcnt(4)
    v_mfma_f32_16x16x32_bf16 v[32:35], v[64:67], v[104:107], v[32:35]
    s_add_u32 s49, s8, 19
    s_and_b32 s49, s49, 31
    ds_read_b64_tr_b16 v[144:145], v12 offset:32768
    v_mfma_f32_16x16x32_bf16 v[36:39], v[64:67], v[108:111], v[36:39]
    s_lshl_b32 s51, s49, 11
    ds_read_b64_tr_b16 v[146:147], v12 offset:34816
    ds_read_b64_tr_b16 v[148:149], v13 offset:32768
    v_mfma_f32_16x16x32_bf16 v[40:43], v[68:71], v[104:107], v[40:43]
    buffer_load_dwordx4 v[96:99], v7, s[72:75], s51 offen offset:0 sc1
    v_mfma_f32_16x16x32_bf16 v[44:47], v[68:71], v[108:111], v[44:47]
    ds_read_b64_tr_b16 v[150:151], v13 offset:34816
    s_waitcnt lgkmcnt(4)
    v_mfma_f32_16x16x32_bf16 v[48:51], v[72:75], v[104:107], v[48:51]
    ds_read_b64_tr_b16 v[152:153], v14 offset:32768
    ds_read_b64_tr_b16 v[154:155], v14 offset:34816
    v_mfma_f32_16x16x32_bf16 v[52:55], v[72:75], v[108:111], v[52:55]
    buffer_load_dwordx4 v[100:103], v7, s[72:75], s51 offen offset:1024 sc1
    v_mfma_f32_16x16x32_bf16 v[56:59], v[76:79], v[104:107], v[56:59]
    ds_read_b64_tr_b16 v[156:157], v15 offset:32768
    v_mfma_f32_16x16x32_bf16 v[60:63], v[76:79], v[108:111], v[60:63]
    ds_read_b64_tr_b16 v[158:159], v15 offset:34816
    s_waitcnt vmcnt(8) lgkmcnt(4)
    v_mfma_f32_16x16x32_bf16 v[32:35], v[144:147], v[112:115], v[32:35]
    s_add_u32 s49, s8, 20
    s_and_b32 s49, s49, 31
    ds_read_b64_tr_b16 v[64:65], v12 offset:49152
    v_mfma_f32_16x16x32_bf16 v[36:39], v[144:147], v[116:119], v[36:39]
    s_lshl_b32 s51, s49, 11
    ds_read_b64_tr_b16 v[66:67], v12 offset:51200
    ds_read_b64_tr_b16 v[68:69], v13 offset:49152
    v_mfma_f32_16x16x32_bf16 v[40:43], v[148:151], v[112:115], v[40:43]
    buffer_load_dwordx4 v[104:107], v7, s[72:75], s51 offen offset:0 sc1
    v_mfma_f32_16x16x32_bf16 v[44:47], v[148:151], v[116:119], v[44:47]
    ds_read_b64_tr_b16 v[70:71], v13 offset:51200
    s_waitcnt lgkmcnt(4)
    v_mfma_f32_16x16x32_bf16 v[48:51], v[152:155], v[112:115], v[48:51]
    ds_read_b64_tr_b16 v[72:73], v14 offset:49152
    ds_read_b64_tr_b16 v[74:75], v14 offset:51200
    v_mfma_f32_16x16x32_bf16 v[52:55], v[152:155], v[116:119], v[52:55]
    buffer_load_dwordx4 v[108:111], v7, s[72:75], s51 offen offset:1024 sc1
    v_mfma_f32_16x16x32_bf16 v[56:59], v[156:159], v[112:115], v[56:59]
    ds_read_b64_tr_b16 v[76:77], v15 offset:49152
    v_mfma_f32_16x16x32_bf16 v[60:63], v[156:159], v[116:119], v[60:63]
    ds_read_b64_tr_b16 v[78:79], v15 offset:51200
    s_waitcnt vmcnt(8) lgkmcnt(4)
    v_mfma_f32_16x16x32_bf16 v[32:35], v[64:67], v[120:123], v[32:35]
    s_add_u32 s49, s8, 21
    s_and_b32 s49, s49, 31
    v_mfma_f32_16x16x32_bf16 v[36:39], v[64:67], v[124:127], v[36:39]
    s_lshl_b32 s51, s49, 11
    v_mfma_f32_16x16x32_bf16 v[40:43], v[68:71], v[120:123], v[40:43]
    buffer_load_dwordx4 v[112:115], v7, s[72:75], s51 offen offset:0 sc1
    v_mfma_f32_16x16x32_bf16 v[44:47], v[68:71], v[124:127], v[44:47]
    s_waitcnt lgkmcnt(0)
    v_mfma_f32_16x16x32_bf16 v[48:51], v[72:75], v[120:123], v[48:51]
    v_mfma_f32_16x16x32_bf16 v[52:55], v[72:75], v[124:127], v[52:55]
    buffer_load_dwordx4 v[116:119], v7, s[72:75], s51 offen offset:1024 sc1
    v_mfma_f32_16x16x32_bf16 v[56:59], v[76:79], v[120:123], v[56:59]
    v_mfma_f32_16x16x32_bf16 v[60:63], v[76:79], v[124:127], v[60:63]
    s_waitcnt vmcnt(8)
    v_mfma_f32_16x16x32_bf16 v[64:67], a[96:99], v[128:131], 0
    s_add_u32 s49, s8, 22
    s_and_b32 s49, s49, 31
    ds_read_b64_tr_b16 v[144:145], v8 offset:0
    v_mfma_f32_16x16x32_bf16 v[68:71], a[96:99], v[132:135], 0
    s_lshl_b32 s51, s49, 11
    ds_read_b64_tr_b16 v[146:147], v8 offset:2048
    ds_read_b64_tr_b16 v[148:149], v9 offset:0
    v_mfma_f32_16x16x32_bf16 v[72:75], a[100:103], v[128:131], 0
    buffer_load_dwordx4 v[120:123], v7, s[72:75], s51 offen offset:0 sc1
    v_mfma_f32_16x16x32_bf16 v[76:79], a[100:103], v[132:135], 0
    ds_read_b64_tr_b16 v[150:151], v9 offset:2048
    v_mfma_f32_16x16x32_bf16 v[80:83], a[104:107], v[128:131], 0
    ds_read_b64_tr_b16 v[152:153], v10 offset:0
    ds_read_b64_tr_b16 v[154:155], v10 offset:2048
    v_mfma_f32_16x16x32_bf16 v[84:87], a[104:107], v[132:135], 0
    buffer_load_dwordx4 v[124:127], v7, s[72:75], s51 offen offset:1024 sc1
    v_mfma_f32_16x16x32_bf16 v[88:91], a[108:111], v[128:131], 0
    ds_read_b64_tr_b16 v[156:157], v11 offset:0
    v_mfma_f32_16x16x32_bf16 v[92:95], a[108:111], v[132:135], 0
    ds_read_b64_tr_b16 v[158:159], v11 offset:2048
    s_waitcnt vmcnt(8) lgkmcnt(4)
    v_mfma_f32_16x16x32_bf16 v[64:67], v[144:147], v[136:139], v[64:67]
    s_add_u32 s49, s8, 23
    s_and_b32 s49, s49, 31
    ds_read_b64_tr_b16 a[96:97], v8 offset:16384
    v_mfma_f32_16x16x32_bf16 v[68:71], v[144:147], v[140:143], v[68:71]
    s_lshl_b32 s51, s49, 11
    ds_read_b64_tr_b16 a[98:99], v8 offset:18432
    ds_read_b64_tr_b16 a[100:101], v9 offset:16384
    v_mfma_f32_16x16x32_bf16 v[72:75], v[148:151], v[136:139], v[72:75]
    buffer_load_dwordx4 v[128:131], v7, s[72:75], s51 offen offset:0 sc1
    v_mfma_f32_16x16x32_bf16 v[76:79], v[148:151], v[140:143], v[76:79]
    ds_read_b64_tr_b16 a[102:103], v9 offset:18432
    s_waitcnt lgkmcnt(4)
    v_mfma_f32_16x16x32_bf16 v[80:83], v[152:155], v[136:139], v[80:83]
    ds_read_b64_tr_b16 a[104:105], v10 offset:16384
    ds_read_b64_tr_b16 a[106:107], v10 offset:18432
    v_mfma_f32_16x16x32_bf16 v[84:87], v[152:155], v[140:143], v[84:87]
    buffer_load_dwordx4 v[132:135], v7, s[72:75], s51 offen offset:1024 sc1
    v_mfma_f32_16x16x32_bf16 v[88:91], v[156:159], v[136:139], v[88:91]
    ds_read_b64_tr_b16 a[108:109], v11 offset:16384
    v_mfma_f32_16x16x32_bf16 v[92:95], v[156:159], v[140:143], v[92:95]
    ds_read_b64_tr_b16 a[110:111], v11 offset:18432
    s_add_u32 s49, s8, 28
    s_and_b32 s49, s49, 31
    s_add_u32 m0, s56, 0
    s_lshl_b32 s52, s49, 15
    buffer_load_dwordx4 v28, s[68:71], s52 offen offset:0 lds
    s_add_u32 s53, s52, 14336
    buffer_load_dwordx4 v29, s[68:71], s52 offen offset:1024 lds
    buffer_load_dwordx4 v28, s[68:71], s53 offen offset:2048 lds
    buffer_load_dwordx4 v29, s[68:71], s53 offen offset:3072 lds
    s_waitcnt vmcnt(12) lgkmcnt(4)
    v_mfma_f32_16x16x32_bf16 v[64:67], a[96:99], v[96:99], v[64:67]
    s_add_u32 s49, s8, 24
    s_and_b32 s49, s49, 31
    ds_read_b64_tr_b16 v[144:145], v12 offset:0
    v_mfma_f32_16x16x32_bf16 v[68:71], a[96:99], v[100:103], v[68:71]
    s_lshl_b32 s51, s49, 11
    ds_read_b64_tr_b16 v[146:147], v12 offset:2048
    ds_read_b64_tr_b16 v[148:149], v13 offset:0
    v_mfma_f32_16x16x32_bf16 v[72:75], a[100:103], v[96:99], v[72:75]
    buffer_load_dwordx4 v[136:139], v7, s[72:75], s51 offen offset:0 sc1
    v_mfma_f32_16x16x32_bf16 v[76:79], a[100:103], v[100:103], v[76:79]
    ds_read_b64_tr_b16 v[150:151], v13 offset:2048
    s_waitcnt lgkmcnt(4)
    v_mfma_f32_16x16x32_bf16 v[80:83], a[104:107], v[96:99], v[80:83]
    ds_read_b64_tr_b16 v[152:153], v14 offset:0
    ds_read_b64_tr_b16 v[154:155], v14 offset:2048
    v_mfma_f32_16x16x32_bf16 v[84:87], a[104:107], v[100:103], v[84:87]
    buffer_load_dwordx4 v[140:143], v7, s[72:75], s51 offen offset:1024 sc1
    v_mfma_f32_16x16x32_bf16 v[88:91], a[108:111], v[96:99], v[88:91]
    ds_read_b64_tr_b16 v[156:157], v15 offset:0
    v_mfma_f32_16x16x32_bf16 v[92:95], a[108:111], v[100:103], v[92:95]
    ds_read_b64_tr_b16 v[158:159], v15 offset:2048
    s_add_u32 s49, s8, 29
    s_and_b32 s49, s49, 31
    s_add_u32 m0, s56, 16384
    s_lshl_b32 s52, s49, 15
    buffer_load_dwordx4 v28, s[68:71], s52 offen offset:0 lds
    s_add_u32 s53, s52, 14336
    buffer_load_dwordx4 v29, s[68:71], s52 offen offset:1024 lds
    buffer_load_dwordx4 v28, s[68:71], s53 offen offset:2048 lds
    buffer_load_dwordx4 v29, s[68:71], s53 offen offset:3072 lds
    s_waitcnt vmcnt(16) lgkmcnt(4)
    v_mfma_f32_16x16x32_bf16 v[64:67], v[144:147], v[104:107], v[64:67]
    s_add_u32 s49, s8, 25
    s_and_b32 s49, s49, 31
    ds_read_b64_tr_b16 a[96:97], v12 offset:16384
    v_mfma_f32_16x16x32_bf16 v[68:71], v[144:147], v[108:111], v[68:71]
    s_lshl_b32 s51, s49, 11
    ds_read_b64_tr_b16 a[98:99], v12 offset:18432
    ds_read_b64_tr_b16 a[100:101], v13 offset:16384
    v_mfma_f32_16x16x32_bf16 v[72:75], v[148:151], v[104:107], v[72:75]
    buffer_load_dwordx4 v[96:99], v7, s[72:75], s51 offen offset:0 sc1
    v_mfma_f32_16x16x32_bf16 v[76:79], v[148:151], v[108:111], v[76:79]
    ds_read_b64_tr_b16 a[102:103], v13 offset:18432
    s_waitcnt lgkmcnt(4)
    v_mfma_f32_16x16x32_bf16 v[80:83], v[152:155], v[104:107], v[80:83]
    ds_read_b64_tr_b16 a[104:105], v14 offset:16384
    ds_read_b64_tr_b16 a[106:107], v14 offset:18432
    v_mfma_f32_16x16x32_bf16 v[84:87], v[152:155], v[108:111], v[84:87]
    buffer_load_dwordx4 v[100:103], v7, s[72:75], s51 offen offset:1024 sc1
    v_mfma_f32_16x16x32_bf16 v[88:91], v[156:159], v[104:107], v[88:91]
    ds_read_b64_tr_b16 a[108:109], v15 offset:16384
    v_mfma_f32_16x16x32_bf16 v[92:95], v[156:159], v[108:111], v[92:95]
    ds_read_b64_tr_b16 a[110:111], v15 offset:18432
    s_add_u32 s49, s8, 30
    s_and_b32 s49, s49, 31
    s_add_u32 m0, s56, 65536
    s_lshl_b32 s52, s49, 15
    buffer_load_dwordx4 v28, s[68:71], s52 offen offset:0 lds
    s_add_u32 s53, s52, 14336
    buffer_load_dwordx4 v29, s[68:71], s52 offen offset:1024 lds
    buffer_load_dwordx4 v28, s[68:71], s53 offen offset:2048 lds
    buffer_load_dwordx4 v29, s[68:71], s53 offen offset:3072 lds
    s_waitcnt vmcnt(20) lgkmcnt(4)
    v_mfma_f32_16x16x32_bf16 v[64:67], a[96:99], v[112:115], v[64:67]
    s_add_u32 s49, s8, 26
    s_and_b32 s49, s49, 31
    ds_read_b64_tr_b16 v[144:145], v24 offset:0
    v_mfma_f32_16x16x32_bf16 v[68:71], a[96:99], v[116:119], v[68:71]
    s_lshl_b32 s51, s49, 11
    ds_read_b64_tr_b16 v[146:147], v24 offset:2048
    ds_read_b64_tr_b16 v[148:149], v25 offset:0
    v_mfma_f32_16x16x32_bf16 v[72:75], a[100:103], v[112:115], v[72:75]
    buffer_load_dwordx4 v[104:107], v7, s[72:75], s51 offen offset:0 sc1
    v_mfma_f32_16x16x32_bf16 v[76:79], a[100:103], v[116:119], v[76:79]
    ds_read_b64_tr_b16 v[150:151], v25 offset:2048
    s_waitcnt lgkmcnt(4)
    v_mfma_f32_16x16x32_bf16 v[80:83], a[104:107], v[112:115], v[80:83]
    ds_read_b64_tr_b16 v[152:153], v26 offset:0
    ds_read_b64_tr_b16 v[154:155], v26 offset:2048
    v_mfma_f32_16x16x32_bf16 v[84:87], a[104:107], v[116:119], v[84:87]
    buffer_load_dwordx4 v[108:111], v7, s[72:75], s51 offen offset:1024 sc1
    v_mfma_f32_16x16x32_bf16 v[88:91], a[108:111], v[112:115], v[88:91]
    ds_read_b64_tr_b16 v[156:157], v27 offset:0
    v_mfma_f32_16x16x32_bf16 v[92:95], a[108:111], v[116:119], v[92:95]
    ds_read_b64_tr_b16 v[158:159], v27 offset:2048
    s_add_u32 s49, s8, 31
    s_and_b32 s49, s49, 31
    s_add_u32 m0, s56, 81920
    s_lshl_b32 s52, s49, 15
    buffer_load_dwordx4 v28, s[68:71], s52 offen offset:0 lds
    s_add_u32 s53, s52, 14336
    buffer_load_dwordx4 v29, s[68:71], s52 offen offset:1024 lds
    buffer_load_dwordx4 v28, s[68:71], s53 offen offset:2048 lds
    buffer_load_dwordx4 v29, s[68:71], s53 offen offset:3072 lds
    s_waitcnt vmcnt(24) lgkmcnt(4)
    v_mfma_f32_16x16x32_bf16 v[64:67], v[144:147], v[120:123], v[64:67]
    s_add_u32 s49, s8, 27
    s_and_b32 s49, s49, 31
    ds_read_b64_tr_b16 a[96:97], v24 offset:16384
    v_mfma_f32_16x16x32_bf16 v[68:71], v[144:147], v[124:127], v[68:71]
    s_lshl_b32 s51, s49, 11
    ds_read_b64_tr_b16 a[98:99], v24 offset:18432
    ds_read_b64_tr_b16 a[100:101], v25 offset:16384
    v_mfma_f32_16x16x32_bf16 v[72:75], v[148:151], v[120:123], v[72:75]
    buffer_load_dwordx4 v[112:115], v7, s[72:75], s51 offen offset:0 sc1
    v_mfma_f32_16x16x32_bf16 v[76:79], v[148:151], v[124:127], v[76:79]
    ds_read_b64_tr_b16 a[102:103], v25 offset:18432
    s_waitcnt lgkmcnt(4)
    v_mfma_f32_16x16x32_bf16 v[80:83], v[152:155], v[120:123], v[80:83]
    ds_read_b64_tr_b16 a[104:105], v26 offset:16384
    ds_read_b64_tr_b16 a[106:107], v26 offset:18432
    v_mfma_f32_16x16x32_bf16 v[84:87], v[152:155], v[124:127], v[84:87]
    buffer_load_dwordx4 v[116:119], v7, s[72:75], s51 offen offset:1024 sc1
    v_mfma_f32_16x16x32_bf16 v[88:91], v[156:159], v[120:123], v[88:91]
    ds_read_b64_tr_b16 a[108:109], v27 offset:16384
    v_mfma_f32_16x16x32_bf16 v[92:95], v[156:159], v[124:127], v[92:95]
    ds_read_b64_tr_b16 a[110:111], v27 offset:18432
    s_waitcnt vmcnt(24) lgkmcnt(4)
    v_mfma_f32_16x16x32_bf16 v[64:67], a[96:99], v[128:131], v[64:67]
    s_add_u32 s49, s8, 0
    s_and_b32 s49, s49, 31
    ds_read_b64_tr_b16 v[144:145], v8 offset:32768
    v_mfma_f32_16x16x32_bf16 v[68:71], a[96:99], v[132:135], v[68:71]
    s_lshl_b32 s51, s49, 11
    ds_read_b64_tr_b16 v[146:147], v8 offset:34816
    ds_read_b64_tr_b16 v[148:149], v9 offset:32768
    v_mfma_f32_16x16x32_bf16 v[72:75], a[100:103], v[128:131], v[72:75]
    buffer_load_dwordx4 v[120:123], v7, s[72:75], s51 offen offset:0 sc1
    v_mfma_f32_16x16x32_bf16 v[76:79], a[100:103], v[132:135], v[76:79]
    ds_read_b64_tr_b16 v[150:151], v9 offset:34816
    s_waitcnt lgkmcnt(4)
    v_mfma_f32_16x16x32_bf16 v[80:83], a[104:107], v[128:131], v[80:83]
    ds_read_b64_tr_b16 v[152:153], v10 offset:32768
    ds_read_b64_tr_b16 v[154:155], v10 offset:34816
    v_mfma_f32_16x16x32_bf16 v[84:87], a[104:107], v[132:135], v[84:87]
    buffer_load_dwordx4 v[124:127], v7, s[72:75], s51 offen offset:1024 sc1
    v_mfma_f32_16x16x32_bf16 v[88:91], a[108:111], v[128:131], v[88:91]
    ds_read_b64_tr_b16 v[156:157], v11 offset:32768
    v_mfma_f32_16x16x32_bf16 v[92:95], a[108:111], v[132:135], v[92:95]
    ds_read_b64_tr_b16 v[158:159], v11 offset:34816
    s_waitcnt vmcnt(20) lgkmcnt(4)
    v_mfma_f32_16x16x32_bf16 v[64:67], v[144:147], v[136:139], v[64:67]
    s_add_u32 s49, s8, 1
    s_and_b32 s49, s49, 31
    ds_read_b64_tr_b16 a[96:97], v8 offset:49152
    v_mfma_f32_16x16x32_bf16 v[68:71], v[144:147], v[140:143], v[68:71]
    s_lshl_b32 s51, s49, 11
    ds_read_b64_tr_b16 a[98:99], v8 offset:51200
    ds_read_b64_tr_b16 a[100:101], v9 offset:49152
    v_mfma_f32_16x16x32_bf16 v[72:75], v[148:151], v[136:139], v[72:75]
    buffer_load_dwordx4 v[128:131], v7, s[72:75], s51 offen offset:0 sc1
    v_mfma_f32_16x16x32_bf16 v[76:79], v[148:151], v[140:143], v[76:79]
    ds_read_b64_tr_b16 a[102:103], v9 offset:51200
    s_waitcnt lgkmcnt(4)
    v_mfma_f32_16x16x32_bf16 v[80:83], v[152:155], v[136:139], v[80:83]
    ds_read_b64_tr_b16 a[104:105], v10 offset:49152
    ds_read_b64_tr_b16 a[106:107], v10 offset:51200
    v_mfma_f32_16x16x32_bf16 v[84:87], v[152:155], v[140:143], v[84:87]
    buffer_load_dwordx4 v[132:135], v7, s[72:75], s51 offen offset:1024 sc1
    v_mfma_f32_16x16x32_bf16 v[88:91], v[156:159], v[136:139], v[88:91]
    ds_read_b64_tr_b16 a[108:109], v11 offset:49152
    v_mfma_f32_16x16x32_bf16 v[92:95], v[156:159], v[140:143], v[92:95]
    ds_read_b64_tr_b16 a[110:111], v11 offset:51200
    s_waitcnt vmcnt(16) lgkmcnt(4)
    v_mfma_f32_16x16x32_bf16 v[64:67], a[96:99], v[96:99], v[64:67]
    s_add_u32 s49, s8, 2
    s_and_b32 s49, s49, 31
    ds_read_b64_tr_b16 v[144:145], v12 offset:32768
    v_mfma_f32_16x16x32_bf16 v[68:71], a[96:99], v[100:103], v[68:71]
    s_lshl_b32 s51, s49, 11
    ds_read_b64_tr_b16 v[146:147], v12 offset:34816
    ds_read_b64_tr_b16 v[148:149], v13 offset:32768
    v_mfma_f32_16x16x32_bf16 v[72:75], a[100:103], v[96:99], v[72:75]
    buffer_load_dwordx4 v[136:139], v7, s[72:75], s51 offen offset:0 sc1
    v_mfma_f32_16x16x32_bf16 v[76:79], a[100:103], v[100:103], v[76:79]
    ds_read_b64_tr_b16 v[150:151], v13 offset:34816
    s_waitcnt lgkmcnt(4)
    v_mfma_f32_16x16x32_bf16 v[80:83], a[104:107], v[96:99], v[80:83]
    ds_read_b64_tr_b16 v[152:153], v14 offset:32768
    ds_read_b64_tr_b16 v[154:155], v14 offset:34816
    v_mfma_f32_16x16x32_bf16 v[84:87], a[104:107], v[100:103], v[84:87]
    buffer_load_dwordx4 v[140:143], v7, s[72:75], s51 offen offset:1024 sc1
    v_mfma_f32_16x16x32_bf16 v[88:91], a[108:111], v[96:99], v[88:91]
    ds_read_b64_tr_b16 v[156:157], v15 offset:32768
    v_mfma_f32_16x16x32_bf16 v[92:95], a[108:111], v[100:103], v[92:95]
    ds_read_b64_tr_b16 v[158:159], v15 offset:34816
    s_waitcnt vmcnt(12) lgkmcnt(4)
    v_mfma_f32_16x16x32_bf16 v[64:67], v[144:147], v[104:107], v[64:67]
    s_add_u32 s49, s8, 28
    s_and_b32 s49, s49, 31
    ds_read_b64_tr_b16 a[96:97], v12 offset:49152
    v_mfma_f32_16x16x32_bf16 v[68:71], v[144:147], v[108:111], v[68:71]
    s_lshl_b32 s51, s49, 11
    ds_read_b64_tr_b16 a[98:99], v12 offset:51200
    ds_read_b64_tr_b16 a[100:101], v13 offset:49152
    v_mfma_f32_16x16x32_bf16 v[72:75], v[148:151], v[104:107], v[72:75]
    buffer_load_dwordx4 v[96:99], v16, s[72:75], s51 offen offset:0 sc1
    v_mfma_f32_16x16x32_bf16 v[76:79], v[148:151], v[108:111], v[76:79]
    ds_read_b64_tr_b16 a[102:103], v13 offset:51200
    s_waitcnt lgkmcnt(4)
    v_mfma_f32_16x16x32_bf16 v[80:83], v[152:155], v[104:107], v[80:83]
    ds_read_b64_tr_b16 a[104:105], v14 offset:49152
    ds_read_b64_tr_b16 a[106:107], v14 offset:51200
    v_mfma_f32_16x16x32_bf16 v[84:87], v[152:155], v[108:111], v[84:87]
    buffer_load_dwordx4 v[100:103], v16, s[72:75], s51 offen offset:1024 sc1
    v_mfma_f32_16x16x32_bf16 v[88:91], v[156:159], v[104:107], v[88:91]
    ds_read_b64_tr_b16 a[108:109], v15 offset:49152
    v_mfma_f32_16x16x32_bf16 v[92:95], v[156:159], v[108:111], v[92:95]
    ds_read_b64_tr_b16 a[110:111], v15 offset:51200
    s_waitcnt vmcnt(8) lgkmcnt(4)
    v_mfma_f32_16x16x32_bf16 v[64:67], a[96:99], v[112:115], v[64:67]
    s_add_u32 s49, s8, 28
    s_and_b32 s49, s49, 31
    v_mfma_f32_16x16x32_bf16 v[68:71], a[96:99], v[116:119], v[68:71]
    s_lshl_b32 s51, s49, 11
    v_mfma_f32_16x16x32_bf16 v[72:75], a[100:103], v[112:115], v[72:75]
    buffer_load_dwordx4 v[104:107], v7, s[72:75], s51 offen offset:0 sc1
    v_mfma_f32_16x16x32_bf16 v[76:79], a[100:103], v[116:119], v[76:79]
    s_waitcnt lgkmcnt(0)
    v_mfma_f32_16x16x32_bf16 v[80:83], a[104:107], v[112:115], v[80:83]
    v_mfma_f32_16x16x32_bf16 v[84:87], a[104:107], v[116:119], v[84:87]
    buffer_load_dwordx4 v[108:111], v7, s[72:75], s51 offen offset:1024 sc1
    v_mfma_f32_16x16x32_bf16 v[88:91], a[108:111], v[112:115], v[88:91]
    v_mfma_f32_16x16x32_bf16 v[92:95], a[108:111], v[116:119], v[92:95]
    s_waitcnt vmcnt(8)
    v_mfma_f32_16x16x32_bf16 v[64:67], a[128:131], v[120:123], v[64:67]
    s_add_u32 s49, s8, 29
    s_and_b32 s49, s49, 31
    v_mfma_f32_16x16x32_bf16 v[68:71], a[128:131], v[124:127], v[68:71]
    s_lshl_b32 s51, s49, 11
    v_mfma_f32_16x16x32_bf16 v[72:75], a[132:135], v[120:123], v[72:75]
    buffer_load_dwordx4 v[112:115], v16, s[72:75], s51 offen offset:0 sc1
    v_mfma_f32_16x16x32_bf16 v[76:79], a[132:135], v[124:127], v[76:79]
    v_mfma_f32_16x16x32_bf16 v[80:83], a[136:139], v[120:123], v[80:83]
    v_mfma_f32_16x16x32_bf16 v[84:87], a[136:139], v[124:127], v[84:87]
    buffer_load_dwordx4 v[116:119], v16, s[72:75], s51 offen offset:1024 sc1
    v_mfma_f32_16x16x32_bf16 v[88:91], a[140:143], v[120:123], v[88:91]
    v_mfma_f32_16x16x32_bf16 v[92:95], a[140:143], v[124:127], v[92:95]
    s_waitcnt vmcnt(8)
    v_mfma_f32_16x16x32_bf16 v[64:67], a[144:147], v[128:131], v[64:67]
    s_add_u32 s49, s8, 29
    s_and_b32 s49, s49, 31
    v_mfma_f32_16x16x32_bf16 v[68:71], a[144:147], v[132:135], v[68:71]
    s_lshl_b32 s51, s49, 11
    v_mfma_f32_16x16x32_bf16 v[72:75], a[148:151], v[128:131], v[72:75]
    buffer_load_dwordx4 v[120:123], v7, s[72:75], s51 offen offset:0 sc1
    v_mfma_f32_16x16x32_bf16 v[76:79], a[148:151], v[132:135], v[76:79]
    v_mfma_f32_16x16x32_bf16 v[80:83], a[152:155], v[128:131], v[80:83]
    v_mfma_f32_16x16x32_bf16 v[84:87], a[152:155], v[132:135], v[84:87]
    buffer_load_dwordx4 v[124:127], v7, s[72:75], s51 offen offset:1024 sc1
    v_mfma_f32_16x16x32_bf16 v[88:91], a[156:159], v[128:131], v[88:91]
    v_mfma_f32_16x16x32_bf16 v[92:95], a[156:159], v[132:135], v[92:95]
    s_waitcnt vmcnt(8)
    v_mfma_f32_16x16x32_bf16 v[64:67], a[160:163], v[136:139], v[64:67]
    s_add_u32 s49, s8, 30
    s_and_b32 s49, s49, 31
    ds_read_b64_tr_b16 v[144:145], v8 offset:0
    v_mfma_f32_16x16x32_bf16 v[68:71], a[160:163], v[140:143], v[68:71]
    s_lshl_b32 s51, s49, 11
    ds_read_b64_tr_b16 v[146:147], v8 offset:2048
    ds_read_b64_tr_b16 v[148:149], v9 offset:0
    v_mfma_f32_16x16x32_bf16 v[72:75], a[164:167], v[136:139], v[72:75]
    buffer_load_dwordx4 v[128:131], v16, s[72:75], s51 offen offset:0 sc1
    v_mfma_f32_16x16x32_bf16 v[76:79], a[164:167], v[140:143], v[76:79]
    ds_read_b64_tr_b16 v[150:151], v9 offset:2048
    v_mfma_f32_16x16x32_bf16 v[80:83], a[168:171], v[136:139], v[80:83]
    ds_read_b64_tr_b16 v[152:153], v10 offset:0
    ds_read_b64_tr_b16 v[154:155], v10 offset:2048
    v_mfma_f32_16x16x32_bf16 v[84:87], a[168:171], v[140:143], v[84:87]
    buffer_load_dwordx4 v[132:135], v16, s[72:75], s51 offen offset:1024 sc1
    v_mfma_f32_16x16x32_bf16 v[88:91], a[172:175], v[136:139], v[88:91]
    ds_read_b64_tr_b16 v[156:157], v11 offset:0
    v_mfma_f32_16x16x32_bf16 v[92:95], a[172:175], v[140:143], v[92:95]
    ds_read_b64_tr_b16 v[158:159], v11 offset:2048
    s_waitcnt vmcnt(8) lgkmcnt(4)
    v_mfma_f32_16x16x32_bf16 v[32:35], v[144:147], v[96:99], v[32:35]
    s_add_u32 s49, s8, 30
    s_and_b32 s49, s49, 31
    v_mfma_f32_16x16x32_bf16 v[36:39], v[144:147], v[100:103], v[36:39]
    s_lshl_b32 s51, s49, 11
    v_mfma_f32_16x16x32_bf16 v[40:43], v[148:151], v[96:99], v[40:43]
    buffer_load_dwordx4 v[136:139], v7, s[72:75], s51 offen offset:0 sc1
    v_mfma_f32_16x16x32_bf16 v[44:47], v[148:151], v[100:103], v[44:47]
    s_waitcnt lgkmcnt(0)
    v_mfma_f32_16x16x32_bf16 v[48:51], v[152:155], v[96:99], v[48:51]
    v_mfma_f32_16x16x32_bf16 v[52:55], v[152:155], v[100:103], v[52:55]
    buffer_load_dwordx4 v[140:143], v7, s[72:75], s51 offen offset:1024 sc1
    v_mfma_f32_16x16x32_bf16 v[56:59], v[156:159], v[96:99], v[56:59]
    v_mfma_f32_16x16x32_bf16 v[60:63], v[156:159], v[100:103], v[60:63]
    s_waitcnt vmcnt(8)
    v_mfma_f32_16x16x32_bf16 v[64:67], v[144:147], v[104:107], v[64:67]
    s_add_u32 s49, s8, 31
    s_and_b32 s49, s49, 31
    ds_read_b64_tr_b16 a[96:97], v8 offset:16384
    v_mfma_f32_16x16x32_bf16 v[68:71], v[144:147], v[108:111], v[68:71]
    s_lshl_b32 s51, s49, 11
    ds_read_b64_tr_b16 a[98:99], v8 offset:18432
    ds_read_b64_tr_b16 a[100:101], v9 offset:16384
    v_mfma_f32_16x16x32_bf16 v[72:75], v[148:151], v[104:107], v[72:75]
    buffer_load_dwordx4 v[96:99], v16, s[72:75], s51 offen offset:0 sc1
    v_mfma_f32_16x16x32_bf16 v[76:79], v[148:151], v[108:111], v[76:79]
    ds_read_b64_tr_b16 a[102:103], v9 offset:18432
    v_mfma_f32_16x16x32_bf16 v[80:83], v[152:155], v[104:107], v[80:83]
    ds_read_b64_tr_b16 a[104:105], v10 offset:16384
    ds_read_b64_tr_b16 a[106:107], v10 offset:18432
    v_mfma_f32_16x16x32_bf16 v[84:87], v[152:155], v[108:111], v[84:87]
    buffer_load_dwordx4 v[100:103], v16, s[72:75], s51 offen offset:1024 sc1
    v_mfma_f32_16x16x32_bf16 v[88:91], v[156:159], v[104:107], v[88:91]
    ds_read_b64_tr_b16 a[108:109], v11 offset:16384
    v_mfma_f32_16x16x32_bf16 v[92:95], v[156:159], v[108:111], v[92:95]
    ds_read_b64_tr_b16 a[110:111], v11 offset:18432
    s_waitcnt vmcnt(8) lgkmcnt(4)
    v_mfma_f32_16x16x32_bf16 v[32:35], a[96:99], v[112:115], v[32:35]
    s_add_u32 s49, s8, 31
    s_and_b32 s49, s49, 31
    v_mfma_f32_16x16x32_bf16 v[36:39], a[96:99], v[116:119], v[36:39]
    s_lshl_b32 s51, s49, 11
    v_mfma_f32_16x16x32_bf16 v[40:43], a[100:103], v[112:115], v[40:43]
    buffer_load_dwordx4 v[104:107], v7, s[72:75], s51 offen offset:0 sc1
    v_mfma_f32_16x16x32_bf16 v[44:47], a[100:103], v[116:119], v[44:47]
    s_waitcnt lgkmcnt(0)
    v_mfma_f32_16x16x32_bf16 v[48:51], a[104:107], v[112:115], v[48:51]
    v_mfma_f32_16x16x32_bf16 v[52:55], a[104:107], v[116:119], v[52:55]
    buffer_load_dwordx4 v[108:111], v7, s[72:75], s51 offen offset:1024 sc1
    v_mfma_f32_16x16x32_bf16 v[56:59], a[108:111], v[112:115], v[56:59]
    v_mfma_f32_16x16x32_bf16 v[60:63], a[108:111], v[116:119], v[60:63]
    s_waitcnt vmcnt(8)
    v_mfma_f32_16x16x32_bf16 v[64:67], a[96:99], v[120:123], v[64:67]
    s_add_u32 s49, s8, 15
    s_and_b32 s49, s49, 31
    ds_read_b64_tr_b16 v[144:145], v12 offset:0
    v_mfma_f32_16x16x32_bf16 v[68:71], a[96:99], v[124:127], v[68:71]
    s_lshl_b32 s51, s49, 11
    ds_read_b64_tr_b16 v[146:147], v12 offset:2048
    ds_read_b64_tr_b16 v[148:149], v13 offset:0
    v_mfma_f32_16x16x32_bf16 v[72:75], a[100:103], v[120:123], v[72:75]
    buffer_load_dwordx4 v[112:115], v7, s[72:75], s51 offen offset:0 sc1
    v_mfma_f32_16x16x32_bf16 v[76:79], a[100:103], v[124:127], v[76:79]
    ds_read_b64_tr_b16 v[150:151], v13 offset:2048
    v_mfma_f32_16x16x32_bf16 v[80:83], a[104:107], v[120:123], v[80:83]
    ds_read_b64_tr_b16 v[152:153], v14 offset:0
    ds_read_b64_tr_b16 v[154:155], v14 offset:2048
    v_mfma_f32_16x16x32_bf16 v[84:87], a[104:107], v[124:127], v[84:87]
    buffer_load_dwordx4 v[116:119], v7, s[72:75], s51 offen offset:1024 sc1
    v_mfma_f32_16x16x32_bf16 v[88:91], a[108:111], v[120:123], v[88:91]
    ds_read_b64_tr_b16 v[156:157], v15 offset:0
    v_mfma_f32_16x16x32_bf16 v[92:95], a[108:111], v[124:127], v[92:95]
    ds_read_b64_tr_b16 v[158:159], v15 offset:2048
    s_waitcnt vmcnt(8) lgkmcnt(4)
    v_mfma_f32_16x16x32_bf16 v[32:35], v[144:147], v[128:131], v[32:35]
    s_add_u32 s49, s8, 3
    s_and_b32 s49, s49, 31
    v_mfma_f32_16x16x32_bf16 v[36:39], v[144:147], v[132:135], v[36:39]
    s_lshl_b32 s51, s49, 11
    v_mfma_f32_16x16x32_bf16 v[40:43], v[148:151], v[128:131], v[40:43]
L_pad9:
    s_cbranch_execz L_ret2
    buffer_load_dwordx4 v[120:123], v7, s[72:75], s51 offen offset:0 sc1
    v_mfma_f32_16x16x32_bf16 v[44:47], v[148:151], v[132:135], v[44:47]
    s_waitcnt lgkmcnt(0)
    v_mfma_f32_16x16x32_bf16 v[48:51], v[152:155], v[128:131], v[48:51]
    v_mfma_f32_16x16x32_bf16 v[52:55], v[152:155], v[132:135], v[52:55]
    buffer_load_dwordx4 v[124:127], v7, s[72:75], s51 offen offset:1024 sc1
    v_mfma_f32_16x16x32_bf16 v[56:59], v[156:159], v[128:131], v[56:59]
    v_mfma_f32_16x16x32_bf16 v[60:63], v[156:159], v[132:135], v[60:63]
    s_waitcnt vmcnt(8)
    v_mfma_f32_16x16x32_bf16 v[64:67], v[144:147], v[136:139], v[64:67]
    s_add_u32 s49, s8, 4
    s_and_b32 s49, s49, 31
    ds_read_b64_tr_b16 a[96:97], v12 offset:16384
    v_mfma_f32_16x16x32_bf16 v[68:71], v[144:147], v[140:143], v[68:71]
    s_lshl_b32 s51, s49, 11
    ds_read_b64_tr_b16 a[98:99], v12 offset:18432
    ds_read_b64_tr_b16 a[100:101], v13 offset:16384
    v_mfma_f32_16x16x32_bf16 v[72:75], v[148:151], v[136:139], v[72:75]
    buffer_load_dwordx4 v[128:131], v7, s[72:75], s51 offen offset:0 sc1
    v_mfma_f32_16x16x32_bf16 v[76:79], v[148:151], v[140:143], v[76:79]
    ds_read_b64_tr_b16 a[102:103], v13 offset:18432
    v_mfma_f32_16x16x32_bf16 v[80:83], v[152:155], v[136:139], v[80:83]
    ds_read_b64_tr_b16 a[104:105], v14 offset:16384
    ds_read_b64_tr_b16 a[106:107], v14 offset:18432
    v_mfma_f32_16x16x32_bf16 v[84:87], v[152:155], v[140:143], v[84:87]
    buffer_load_dwordx4 v[132:135], v7, s[72:75], s51 offen offset:1024 sc1
    v_mfma_f32_16x16x32_bf16 v[88:91], v[156:159], v[136:139], v[88:91]
    ds_read_b64_tr_b16 a[108:109], v15 offset:16384
    v_mfma_f32_16x16x32_bf16 v[92:95], v[156:159], v[140:143], v[92:95]
    ds_read_b64_tr_b16 a[110:111], v15 offset:18432
    s_waitcnt vmcnt(8) lgkmcnt(4)
    v_mfma_f32_16x16x32_bf16 v[32:35], a[96:99], v[96:99], v[32:35]
    s_add_u32 s49, s8, 5
    s_and_b32 s49, s49, 31
    v_mfma_f32_16x16x32_bf16 v[36:39], a[96:99], v[100:103], v[36:39]
    s_lshl_b32 s51, s49, 11
    v_mfma_f32_16x16x32_bf16 v[40:43], a[100:103], v[96:99], v[40:43]
    buffer_load_dwordx4 v[136:139], v7, s[72:75], s51 offen offset:0 sc1
    v_mfma_f32_16x16x32_bf16 v[44:47], a[100:103], v[100:103], v[44:47]
    s_waitcnt lgkmcnt(0)
    v_mfma_f32_16x16x32_bf16 v[48:51], a[104:107], v[96:99], v[48:51]
    v_mfma_f32_16x16x32_bf16 v[52:55], a[104:107], v[100:103], v[52:55]
    buffer_load_dwordx4 v[140:143], v7, s[72:75], s51 offen offset:1024 sc1
    v_mfma_f32_16x16x32_bf16 v[56:59], a[108:111], v[96:99], v[56:59]
    v_mfma_f32_16x16x32_bf16 v[60:63], a[108:111], v[100:103], v[60:63]
    s_waitcnt vmcnt(8)
    v_mfma_f32_16x16x32_bf16 v[64:67], a[96:99], v[104:107], v[64:67]
    s_add_u32 s49, s8, 6
    s_and_b32 s49, s49, 31
    v_mfma_f32_16x16x32_bf16 v[68:71], a[96:99], v[108:111], v[68:71]
    s_lshl_b32 s51, s49, 11
    v_mfma_f32_16x16x32_bf16 v[72:75], a[100:103], v[104:107], v[72:75]
    buffer_load_dwordx4 v[96:99], v7, s[72:75], s51 offen offset:0 sc1
    v_mfma_f32_16x16x32_bf16 v[76:79], a[100:103], v[108:111], v[76:79]
    v_mfma_f32_16x16x32_bf16 v[80:83], a[104:107], v[104:107], v[80:83]
    v_mfma_f32_16x16x32_bf16 v[84:87], a[104:107], v[108:111], v[84:87]
    buffer_load_dwordx4 v[100:103], v7, s[72:75], s51 offen offset:1024 sc1
    v_mfma_f32_16x16x32_bf16 v[88:91], a[108:111], v[104:107], v[88:91]
    v_mfma_f32_16x16x32_bf16 v[92:95], a[108:111], v[108:111], v[92:95]
    s_waitcnt vmcnt(8)
    v_mfma_f32_16x16x32_bf16 v[64:67], a[112:115], v[112:115], v[64:67]
    s_add_u32 s49, s8, 16
    s_and_b32 s49, s49, 31
    v_mfma_f32_16x16x32_bf16 v[68:71], a[112:115], v[116:119], v[68:71]
    s_lshl_b32 s51, s49, 11
    v_mfma_f32_16x16x32_bf16 v[72:75], a[116:119], v[112:115], v[72:75]
    buffer_load_dwordx4 v[104:107], v7, s[72:75], s51 offen offset:0 sc1
    v_mfma_f32_16x16x32_bf16 v[76:79], a[116:119], v[116:119], v[76:79]
    v_add_u32 v2, s56, v7
    v_add_u32 v2, 131072, v2
    v_add_u32 v3, 16384, v2
    v_mfma_f32_16x16x32_bf16 v[80:83], a[120:123], v[112:115], v[80:83]
    v_mfma_f32_16x16x32_bf16 v[84:87], a[120:123], v[116:119], v[84:87]
    buffer_load_dwordx4 v[108:111], v7, s[72:75], s51 offen offset:1024 sc1
    v_mfma_f32_16x16x32_bf16 v[88:91], a[124:127], v[112:115], v[88:91]
    v_mfma_f32_16x16x32_bf16 v[92:95], a[124:127], v[116:119], v[92:95]
    s_waitcnt vmcnt(8)
    v_mfma_f32_16x16x32_bf16 v[64:67], a[176:179], v[120:123], v[64:67]
    s_add_u32 s49, s8, 7
    s_and_b32 s49, s49, 31
    v_mfma_f32_16x16x32_bf16 v[68:71], a[176:179], v[124:127], v[68:71]
    s_lshl_b32 s51, s49, 11
    v_mfma_f32_16x16x32_bf16 v[72:75], a[180:183], v[120:123], v[72:75]
    buffer_load_dwordx4 v[112:115], v7, s[72:75], s51 offen offset:0 sc1
    v_mfma_f32_16x16x32_bf16 v[76:79], a[180:183], v[124:127], v[76:79]
    ds_write_b128 v2, v[40:43] offset:0
    v_mfma_f32_16x16x32_bf16 v[80:83], a[184:187], v[120:123], v[80:83]
    v_mfma_f32_16x16x32_bf16 v[84:87], a[184:187], v[124:127], v[84:87]
    buffer_load_dwordx4 v[116:119], v7, s[72:75], s51 offen offset:1024 sc1
    v_mfma_f32_16x16x32_bf16 v[88:91], a[188:191], v[120:123], v[88:91]
    ds_write_b128 v2, v[44:47] offset:1024
    v_mfma_f32_16x16x32_bf16 v[92:95], a[188:191], v[124:127], v[92:95]
    s_waitcnt vmcnt(8)
    v_mfma_f32_16x16x32_bf16 v[64:67], v[192:195], v[128:131], v[64:67]
    s_add_u32 s49, s8, 8
    s_and_b32 s49, s49, 31
    v_mfma_f32_16x16x32_bf16 v[68:71], v[192:195], v[132:135], v[68:71]
    s_lshl_b32 s51, s49, 11
    v_mfma_f32_16x16x32_bf16 v[72:75], v[196:199], v[128:131], v[72:75]
    buffer_load_dwordx4 v[120:123], v7, s[72:75], s51 offen offset:0 sc1
    v_mfma_f32_16x16x32_bf16 v[76:79], v[196:199], v[132:135], v[76:79]
    ds_write_b128 v2, v[48:51] offset:2048
    v_mfma_f32_16x16x32_bf16 v[80:83], v[200:203], v[128:131], v[80:83]
    v_mfma_f32_16x16x32_bf16 v[84:87], v[200:203], v[132:135], v[84:87]
    buffer_load_dwordx4 v[124:127], v7, s[72:75], s51 offen offset:1024 sc1
    v_mfma_f32_16x16x32_bf16 v[88:91], v[204:207], v[128:131], v[88:91]
    ds_write_b128 v2, v[52:55] offset:3072
    v_mfma_f32_16x16x32_bf16 v[92:95], v[204:207], v[132:135], v[92:95]
    s_waitcnt vmcnt(8)
    v_mfma_f32_16x16x32_bf16 v[64:67], a[192:195], v[136:139], v[64:67]
    s_add_u32 s49, s8, 9
    s_and_b32 s49, s49, 31
    v_mfma_f32_16x16x32_bf16 v[68:71], a[192:195], v[140:143], v[68:71]
    s_lshl_b32 s51, s49, 11
    v_mfma_f32_16x16x32_bf16 v[72:75], a[196:199], v[136:139], v[72:75]
    buffer_load_dwordx4 v[128:131], v7, s[72:75], s51 offen offset:0 sc1
    v_mfma_f32_16x16x32_bf16 v[76:79], a[196:199], v[140:143], v[76:79]
    ds_write_b128 v3, v[56:59] offset:0
    v_mfma_f32_16x16x32_bf16 v[80:83], a[200:203], v[136:139], v[80:83]
    v_mfma_f32_16x16x32_bf16 v[84:87], a[200:203], v[140:143], v[84:87]
    buffer_load_dwordx4 v[132:135], v7, s[72:75], s51 offen offset:1024 sc1
    v_mfma_f32_16x16x32_bf16 v[88:91], a[204:207], v[136:139], v[88:91]
    ds_write_b128 v3, v[60:63] offset:1024
    v_mfma_f32_16x16x32_bf16 v[92:95], a[204:207], v[140:143], v[92:95]
    s_waitcnt vmcnt(8)
    v_mfma_f32_16x16x32_bf16 v[64:67], a[208:211], v[96:99], v[64:67]
    s_add_u32 s49, s8, 17
    s_and_b32 s49, s49, 31
    v_mfma_f32_16x16x32_bf16 v[68:71], a[208:211], v[100:103], v[68:71]
    s_lshl_b32 s51, s49, 11
    v_mfma_f32_16x16x32_bf16 v[72:75], a[212:215], v[96:99], v[72:75]
    buffer_load_dwordx4 v[136:139], v7, s[72:75], s51 offen offset:0 sc1
    v_mfma_f32_16x16x32_bf16 v[76:79], a[212:215], v[100:103], v[76:79]
    v_mfma_f32_16x16x32_bf16 v[80:83], a[216:219], v[96:99], v[80:83]
    v_mfma_f32_16x16x32_bf16 v[84:87], a[216:219], v[100:103], v[84:87]
    buffer_load_dwordx4 v[140:143], v7, s[72:75], s51 offen offset:1024 sc1
    v_mfma_f32_16x16x32_bf16 v[88:91], a[220:223], v[96:99], v[88:91]
    v_mfma_f32_16x16x32_bf16 v[92:95], a[220:223], v[100:103], v[92:95]
    s_waitcnt vmcnt(8)
    v_mfma_f32_16x16x32_bf16 v[64:67], a[0:3], v[104:107], v[64:67]
    s_add_u32 s49, s8, 10
    s_and_b32 s49, s49, 31
    v_mfma_f32_16x16x32_bf16 v[68:71], a[0:3], v[108:111], v[68:71]
    s_lshl_b32 s51, s49, 11
    v_mfma_f32_16x16x32_bf16 v[72:75], a[4:7], v[104:107], v[72:75]
    buffer_load_dwordx4 v[96:99], v7, s[72:75], s51 offen offset:0 sc1
    v_mfma_f32_16x16x32_bf16 v[76:79], a[4:7], v[108:111], v[76:79]
    v_mfma_f32_16x16x32_bf16 v[80:83], a[8:11], v[104:107], v[80:83]
    v_mfma_f32_16x16x32_bf16 v[84:87], a[8:11], v[108:111], v[84:87]
    buffer_load_dwordx4 v[100:103], v7, s[72:75], s51 offen offset:1024 sc1
    v_mfma_f32_16x16x32_bf16 v[88:91], a[12:15], v[104:107], v[88:91]
    v_mfma_f32_16x16x32_bf16 v[92:95], a[12:15], v[108:111], v[92:95]
    s_waitcnt lgkmcnt(0)
    s_barrier
    s_waitcnt vmcnt(8)
    v_mfma_f32_16x16x32_bf16 v[64:67], v[208:211], v[112:115], v[64:67]
    s_add_u32 s49, s8, 11
    s_and_b32 s49, s49, 31
    v_mfma_f32_16x16x32_bf16 v[68:71], v[208:211], v[116:119], v[68:71]
    s_lshl_b32 s51, s49, 11
    v_mfma_f32_16x16x32_bf16 v[72:75], v[212:215], v[112:115], v[72:75]
    buffer_load_dwordx4 v[104:107], v7, s[72:75], s51 offen offset:0 sc1
    v_mfma_f32_16x16x32_bf16 v[76:79], v[212:215], v[116:119], v[76:79]
    s_xor_b32 s49, s56, 4096
    s_add_u32 s49, s49, 131072
    v_add_u32 v2, s49, v7
    v_mfma_f32_16x16x32_bf16 v[80:83], v[216:219], v[112:115], v[80:83]
    s_xor_b32 s49, s56, 8192
    s_add_u32 s49, s49, 131072
    v_add_u32 v3, s49, v7
    v_mfma_f32_16x16x32_bf16 v[84:87], v[216:219], v[116:119], v[84:87]
    buffer_load_dwordx4 v[108:111], v7, s[72:75], s51 offen offset:1024 sc1
    v_mfma_f32_16x16x32_bf16 v[88:91], v[220:223], v[112:115], v[88:91]
    s_xor_b32 s49, s56, 12288
    s_add_u32 s49, s49, 147456
    v_add_u32 v4, s49, v7
    v_mfma_f32_16x16x32_bf16 v[92:95], v[220:223], v[116:119], v[92:95]
    s_waitcnt vmcnt(8)
    v_mfma_f32_16x16x32_bf16 v[64:67], a[224:227], v[120:123], v[64:67]
    s_add_u32 s49, s8, 12
    s_and_b32 s49, s49, 31
    ds_read_b128 v[40:43], v2 offset:0
    v_mfma_f32_16x16x32_bf16 v[68:71], a[224:227], v[124:127], v[68:71]
    s_lshl_b32 s51, s49, 11
    ds_read_b128 v[44:47], v2 offset:1024
    v_mfma_f32_16x16x32_bf16 v[72:75], a[228:231], v[120:123], v[72:75]
    buffer_load_dwordx4 v[112:115], v7, s[72:75], s51 offen offset:0 sc1
    v_mfma_f32_16x16x32_bf16 v[76:79], a[228:231], v[124:127], v[76:79]
    ds_read_b128 v[48:51], v3 offset:2048
    v_mfma_f32_16x16x32_bf16 v[80:83], a[232:235], v[120:123], v[80:83]
    ds_read_b128 v[52:55], v3 offset:3072
    v_mfma_f32_16x16x32_bf16 v[84:87], a[232:235], v[124:127], v[84:87]
    buffer_load_dwordx4 v[116:119], v7, s[72:75], s51 offen offset:1024 sc1
    v_mfma_f32_16x16x32_bf16 v[88:91], a[236:239], v[120:123], v[88:91]
    ds_read_b128 v[56:59], v4 offset:0
    v_mfma_f32_16x16x32_bf16 v[92:95], a[236:239], v[124:127], v[92:95]
    ds_read_b128 v[60:63], v4 offset:1024
    s_waitcnt vmcnt(8)
    v_mfma_f32_16x16x32_bf16 v[64:67], v[224:227], v[128:131], v[64:67]
    s_add_u32 s49, s8, 13
    s_and_b32 s49, s49, 31
    v_mfma_f32_16x16x32_bf16 v[68:71], v[224:227], v[132:135], v[68:71]
    s_lshl_b32 s51, s49, 11
    v_mfma_f32_16x16x32_bf16 v[72:75], v[228:231], v[128:131], v[72:75]
    buffer_load_dwordx4 v[120:123], v7, s[72:75], s51 offen offset:0 sc1
    v_mfma_f32_16x16x32_bf16 v[76:79], v[228:231], v[132:135], v[76:79]
    v_and_b32 v5, 31, v0
    s_lshl_b32 s49, s64, 6
    s_add_u32 s49, s49, 32
    v_add_u32 v5, s49, v5
    v_mfma_f32_16x16x32_bf16 v[80:83], v[232:235], v[128:131], v[80:83]
    v_lshlrev_b32 v5, 10, v5
    v_lshrrev_b32 v6, 5, v0
    v_lshl_add_u32 v5, v6, 4, v5
    v_mfma_f32_16x16x32_bf16 v[84:87], v[232:235], v[132:135], v[84:87]
    buffer_load_dwordx4 v[124:127], v7, s[72:75], s51 offen offset:1024 sc1
    v_mfma_f32_16x16x32_bf16 v[88:91], v[236:239], v[128:131], v[88:91]
    s_lshl_b32 s49, s42, 5
    s_lshl_b32 s50, s65, 7
    s_add_u32 s50, s50, s49
    s_waitcnt lgkmcnt(0)
    v_mfma_f32_16x16x32_bf16 v[92:95], v[236:239], v[132:135], v[92:95]
    s_waitcnt vmcnt(8)
    v_mfma_f32_16x16x32_bf16 v[64:67], a[16:19], v[136:139], v[64:67]
    v_add_f32 v32, v32, v40
    v_mfma_f32_16x16x32_bf16 v[68:71], a[16:19], v[140:143], v[68:71]
    v_add_f32 v48, v48, v56
    v_mfma_f32_16x16x32_bf16 v[72:75], a[20:23], v[136:139], v[72:75]
    v_mfma_f32_16x16x32_bf16 v[76:79], a[20:23], v[140:143], v[76:79]
    v_add_f32 v33, v33, v41
    v_add_f32 v49, v49, v57
    v_mfma_f32_16x16x32_bf16 v[80:83], a[24:27], v[136:139], v[80:83]
    v_add_f32 v34, v34, v42
    v_mfma_f32_16x16x32_bf16 v[84:87], a[24:27], v[140:143], v[84:87]
    v_mfma_f32_16x16x32_bf16 v[88:91], a[28:31], v[136:139], v[88:91]
    v_add_f32 v50, v50, v58
    v_mfma_f32_16x16x32_bf16 v[92:95], a[28:31], v[140:143], v[92:95]
    v_add_f32 v35, v35, v43
    s_waitcnt vmcnt(6)
    v_mfma_f32_16x16x32_bf16 v[64:67], v[240:243], v[96:99], v[64:67]
    v_add_f32 v51, v51, v59
    v_mfma_f32_16x16x32_bf16 v[68:71], v[240:243], v[100:103], v[68:71]
    v_add_f32 v36, v36, v44
    v_mfma_f32_16x16x32_bf16 v[72:75], v[244:247], v[96:99], v[72:75]
    v_mfma_f32_16x16x32_bf16 v[76:79], v[244:247], v[100:103], v[76:79]
    v_add_f32 v52, v52, v60
    v_add_f32 v37, v37, v45
    v_mfma_f32_16x16x32_bf16 v[80:83], v[248:251], v[96:99], v[80:83]
    v_add_f32 v53, v53, v61
    v_mfma_f32_16x16x32_bf16 v[84:87], v[248:251], v[100:103], v[84:87]
    v_mfma_f32_16x16x32_bf16 v[88:91], v[252:255], v[96:99], v[88:91]
    v_add_f32 v38, v38, v46
    v_mfma_f32_16x16x32_bf16 v[92:95], v[252:255], v[100:103], v[92:95]
    v_add_f32 v54, v54, v62
    s_waitcnt vmcnt(4)
    v_mfma_f32_16x16x32_bf16 v[64:67], a[240:243], v[104:107], v[64:67]
    v_add_f32 v39, v39, v47
    v_mfma_f32_16x16x32_bf16 v[68:71], a[240:243], v[108:111], v[68:71]
    v_add_f32 v55, v55, v63
    v_mfma_f32_16x16x32_bf16 v[72:75], a[244:247], v[104:107], v[72:75]
    v_mfma_f32_16x16x32_bf16 v[76:79], a[244:247], v[108:111], v[76:79]
    v_add_f32 v32, v32, v48
    v_add_f32 v33, v33, v49
    v_mfma_f32_16x16x32_bf16 v[80:83], a[248:251], v[104:107], v[80:83]
    v_add_f32 v34, v34, v50
    v_mfma_f32_16x16x32_bf16 v[84:87], a[248:251], v[108:111], v[84:87]
    v_mfma_f32_16x16x32_bf16 v[88:91], a[252:255], v[104:107], v[88:91]
    v_add_f32 v35, v35, v51
    v_mfma_f32_16x16x32_bf16 v[92:95], a[252:255], v[108:111], v[92:95]
    v_add_f32 v36, v36, v52
    s_waitcnt vmcnt(2)
    v_mfma_f32_16x16x32_bf16 v[64:67], a[64:67], v[112:115], v[64:67]
    v_add_f32 v37, v37, v53
    v_mfma_f32_16x16x32_bf16 v[68:71], a[64:67], v[116:119], v[68:71]
    v_add_f32 v38, v38, v54
    v_mfma_f32_16x16x32_bf16 v[72:75], a[68:71], v[112:115], v[72:75]
    v_mfma_f32_16x16x32_bf16 v[76:79], a[68:71], v[116:119], v[76:79]
    v_add_f32 v39, v39, v55
    v_cvt_pk_bf16_f32 v32, v32, v33
    v_mfma_f32_16x16x32_bf16 v[80:83], a[72:75], v[112:115], v[80:83]
    v_cvt_pk_bf16_f32 v33, v34, v35
    v_mfma_f32_16x16x32_bf16 v[84:87], a[72:75], v[116:119], v[84:87]
    v_mfma_f32_16x16x32_bf16 v[88:91], a[76:79], v[112:115], v[88:91]
    v_cvt_pk_bf16_f32 v34, v36, v37
    v_mfma_f32_16x16x32_bf16 v[92:95], a[76:79], v[116:119], v[92:95]
    v_cvt_pk_bf16_f32 v35, v38, v39
    s_waitcnt vmcnt(0)
    v_mfma_f32_16x16x32_bf16 v[64:67], a[80:83], v[120:123], v[64:67]
    v_mfma_f32_16x16x32_bf16 v[68:71], a[80:83], v[124:127], v[68:71]
    v_mfma_f32_16x16x32_bf16 v[72:75], a[84:87], v[120:123], v[72:75]
    v_mfma_f32_16x16x32_bf16 v[76:79], a[84:87], v[124:127], v[76:79]
    s_nop 1
    v_permlane16_swap_b32 v32, v34
    v_permlane16_swap_b32 v33, v35
    buffer_store_dwordx4 v[32:35], v5, s[76:79], s50 offen
    v_mfma_f32_16x16x32_bf16 v[80:83], a[88:91], v[120:123], v[80:83]
    v_mfma_f32_16x16x32_bf16 v[84:87], a[88:91], v[124:127], v[84:87]
    v_mfma_f32_16x16x32_bf16 v[88:91], a[92:95], v[120:123], v[88:91]
    v_mfma_f32_16x16x32_bf16 v[92:95], a[92:95], v[124:127], v[92:95]
    s_nop 4
    v_add_u32 v2, s56, v7
    v_add_u32 v2, 32768, v2
    v_add_u32 v3, 16384, v2
    ds_write_b128 v2, v[72:75] offset:0
    ds_write_b128 v2, v[76:79] offset:1024
    ds_write_b128 v2, v[80:83] offset:2048
    ds_write_b128 v2, v[84:87] offset:3072
    ds_write_b128 v3, v[88:91] offset:0
    ds_write_b128 v3, v[92:95] offset:1024
    s_waitcnt lgkmcnt(0)
    s_barrier
    s_xor_b32 s49, s56, 4096
    s_add_u32 s49, s49, 32768
    v_add_u32 v2, s49, v7
    s_xor_b32 s49, s56, 8192
    s_add_u32 s49, s49, 32768
    v_add_u32 v3, s49, v7
    s_xor_b32 s49, s56, 12288
    s_add_u32 s49, s49, 49152
    v_add_u32 v4, s49, v7
    ds_read_b128 v[72:75], v2 offset:0
    ds_read_b128 v[76:79], v2 offset:1024
    ds_read_b128 v[80:83], v3 offset:2048
    ds_read_b128 v[84:87], v3 offset:3072
    ds_read_b128 v[88:91], v4 offset:0
    ds_read_b128 v[92:95], v4 offset:1024
    v_and_b32 v5, 31, v0
    s_lshl_b32 s49, s64, 6
    s_add_u32 s49, s49, 0
    v_add_u32 v5, s49, v5
    v_lshlrev_b32 v5, 10, v5
    v_lshrrev_b32 v6, 5, v0
    v_lshl_add_u32 v5, v6, 4, v5
    s_lshl_b32 s49, s42, 5
    s_lshl_b32 s50, s65, 7
    s_add_u32 s50, s50, s49
    s_waitcnt lgkmcnt(0)
    v_add_f32 v64, v64, v72
    v_add_f32 v80, v80, v88
    v_add_f32 v65, v65, v73
    v_add_f32 v81, v81, v89
    v_add_f32 v66, v66, v74
    v_add_f32 v82, v82, v90
    v_add_f32 v67, v67, v75
    v_add_f32 v83, v83, v91
    v_add_f32 v68, v68, v76
    v_add_f32 v84, v84, v92
    v_add_f32 v69, v69, v77
    v_add_f32 v85, v85, v93
    v_add_f32 v70, v70, v78
    v_add_f32 v86, v86, v94
    v_add_f32 v71, v71, v79
    v_add_f32 v87, v87, v95
    v_add_f32 v64, v64, v80
    v_add_f32 v65, v65, v81
    v_add_f32 v66, v66, v82
    v_add_f32 v67, v67, v83
    v_add_f32 v68, v68, v84
    v_add_f32 v69, v69, v85
    v_add_f32 v70, v70, v86
    v_add_f32 v71, v71, v87
    v_cvt_pk_bf16_f32 v64, v64, v65
    v_cvt_pk_bf16_f32 v65, v66, v67
    v_cvt_pk_bf16_f32 v66, v68, v69
    v_cvt_pk_bf16_f32 v67, v70, v71
    s_nop 1
    v_permlane16_swap_b32 v64, v66
    v_permlane16_swap_b32 v65, v67
    buffer_store_dwordx4 v[64:67], v5, s[76:79], s50 offen
L_end:
    s_endpgm
L_slow1:
    s_waitcnt vmcnt(0)
    s_nop 8
    v_and_b32 v2, 15, v0
    v_bfe_u32 v3, v0, 4, 1
    v_lshrrev_b32 v4, 5, v0
    v_lshl_add_u32 v3, v3, 1, v4
    v_lshlrev_b32 v3, 4, v3
    v_lshl_add_u32 v20, v2, 8, v3
    v_add_u32 v21, 4096, v20
    v_lshrrev_b32 v3, 4, v0
    v_lshlrev_b32 v22, 1, v2
    v_lshl_add_u32 v22, v3, 10, v22
    v_add_u32 v23, 4096, v22
    v_mov_b32 v1, 0xff800000
    v_mov_b32 v2, 0xff800000
    s_mov_b32 s50, 0
L_slow_max1:
    buffer_load_dwordx4 v[80:83], v20, s[28:31], s50 offen offset:0
    buffer_load_dwordx4 v[84:87], v20, s[28:31], s50 offen offset:64
    buffer_load_dwordx4 v[88:91], v20, s[28:31], s50 offen offset:128
    buffer_load_dwordx4 v[92:95], v20, s[28:31], s50 offen offset:192
    s_waitcnt vmcnt(0)
    v_mfma_f32_16x16x32_bf16 v[48:51], v[80:83], v[160:163], 0
    v_mfma_f32_16x16x32_bf16 v[48:51], v[84:87], v[164:167], v[48:51]
    v_mfma_f32_16x16x32_bf16 v[48:51], v[88:91], v[168:171], v[48:51]
    v_mfma_f32_16x16x32_bf16 v[48:51], v[92:95], v[172:175], v[48:51]
    v_mfma_f32_16x16x32_bf16 v[56:59], v[80:83], v[176:179], 0
    v_mfma_f32_16x16x32_bf16 v[56:59], v[84:87], v[180:183], v[56:59]
    v_mfma_f32_16x16x32_bf16 v[56:59], v[88:91], v[184:187], v[56:59]
    v_mfma_f32_16x16x32_bf16 v[56:59], v[92:95], v[188:191], v[56:59]
    buffer_load_dwordx4 v[80:83], v21, s[28:31], s50 offen offset:0
    buffer_load_dwordx4 v[84:87], v21, s[28:31], s50 offen offset:64
    buffer_load_dwordx4 v[88:91], v21, s[28:31], s50 offen offset:128
    buffer_load_dwordx4 v[92:95], v21, s[28:31], s50 offen offset:192
    s_waitcnt vmcnt(0)
    v_mfma_f32_16x16x32_bf16 v[52:55], v[80:83], v[160:163], 0
    v_mfma_f32_16x16x32_bf16 v[52:55], v[84:87], v[164:167], v[52:55]
    v_mfma_f32_16x16x32_bf16 v[52:55], v[88:91], v[168:171], v[52:55]
    v_mfma_f32_16x16x32_bf16 v[52:55], v[92:95], v[172:175], v[52:55]
    v_mfma_f32_16x16x32_bf16 v[60:63], v[80:83], v[176:179], 0
    v_mfma_f32_16x16x32_bf16 v[60:63], v[84:87], v[180:183], v[60:63]
    v_mfma_f32_16x16x32_bf16 v[60:63], v[88:91], v[184:187], v[60:63]
    v_mfma_f32_16x16x32_bf16 v[60:63], v[92:95], v[188:191], v[60:63]
    s_nop 8
    v_max3_f32 v1, v1, v48, v49
    v_max3_f32 v1, v1, v50, v51
    v_max3_f32 v1, v1, v52, v53
    v_max3_f32 v1, v1, v54, v55
    v_max3_f32 v2, v2, v56, v57
    v_max3_f32 v2, v2, v58, v59
    v_max3_f32 v2, v2, v60, v61
    v_max3_f32 v2, v2, v62, v63
    s_add_u32 s50, s50, 8192
    s_cmp_lt_u32 s50, 131072
    s_cbranch_scc1 L_slow_max1
    v_mov_b32 v3, v1
    v_mov_b32 v4, v2
    s_nop 0
    v_permlane16_swap_b32 v1, v3
    v_permlane16_swap_b32 v2, v4
    v_max_f32 v1, v1, v3
    v_max_f32 v2, v2, v4
    v_mov_b32 v3, v1
    v_mov_b32 v4, v2
    s_nop 0
    v_permlane32_swap_b32 v1, v3
    v_permlane32_swap_b32 v2, v4
    v_min_f32 v104, -v1, -v3
    v_min_f32 v108, -v2, -v4
    v_min_f32 v108, s54, v108
    v_mov_b32 v105, v104
    v_mov_b32 v109, v108
    v_mov_b64 v[106:107], v[104:105]
    v_mov_b64 v[110:111], v[108:109]
    v_mov_b64 v[116:117], 0
    v_mov_b64 v[118:119], 0
    s_mov_b32 s50, 0
    v_mov_b64 v[192:193], 0
    v_mov_b64 v[194:195], 0
    v_mov_b64 v[196:197], 0
    v_mov_b64 v[198:199], 0
    v_mov_b64 v[200:201], 0
    v_mov_b64 v[202:203], 0
    v_mov_b64 v[204:205], 0
    v_mov_b64 v[206:207], 0
    v_mov_b64 v[208:209], 0
    v_mov_b64 v[210:211], 0
    v_mov_b64 v[212:213], 0
    v_mov_b64 v[214:215], 0
    v_mov_b64 v[216:217], 0
    v_mov_b64 v[218:219], 0
    v_mov_b64 v[220:221], 0
    v_mov_b64 v[222:223], 0
    v_mov_b64 v[224:225], 0
    v_mov_b64 v[226:227], 0
    v_mov_b64 v[228:229], 0
    v_mov_b64 v[230:231], 0
    v_mov_b64 v[232:233], 0
    v_mov_b64 v[234:235], 0
    v_mov_b64 v[236:237], 0
    v_mov_b64 v[238:239], 0
    v_mov_b64 v[240:241], 0
    v_mov_b64 v[242:243], 0
    v_mov_b64 v[244:245], 0
    v_mov_b64 v[246:247], 0
    v_mov_b64 v[248:249], 0
    v_mov_b64 v[250:251], 0
    v_mov_b64 v[252:253], 0
    v_mov_b64 v[254:255], 0
L_slow_pv1:
    buffer_load_dwordx4 v[80:83], v20, s[28:31], s50 offen offset:0
    buffer_load_dwordx4 v[84:87], v20, s[28:31], s50 offen offset:64
    buffer_load_dwordx4 v[88:91], v20, s[28:31], s50 offen offset:128
    buffer_load_dwordx4 v[92:95], v20, s[28:31], s50 offen offset:192
    s_waitcnt vmcnt(0)
    v_mfma_f32_16x16x32_bf16 v[48:51], v[80:83], v[160:163], v[104:107]
    v_mfma_f32_16x16x32_bf16 v[48:51], v[84:87], v[164:167], v[48:51]
    v_mfma_f32_16x16x32_bf16 v[48:51], v[88:91], v[168:171], v[48:51]
    v_mfma_f32_16x16x32_bf16 v[48:51], v[92:95], v[172:175], v[48:51]
    v_mfma_f32_16x16x32_bf16 v[56:59], v[80:83], v[176:179], v[108:111]
    v_mfma_f32_16x16x32_bf16 v[56:59], v[84:87], v[180:183], v[56:59]
    v_mfma_f32_16x16x32_bf16 v[56:59], v[88:91], v[184:187], v[56:59]
    v_mfma_f32_16x16x32_bf16 v[56:59], v[92:95], v[188:191], v[56:59]
    buffer_load_dwordx4 v[80:83], v21, s[28:31], s50 offen offset:0
    buffer_load_dwordx4 v[84:87], v21, s[28:31], s50 offen offset:64
    buffer_load_dwordx4 v[88:91], v21, s[28:31], s50 offen offset:128
    buffer_load_dwordx4 v[92:95], v21, s[28:31], s50 offen offset:192
    s_waitcnt vmcnt(0)
    v_mfma_f32_16x16x32_bf16 v[52:55], v[80:83], v[160:163], v[104:107]
    v_mfma_f32_16x16x32_bf16 v[52:55], v[84:87], v[164:167], v[52:55]
    v_mfma_f32_16x16x32_bf16 v[52:55], v[88:91], v[168:171], v[52:55]
    v_mfma_f32_16x16x32_bf16 v[52:55], v[92:95], v[172:175], v[52:55]
    v_mfma_f32_16x16x32_bf16 v[60:63], v[80:83], v[176:179], v[108:111]
    v_mfma_f32_16x16x32_bf16 v[60:63], v[84:87], v[180:183], v[60:63]
    v_mfma_f32_16x16x32_bf16 v[60:63], v[88:91], v[184:187], v[60:63]
    v_mfma_f32_16x16x32_bf16 v[60:63], v[92:95], v[188:191], v[60:63]
    s_nop 8
    v_exp_f32 v48, v48
    v_exp_f32 v49, v49
    v_exp_f32 v50, v50
    v_cvt_pk_bf16_f32 v48, v48, v49
    v_exp_f32 v51, v51
    v_exp_f32 v52, v52
    v_cvt_pk_bf16_f32 v49, v50, v51
    v_exp_f32 v53, v53
    v_exp_f32 v54, v54
    v_cvt_pk_bf16_f32 v50, v52, v53
    v_exp_f32 v55, v55
    v_exp_f32 v56, v56
    v_cvt_pk_bf16_f32 v51, v54, v55
    v_exp_f32 v57, v57
    v_exp_f32 v58, v58
    v_cvt_pk_bf16_f32 v56, v56, v57
    v_exp_f32 v59, v59
    v_exp_f32 v60, v60
    v_cvt_pk_bf16_f32 v57, v58, v59
    v_exp_f32 v61, v61
    v_exp_f32 v62, v62
    v_cvt_pk_bf16_f32 v58, v60, v61
    v_exp_f32 v63, v63
    s_nop 0
    v_cvt_pk_bf16_f32 v59, v62, v63
    s_nop 1
    v_mfma_f32_16x16x32_bf16 v[116:119], v[120:123], v[48:51], v[116:119]
    v_mfma_f32_16x16x32_bf16 v[116:119], v[124:127], v[56:59], v[116:119]
    buffer_load_ushort v88, v22, s[32:35], s50 offen offset:0
    buffer_load_ushort v89, v22, s[32:35], s50 offen offset:256
    buffer_load_ushort v90, v22, s[32:35], s50 offen offset:512
    buffer_load_ushort v91, v22, s[32:35], s50 offen offset:768
    buffer_load_ushort v92, v23, s[32:35], s50 offen offset:0
    buffer_load_ushort v93, v23, s[32:35], s50 offen offset:256
    buffer_load_ushort v94, v23, s[32:35], s50 offen offset:512
    buffer_load_ushort v95, v23, s[32:35], s50 offen offset:768
    s_waitcnt vmcnt(0)
    v_lshl_or_b32 v80, v89, 16, v88
    v_lshl_or_b32 v81, v91, 16, v90
    v_lshl_or_b32 v82, v93, 16, v92
    v_lshl_or_b32 v83, v95, 16, v94
    s_nop 1
    v_mfma_f32_16x16x32_bf16 v[192:195], v[80:83], v[48:51], v[192:195]
    v_mfma_f32_16x16x32_bf16 v[224:227], v[80:83], v[56:59], v[224:227]
    buffer_load_ushort v88, v22, s[32:35], s50 offen offset:32
    buffer_load_ushort v89, v22, s[32:35], s50 offen offset:288
    buffer_load_ushort v90, v22, s[32:35], s50 offen offset:544
    buffer_load_ushort v91, v22, s[32:35], s50 offen offset:800
    buffer_load_ushort v92, v23, s[32:35], s50 offen offset:32
    buffer_load_ushort v93, v23, s[32:35], s50 offen offset:288
    buffer_load_ushort v94, v23, s[32:35], s50 offen offset:544
    buffer_load_ushort v95, v23, s[32:35], s50 offen offset:800
    s_waitcnt vmcnt(0)
    v_lshl_or_b32 v80, v89, 16, v88
    v_lshl_or_b32 v81, v91, 16, v90
    v_lshl_or_b32 v82, v93, 16, v92
    v_lshl_or_b32 v83, v95, 16, v94
    s_nop 1
    v_mfma_f32_16x16x32_bf16 v[196:199], v[80:83], v[48:51], v[196:199]
    v_mfma_f32_16x16x32_bf16 v[228:231], v[80:83], v[56:59], v[228:231]
    buffer_load_ushort v88, v22, s[32:35], s50 offen offset:64
    buffer_load_ushort v89, v22, s[32:35], s50 offen offset:320
    buffer_load_ushort v90, v22, s[32:35], s50 offen offset:576
    buffer_load_ushort v91, v22, s[32:35], s50 offen offset:832
    buffer_load_ushort v92, v23, s[32:35], s50 offen offset:64
    buffer_load_ushort v93, v23, s[32:35], s50 offen offset:320
    buffer_load_ushort v94, v23, s[32:35], s50 offen offset:576
    buffer_load_ushort v95, v23, s[32:35], s50 offen offset:832
    s_waitcnt vmcnt(0)
    v_lshl_or_b32 v80, v89, 16, v88
    v_lshl_or_b32 v81, v91, 16, v90
    v_lshl_or_b32 v82, v93, 16, v92
    v_lshl_or_b32 v83, v95, 16, v94
    s_nop 1
    v_mfma_f32_16x16x32_bf16 v[200:203], v[80:83], v[48:51], v[200:203]
    v_mfma_f32_16x16x32_bf16 v[232:235], v[80:83], v[56:59], v[232:235]
    buffer_load_ushort v88, v22, s[32:35], s50 offen offset:96
    buffer_load_ushort v89, v22, s[32:35], s50 offen offset:352
    buffer_load_ushort v90, v22, s[32:35], s50 offen offset:608
    buffer_load_ushort v91, v22, s[32:35], s50 offen offset:864
    buffer_load_ushort v92, v23, s[32:35], s50 offen offset:96
    buffer_load_ushort v93, v23, s[32:35], s50 offen offset:352
    buffer_load_ushort v94, v23, s[32:35], s50 offen offset:608
    buffer_load_ushort v95, v23, s[32:35], s50 offen offset:864
    s_waitcnt vmcnt(0)
    v_lshl_or_b32 v80, v89, 16, v88
    v_lshl_or_b32 v81, v91, 16, v90
    v_lshl_or_b32 v82, v93, 16, v92
    v_lshl_or_b32 v83, v95, 16, v94
    s_nop 1
    v_mfma_f32_16x16x32_bf16 v[204:207], v[80:83], v[48:51], v[204:207]
    v_mfma_f32_16x16x32_bf16 v[236:239], v[80:83], v[56:59], v[236:239]
    buffer_load_ushort v88, v22, s[32:35], s50 offen offset:128
    buffer_load_ushort v89, v22, s[32:35], s50 offen offset:384
    buffer_load_ushort v90, v22, s[32:35], s50 offen offset:640
    buffer_load_ushort v91, v22, s[32:35], s50 offen offset:896
    buffer_load_ushort v92, v23, s[32:35], s50 offen offset:128
    buffer_load_ushort v93, v23, s[32:35], s50 offen offset:384
    buffer_load_ushort v94, v23, s[32:35], s50 offen offset:640
    buffer_load_ushort v95, v23, s[32:35], s50 offen offset:896
    s_waitcnt vmcnt(0)
    v_lshl_or_b32 v80, v89, 16, v88
    v_lshl_or_b32 v81, v91, 16, v90
    v_lshl_or_b32 v82, v93, 16, v92
    v_lshl_or_b32 v83, v95, 16, v94
    s_nop 1
    v_mfma_f32_16x16x32_bf16 v[208:211], v[80:83], v[48:51], v[208:211]
    v_mfma_f32_16x16x32_bf16 v[240:243], v[80:83], v[56:59], v[240:243]
    buffer_load_ushort v88, v22, s[32:35], s50 offen offset:160
    buffer_load_ushort v89, v22, s[32:35], s50 offen offset:416
    buffer_load_ushort v90, v22, s[32:35], s50 offen offset:672
    buffer_load_ushort v91, v22, s[32:35], s50 offen offset:928
    buffer_load_ushort v92, v23, s[32:35], s50 offen offset:160
    buffer_load_ushort v93, v23, s[32:35], s50 offen offset:416
    buffer_load_ushort v94, v23, s[32:35], s50 offen offset:672
    buffer_load_ushort v95, v23, s[32:35], s50 offen offset:928
    s_waitcnt vmcnt(0)
    v_lshl_or_b32 v80, v89, 16, v88
    v_lshl_or_b32 v81, v91, 16, v90
    v_lshl_or_b32 v82, v93, 16, v92
    v_lshl_or_b32 v83, v95, 16, v94
    s_nop 1
    v_mfma_f32_16x16x32_bf16 v[212:215], v[80:83], v[48:51], v[212:215]
    v_mfma_f32_16x16x32_bf16 v[244:247], v[80:83], v[56:59], v[244:247]
    buffer_load_ushort v88, v22, s[32:35], s50 offen offset:192
    buffer_load_ushort v89, v22, s[32:35], s50 offen offset:448
    buffer_load_ushort v90, v22, s[32:35], s50 offen offset:704
    buffer_load_ushort v91, v22, s[32:35], s50 offen offset:960
    buffer_load_ushort v92, v23, s[32:35], s50 offen offset:192
    buffer_load_ushort v93, v23, s[32:35], s50 offen offset:448
    buffer_load_ushort v94, v23, s[32:35], s50 offen offset:704
    buffer_load_ushort v95, v23, s[32:35], s50 offen offset:960
    s_waitcnt vmcnt(0)
    v_lshl_or_b32 v80, v89, 16, v88
    v_lshl_or_b32 v81, v91, 16, v90
    v_lshl_or_b32 v82, v93, 16, v92
    v_lshl_or_b32 v83, v95, 16, v94
    s_nop 1
    v_mfma_f32_16x16x32_bf16 v[216:219], v[80:83], v[48:51], v[216:219]
    v_mfma_f32_16x16x32_bf16 v[248:251], v[80:83], v[56:59], v[248:251]
    buffer_load_ushort v88, v22, s[32:35], s50 offen offset:224
    buffer_load_ushort v89, v22, s[32:35], s50 offen offset:480
    buffer_load_ushort v90, v22, s[32:35], s50 offen offset:736
    buffer_load_ushort v91, v22, s[32:35], s50 offen offset:992
    buffer_load_ushort v92, v23, s[32:35], s50 offen offset:224
    buffer_load_ushort v93, v23, s[32:35], s50 offen offset:480
    buffer_load_ushort v94, v23, s[32:35], s50 offen offset:736
    buffer_load_ushort v95, v23, s[32:35], s50 offen offset:992
    s_waitcnt vmcnt(0)
    v_lshl_or_b32 v80, v89, 16, v88
    v_lshl_or_b32 v81, v91, 16, v90
    v_lshl_or_b32 v82, v93, 16, v92
    v_lshl_or_b32 v83, v95, 16, v94
    s_nop 1
    v_mfma_f32_16x16x32_bf16 v[220:223], v[80:83], v[48:51], v[220:223]
    v_mfma_f32_16x16x32_bf16 v[252:255], v[80:83], v[56:59], v[252:255]
    s_add_u32 s50, s50, 8192
    s_cmp_lt_u32 s50, 131072
    s_cbranch_scc1 L_slow_pv1
    s_mov_b32 s51, 0x4e800000
    v_add_f32 v1, v116, v117
    v_max_f32 v2, 0x0da24260, v116
    v_max_f32 v4, 0x0da24260, v117
    v_cmp_nge_f32 vcc, s51, v1
    v_rcp_f32 v2, v2
    v_rcp_f32 v4, v4
    s_nop 0
    v_mov_b32 v3, v2
    v_mov_b32 v5, v4
    s_nop 8
    s_branch L_back1
L_slow0:
    s_waitcnt vmcnt(0)
    s_nop 8
    v_and_b32 v2, 15, v0
    v_bfe_u32 v3, v0, 4, 1
    v_lshrrev_b32 v4, 5, v0
    v_lshl_add_u32 v3, v3, 1, v4
    v_lshlrev_b32 v3, 4, v3
    v_lshl_add_u32 v20, v2, 8, v3
    v_add_u32 v21, 4096, v20
    v_lshrrev_b32 v3, 4, v0
    v_lshlrev_b32 v22, 1, v2
    v_lshl_add_u32 v22, v3, 10, v22
    v_add_u32 v23, 4096, v22
    v_mov_b32 v1, 0xff800000
    v_mov_b32 v2, 0xff800000
    s_mov_b32 s50, 0
L_slow_max0:
    buffer_load_dwordx4 v[64:67], v20, s[28:31], s50 offen offset:0
    buffer_load_dwordx4 v[68:71], v20, s[28:31], s50 offen offset:64
    buffer_load_dwordx4 v[72:75], v20, s[28:31], s50 offen offset:128
    buffer_load_dwordx4 v[76:79], v20, s[28:31], s50 offen offset:192
    s_waitcnt vmcnt(0)
    v_mfma_f32_16x16x32_bf16 v[32:35], v[64:67], v[128:131], 0
    v_mfma_f32_16x16x32_bf16 v[32:35], v[68:71], v[132:135], v[32:35]
    v_mfma_f32_16x16x32_bf16 v[32:35], v[72:75], v[136:139], v[32:35]
    v_mfma_f32_16x16x32_bf16 v[32:35], v[76:79], v[140:143], v[32:35]
    v_mfma_f32_16x16x32_bf16 v[40:43], v[64:67], v[144:147], 0
    v_mfma_f32_16x16x32_bf16 v[40:43], v[68:71], v[148:151], v[40:43]
    v_mfma_f32_16x16x32_bf16 v[40:43], v[72:75], v[152:155], v[40:43]
    v_mfma_f32_16x16x32_bf16 v[40:43], v[76:79], v[156:159], v[40:43]
    buffer_load_dwordx4 v[64:67], v21, s[28:31], s50 offen offset:0
    buffer_load_dwordx4 v[68:71], v21, s[28:31], s50 offen offset:64
    buffer_load_dwordx4 v[72:75], v21, s[28:31], s50 offen offset:128
    buffer_load_dwordx4 v[76:79], v21, s[28:31], s50 offen offset:192
    s_waitcnt vmcnt(0)
    v_mfma_f32_16x16x32_bf16 v[36:39], v[64:67], v[128:131], 0
    v_mfma_f32_16x16x32_bf16 v[36:39], v[68:71], v[132:135], v[36:39]
    v_mfma_f32_16x16x32_bf16 v[36:39], v[72:75], v[136:139], v[36:39]
    v_mfma_f32_16x16x32_bf16 v[36:39], v[76:79], v[140:143], v[36:39]
    v_mfma_f32_16x16x32_bf16 v[44:47], v[64:67], v[144:147], 0
    v_mfma_f32_16x16x32_bf16 v[44:47], v[68:71], v[148:151], v[44:47]
    v_mfma_f32_16x16x32_bf16 v[44:47], v[72:75], v[152:155], v[44:47]
    v_mfma_f32_16x16x32_bf16 v[44:47], v[76:79], v[156:159], v[44:47]
    s_nop 8
    v_max3_f32 v1, v1, v32, v33
    v_max3_f32 v1, v1, v34, v35
    v_max3_f32 v1, v1, v36, v37
    v_max3_f32 v1, v1, v38, v39
    v_max3_f32 v2, v2, v40, v41
    v_max3_f32 v2, v2, v42, v43
    v_max3_f32 v2, v2, v44, v45
    v_max3_f32 v2, v2, v46, v47
    s_add_u32 s50, s50, 8192
    s_cmp_lt_u32 s50, 131072
    s_cbranch_scc1 L_slow_max0
    v_mov_b32 v3, v1
    v_mov_b32 v4, v2
    s_nop 0
    v_permlane16_swap_b32 v1, v3
    v_permlane16_swap_b32 v2, v4
    v_max_f32 v1, v1, v3
    v_max_f32 v2, v2, v4
    v_mov_b32 v3, v1
    v_mov_b32 v4, v2
    s_nop 0
    v_permlane32_swap_b32 v1, v3
    v_permlane32_swap_b32 v2, v4
    v_min_f32 v96, -v1, -v3
    v_min_f32 v100, -v2, -v4
    v_mov_b32 v97, v96
    v_mov_b32 v101, v100
    v_mov_b64 v[98:99], v[96:97]
    v_mov_b64 v[102:103], v[100:101]
    v_mov_b64 v[112:113], 0
    v_mov_b64 v[114:115], 0
    s_mov_b32 s50, 0
    v_accvgpr_write_b32 a0, 0
    v_accvgpr_write_b32 a1, 0
    v_accvgpr_write_b32 a2, 0
    v_accvgpr_write_b32 a3, 0
    v_accvgpr_write_b32 a4, 0
    v_accvgpr_write_b32 a5, 0
    v_accvgpr_write_b32 a6, 0
    v_accvgpr_write_b32 a7, 0
    v_accvgpr_write_b32 a8, 0
    v_accvgpr_write_b32 a9, 0
    v_accvgpr_write_b32 a10, 0
    v_accvgpr_write_b32 a11, 0
    v_accvgpr_write_b32 a12, 0
    v_accvgpr_write_b32 a13, 0
    v_accvgpr_write_b32 a14, 0
    v_accvgpr_write_b32 a15, 0
    v_accvgpr_write_b32 a16, 0
    v_accvgpr_write_b32 a17, 0
    v_accvgpr_write_b32 a18, 0
    v_accvgpr_write_b32 a19, 0
    v_accvgpr_write_b32 a20, 0
    v_accvgpr_write_b32 a21, 0
    v_accvgpr_write_b32 a22, 0
    v_accvgpr_write_b32 a23, 0
    v_accvgpr_write_b32 a24, 0
    v_accvgpr_write_b32 a25, 0
    v_accvgpr_write_b32 a26, 0
    v_accvgpr_write_b32 a27, 0
    v_accvgpr_write_b32 a28, 0
    v_accvgpr_write_b32 a29, 0
    v_accvgpr_write_b32 a30, 0
    v_accvgpr_write_b32 a31, 0
    v_accvgpr_write_b32 a32, 0
    v_accvgpr_write_b32 a33, 0
    v_accvgpr_write_b32 a34, 0
    v_accvgpr_write_b32 a35, 0
    v_accvgpr_write_b32 a36, 0
    v_accvgpr_write_b32 a37, 0
    v_accvgpr_write_b32 a38, 0
    v_accvgpr_write_b32 a39, 0
    v_accvgpr_write_b32 a40, 0
    v_accvgpr_write_b32 a41, 0
    v_accvgpr_write_b32 a42, 0
    v_accvgpr_write_b32 a43, 0
    v_accvgpr_write_b32 a44, 0
    v_accvgpr_write_b32 a45, 0
    v_accvgpr_write_b32 a46, 0
    v_accvgpr_write_b32 a47, 0
    v_accvgpr_write_b32 a48, 0
    v_accvgpr_write_b32 a49, 0
    v_accvgpr_write_b32 a50, 0
    v_accvgpr_write_b32 a51, 0
    v_accvgpr_write_b32 a52, 0
    v_accvgpr_write_b32 a53, 0
    v_accvgpr_write_b32 a54, 0
    v_accvgpr_write_b32 a55, 0
    v_accvgpr_write_b32 a56, 0
    v_accvgpr_write_b32 a57, 0
    v_accvgpr_write_b32 a58, 0
    v_accvgpr_write_b32 a59, 0
    v_accvgpr_write_b32 a60, 0
    v_accvgpr_write_b32 a61, 0
    v_accvgpr_write_b32 a62, 0
    v_accvgpr_write_b32 a63, 0
L_slow_pv0:
    buffer_load_dwordx4 v[64:67], v20, s[28:31], s50 offen offset:0
    buffer_load_dwordx4 v[68:71], v20, s[28:31], s50 offen offset:64
    buffer_load_dwordx4 v[72:75], v20, s[28:31], s50 offen offset:128
    buffer_load_dwordx4 v[76:79], v20, s[28:31], s50 offen offset:192
    s_waitcnt vmcnt(0)
    v_mfma_f32_16x16x32_bf16 v[32:35], v[64:67], v[128:131], v[96:99]
    v_mfma_f32_16x16x32_bf16 v[32:35], v[68:71], v[132:135], v[32:35]
    v_mfma_f32_16x16x32_bf16 v[32:35], v[72:75], v[136:139], v[32:35]
    v_mfma_f32_16x16x32_bf16 v[32:35], v[76:79], v[140:143], v[32:35]
    v_mfma_f32_16x16x32_bf16 v[40:43], v[64:67], v[144:147], v[100:103]
    v_mfma_f32_16x16x32_bf16 v[40:43], v[68:71], v[148:151], v[40:43]
    v_mfma_f32_16x16x32_bf16 v[40:43], v[72:75], v[152:155], v[40:43]
    v_mfma_f32_16x16x32_bf16 v[40:43], v[76:79], v[156:159], v[40:43]
    buffer_load_dwordx4 v[64:67], v21, s[28:31], s50 offen offset:0
    buffer_load_dwordx4 v[68:71], v21, s[28:31], s50 offen offset:64
    buffer_load_dwordx4 v[72:75], v21, s[28:31], s50 offen offset:128
    buffer_load_dwordx4 v[76:79], v21, s[28:31], s50 offen offset:192
    s_waitcnt vmcnt(0)
    v_mfma_f32_16x16x32_bf16 v[36:39], v[64:67], v[128:131], v[96:99]
    v_mfma_f32_16x16x32_bf16 v[36:39], v[68:71], v[132:135], v[36:39]
    v_mfma_f32_16x16x32_bf16 v[36:39], v[72:75], v[136:139], v[36:39]
    v_mfma_f32_16x16x32_bf16 v[36:39], v[76:79], v[140:143], v[36:39]
    v_mfma_f32_16x16x32_bf16 v[44:47], v[64:67], v[144:147], v[100:103]
    v_mfma_f32_16x16x32_bf16 v[44:47], v[68:71], v[148:151], v[44:47]
    v_mfma_f32_16x16x32_bf16 v[44:47], v[72:75], v[152:155], v[44:47]
    v_mfma_f32_16x16x32_bf16 v[44:47], v[76:79], v[156:159], v[44:47]
    s_nop 8
    v_exp_f32 v32, v32
    v_exp_f32 v33, v33
    v_exp_f32 v34, v34
    v_cvt_pk_bf16_f32 v32, v32, v33
    v_exp_f32 v35, v35
    v_exp_f32 v36, v36
    v_cvt_pk_bf16_f32 v33, v34, v35
    v_exp_f32 v37, v37
    v_exp_f32 v38, v38
    v_cvt_pk_bf16_f32 v34, v36, v37
    v_exp_f32 v39, v39
    v_exp_f32 v40, v40
    v_cvt_pk_bf16_f32 v35, v38, v39
    v_exp_f32 v41, v41
    v_exp_f32 v42, v42
    v_cvt_pk_bf16_f32 v40, v40, v41
    v_exp_f32 v43, v43
    v_exp_f32 v44, v44
    v_cvt_pk_bf16_f32 v41, v42, v43
    v_exp_f32 v45, v45
    v_exp_f32 v46, v46
    v_cvt_pk_bf16_f32 v42, v44, v45
    v_exp_f32 v47, v47
    s_nop 0
    v_cvt_pk_bf16_f32 v43, v46, v47
    s_nop 1
    v_mfma_f32_16x16x32_bf16 v[112:115], v[120:123], v[32:35], v[112:115]
    v_mfma_f32_16x16x32_bf16 v[112:115], v[124:127], v[40:43], v[112:115]
    buffer_load_ushort v72, v22, s[32:35], s50 offen offset:0
    buffer_load_ushort v73, v22, s[32:35], s50 offen offset:256
    buffer_load_ushort v74, v22, s[32:35], s50 offen offset:512
    buffer_load_ushort v75, v22, s[32:35], s50 offen offset:768
    buffer_load_ushort v76, v23, s[32:35], s50 offen offset:0
    buffer_load_ushort v77, v23, s[32:35], s50 offen offset:256
    buffer_load_ushort v78, v23, s[32:35], s50 offen offset:512
    buffer_load_ushort v79, v23, s[32:35], s50 offen offset:768
    s_waitcnt vmcnt(0)
    v_lshl_or_b32 v64, v73, 16, v72
    v_lshl_or_b32 v65, v75, 16, v74
    v_lshl_or_b32 v66, v77, 16, v76
    v_lshl_or_b32 v67, v79, 16, v78
    s_nop 1
    v_mfma_f32_16x16x32_bf16 a[0:3], v[64:67], v[32:35], a[0:3]
    v_mfma_f32_16x16x32_bf16 a[32:35], v[64:67], v[40:43], a[32:35]
    buffer_load_ushort v72, v22, s[32:35], s50 offen offset:32
    buffer_load_ushort v73, v22, s[32:35], s50 offen offset:288
    buffer_load_ushort v74, v22, s[32:35], s50 offen offset:544
    buffer_load_ushort v75, v22, s[32:35], s50 offen offset:800
    buffer_load_ushort v76, v23, s[32:35], s50 offen offset:32
    buffer_load_ushort v77, v23, s[32:35], s50 offen offset:288
    buffer_load_ushort v78, v23, s[32:35], s50 offen offset:544
    buffer_load_ushort v79, v23, s[32:35], s50 offen offset:800
    s_waitcnt vmcnt(0)
    v_lshl_or_b32 v64, v73, 16, v72
    v_lshl_or_b32 v65, v75, 16, v74
    v_lshl_or_b32 v66, v77, 16, v76
    v_lshl_or_b32 v67, v79, 16, v78
    s_nop 1
    v_mfma_f32_16x16x32_bf16 a[4:7], v[64:67], v[32:35], a[4:7]
    v_mfma_f32_16x16x32_bf16 a[36:39], v[64:67], v[40:43], a[36:39]
    buffer_load_ushort v72, v22, s[32:35], s50 offen offset:64
    buffer_load_ushort v73, v22, s[32:35], s50 offen offset:320
    buffer_load_ushort v74, v22, s[32:35], s50 offen offset:576
    buffer_load_ushort v75, v22, s[32:35], s50 offen offset:832
    buffer_load_ushort v76, v23, s[32:35], s50 offen offset:64
    buffer_load_ushort v77, v23, s[32:35], s50 offen offset:320
    buffer_load_ushort v78, v23, s[32:35], s50 offen offset:576
    buffer_load_ushort v79, v23, s[32:35], s50 offen offset:832
    s_waitcnt vmcnt(0)
    v_lshl_or_b32 v64, v73, 16, v72
    v_lshl_or_b32 v65, v75, 16, v74
    v_lshl_or_b32 v66, v77, 16, v76
    v_lshl_or_b32 v67, v79, 16, v78
    s_nop 1
    v_mfma_f32_16x16x32_bf16 a[8:11], v[64:67], v[32:35], a[8:11]
    v_mfma_f32_16x16x32_bf16 a[40:43], v[64:67], v[40:43], a[40:43]
    buffer_load_ushort v72, v22, s[32:35], s50 offen offset:96
    buffer_load_ushort v73, v22, s[32:35], s50 offen offset:352
    buffer_load_ushort v74, v22, s[32:35], s50 offen offset:608
    buffer_load_ushort v75, v22, s[32:35], s50 offen offset:864
    buffer_load_ushort v76, v23, s[32:35], s50 offen offset:96
    buffer_load_ushort v77, v23, s[32:35], s50 offen offset:352
    buffer_load_ushort v78, v23, s[32:35], s50 offen offset:608
    buffer_load_ushort v79, v23, s[32:35], s50 offen offset:864
    s_waitcnt vmcnt(0)
    v_lshl_or_b32 v64, v73, 16, v72
    v_lshl_or_b32 v65, v75, 16, v74
    v_lshl_or_b32 v66, v77, 16, v76
    v_lshl_or_b32 v67, v79, 16, v78
    s_nop 1
    v_mfma_f32_16x16x32_bf16 a[12:15], v[64:67], v[32:35], a[12:15]
    v_mfma_f32_16x16x32_bf16 a[44:47], v[64:67], v[40:43], a[44:47]
    buffer_load_ushort v72, v22, s[32:35], s50 offen offset:128
    buffer_load_ushort v73, v22, s[32:35], s50 offen offset:384
    buffer_load_ushort v74, v22, s[32:35], s50 offen offset:640
    buffer_load_ushort v75, v22, s[32:35], s50 offen offset:896
    buffer_load_ushort v76, v23, s[32:35], s50 offen offset:128
    buffer_load_ushort v77, v23, s[32:35], s50 offen offset:384
    buffer_load_ushort v78, v23, s[32:35], s50 offen offset:640
    buffer_load_ushort v79, v23, s[32:35], s50 offen offset:896
    s_waitcnt vmcnt(0)
    v_lshl_or_b32 v64, v73, 16, v72
    v_lshl_or_b32 v65, v75, 16, v74
    v_lshl_or_b32 v66, v77, 16, v76
    v_lshl_or_b32 v67, v79, 16, v78
    s_nop 1
    v_mfma_f32_16x16x32_bf16 a[16:19], v[64:67], v[32:35], a[16:19]
    v_mfma_f32_16x16x32_bf16 a[48:51], v[64:67], v[40:43], a[48:51]
    buffer_load_ushort v72, v22, s[32:35], s50 offen offset:160
    buffer_load_ushort v73, v22, s[32:35], s50 offen offset:416
    buffer_load_ushort v74, v22, s[32:35], s50 offen offset:672
    buffer_load_ushort v75, v22, s[32:35], s50 offen offset:928
    buffer_load_ushort v76, v23, s[32:35], s50 offen offset:160
    buffer_load_ushort v77, v23, s[32:35], s50 offen offset:416
    buffer_load_ushort v78, v23, s[32:35], s50 offen offset:672
    buffer_load_ushort v79, v23, s[32:35], s50 offen offset:928
    s_waitcnt vmcnt(0)
    v_lshl_or_b32 v64, v73, 16, v72
    v_lshl_or_b32 v65, v75, 16, v74
    v_lshl_or_b32 v66, v77, 16, v76
    v_lshl_or_b32 v67, v79, 16, v78
    s_nop 1
    v_mfma_f32_16x16x32_bf16 a[20:23], v[64:67], v[32:35], a[20:23]
    v_mfma_f32_16x16x32_bf16 a[52:55], v[64:67], v[40:43], a[52:55]
    buffer_load_ushort v72, v22, s[32:35], s50 offen offset:192
    buffer_load_ushort v73, v22, s[32:35], s50 offen offset:448
    buffer_load_ushort v74, v22, s[32:35], s50 offen offset:704
    buffer_load_ushort v75, v22, s[32:35], s50 offen offset:960
    buffer_load_ushort v76, v23, s[32:35], s50 offen offset:192
    buffer_load_ushort v77, v23, s[32:35], s50 offen offset:448
    buffer_load_ushort v78, v23, s[32:35], s50 offen offset:704
    buffer_load_ushort v79, v23, s[32:35], s50 offen offset:960
    s_waitcnt vmcnt(0)
    v_lshl_or_b32 v64, v73, 16, v72
    v_lshl_or_b32 v65, v75, 16, v74
    v_lshl_or_b32 v66, v77, 16, v76
    v_lshl_or_b32 v67, v79, 16, v78
    s_nop 1
    v_mfma_f32_16x16x32_bf16 a[24:27], v[64:67], v[32:35], a[24:27]
    v_mfma_f32_16x16x32_bf16 a[56:59], v[64:67], v[40:43], a[56:59]
    buffer_load_ushort v72, v22, s[32:35], s50 offen offset:224
    buffer_load_ushort v73, v22, s[32:35], s50 offen offset:480
    buffer_load_ushort v74, v22, s[32:35], s50 offen offset:736
    buffer_load_ushort v75, v22, s[32:35], s50 offen offset:992
    buffer_load_ushort v76, v23, s[32:35], s50 offen offset:224
    buffer_load_ushort v77, v23, s[32:35], s50 offen offset:480
    buffer_load_ushort v78, v23, s[32:35], s50 offen offset:736
    buffer_load_ushort v79, v23, s[32:35], s50 offen offset:992
    s_waitcnt vmcnt(0)
    v_lshl_or_b32 v64, v73, 16, v72
    v_lshl_or_b32 v65, v75, 16, v74
    v_lshl_or_b32 v66, v77, 16, v76
    v_lshl_or_b32 v67, v79, 16, v78
    s_nop 1
    v_mfma_f32_16x16x32_bf16 a[28:31], v[64:67], v[32:35], a[28:31]
    v_mfma_f32_16x16x32_bf16 a[60:63], v[64:67], v[40:43], a[60:63]
    s_add_u32 s50, s50, 8192
    s_cmp_lt_u32 s50, 131072
    s_cbranch_scc1 L_slow_pv0
    s_mov_b32 s51, 0x4e800000
    v_add_f32 v1, v112, v113
    v_max_f32 v2, 0x0da24260, v112
    v_max_f32 v4, 0x0da24260, v113
    v_cmp_nge_f32 vcc, s51, v1
    v_rcp_f32 v2, v2
    v_rcp_f32 v4, v4
    s_nop 0
    v_mov_b32 v3, v2
    v_mov_b32 v5, v4
    s_nop 8
    s_branch L_back0
L_code_end:
.section .rodata,"a"
.p2align 6
.amdhsa_kernel standalone__gqa_block_cached__near_ridge_kernel
  .amdhsa_next_free_vgpr 512
  .amdhsa_next_free_sgpr 102
  .amdhsa_accum_offset 256
  .amdhsa_group_segment_fixed_size 0
  .amdhsa_kernarg_size 64
  .amdhsa_user_sgpr_count 2
  .amdhsa_user_sgpr_kernarg_segment_ptr 1
  .amdhsa_system_sgpr_workgroup_id_x 1
.end_amdhsa_kernel
```
